```python
import torch

def _softmax(x, axis=-1):
    return torch.softmax(x, dim=axis)
def _gelu(x):
    return torch.nn.functional.gelu(x, approximate="tanh")
def _silu(x):
    return torch.nn.functional.silu(x)
def _sigmoid(x):
    return torch.sigmoid(x)
def _layernorm(x, axis=-1, eps=1e-5):
    m = x.mean(dim=axis, keepdim=True)
    v = x.var(dim=axis, keepdim=True, unbiased=False)
    return (x - m) / torch.sqrt(v + eps)
def _scatter_add(tgt, idx, src, axis=0):
    return tgt.clone().index_add_(axis, idx, src)
def _segment_sum(src, seg, n):
    out = torch.zeros((n,) + src.shape[1:], dtype=src.dtype)
    return out.index_add_(0, seg, src)
def _pad(x, pw):
    flat = tuple(v for pair in reversed(pw) for v in pair)
    return torch.nn.functional.pad(x, flat)

kernel_name = 'parallel_sum__mha_block__glu_gated_geglu__prompt'

def setup_inputs():

    _w = (lambda a: (lambda t: t.to(torch.bfloat16) if t.is_floating_point() else t)(torch.as_tensor(a)))
    def _A_setup():
        B, S, D, H = 1, 2048, 512, 32
        return {
            "x": _w((lambda *s: torch.randn(*s, dtype=torch.bfloat16) * 0.05)(B, S, D)),
            "wqkv": _w((lambda *s: torch.randn(*s, dtype=torch.bfloat16) * 0.05)(D, 3 * D)),
            "wo": _w((lambda *s: torch.randn(*s, dtype=torch.bfloat16) * 0.05)(D, D)),
        }
    _A_in = _A_setup()

    def _B_setup():
        B, S, Dm, Df = 1, 2048, 512, 1792
        return {
            "x": _w((lambda *s: torch.randn(*s, dtype=torch.bfloat16) * 0.05)(B, S, Dm)),
            "w_gate": _w((lambda *s: torch.randn(*s, dtype=torch.bfloat16) * 0.4)(Dm, Df) * (Dm ** -0.5)),
            "w_up": _w((lambda *s: torch.randn(*s, dtype=torch.bfloat16) * 0.4)(Dm, Df) * (Dm ** -0.5)),
            "w_down": _w((lambda *s: torch.randn(*s, dtype=torch.bfloat16) * 0.4)(Df, Dm) * (Df ** -0.5)),
        }
    _B_in = _B_setup()

    return {
        "A_x": _A_in["x"],
        "A_wqkv": _A_in["wqkv"],
        "A_wo": _A_in["wo"],
        "B_x": _B_in["x"],
        "B_w_gate": _B_in["w_gate"],
        "B_w_up": _B_in["w_up"],
        "B_w_down": _B_in["w_down"],
    }

def reference(A_x, A_wqkv, A_wo, B_x, B_w_gate, B_w_up, B_w_down):
    def _A_ref(x, wqkv, wo):
        B, S, D = x.shape
        H = 32
        Dh = D // H
        qkv = (lambda x, *d: x.permute(*d))((x @ wqkv).reshape(B, S, 3, H, Dh), 2, 0, 3, 1, 4)
        q, k, v = qkv[0], qkv[1], qkv[2]
        scores = torch.einsum("bhqd,bhkd->bhqk", q, k) * (Dh ** -0.5)
        p = _softmax(scores, axis=-1)
        o = torch.einsum("bhqk,bhkd->bhqd", p, v)
        return (lambda x, *d: x.permute(*d))(o, 0, 2, 1, 3).reshape(B, S, D) @ wo

    def _B_ref(x, w_gate, w_up, w_down):
        g = torch.einsum("bsd,df->bsf", x, w_gate)
        u = torch.einsum("bsd,df->bsf", x, w_up)
        h = _gelu(g) * u
        return torch.einsum("bsf,fd->bsd", h, w_down)

    x = A_x
    xn = _layernorm(x, axis=-1)
    return x + _A_ref(xn, A_wqkv, A_wo) + _B_ref(xn, B_w_gate, B_w_up, B_w_down)
```

```asm
; @launch grid=(256,1,1) block=(512,1,1) lds=163840
.amdgcn_target "amdgcn-amd-amdhsa--gfx950"
.text
.globl parallel_sum__mha_block__glu_gated_geglu__prompt_kernel
.p2align 8
.type parallel_sum__mha_block__glu_gated_geglu__prompt_kernel,@function
parallel_sum__mha_block__glu_gated_geglu__prompt_kernel:
    s_cmp_ge_u32 s2, 256
    s_cbranch_scc1 L_END
    s_load_dwordx16 s[64:79], s[0:1], 0
    s_load_dwordx4 s[80:83], s[0:1], 64
    s_memrealtime s[62:63]
    v_lshrrev_b32 v1, 6, v0
    v_and_b32 v0, 63, v0
    v_readfirstlane_b32 s42, v1
    s_and_b32 s45, s2, 1
    s_lshl_b32 s45, s45, 3
    s_lshr_b32 s3, s2, 3
    s_and_b32 s46, s3, 7
    s_add_u32 s45, s45, s46
    s_lshr_b32 s3, s3, 3
    s_lshl_b32 s3, s3, 2
    s_bfe_u32 s46, s2, 0x20001
    s_add_u32 s46, s46, s3
    s_and_b32 s43, s42, 3
    s_lshr_b32 s44, s42, 2
    s_lshl_b32 s52, s43, 11
    s_lshl_b32 s3, s44, 15
    s_add_u32 s52, s52, s3
    s_lshl_b32 s56, s42, 10
    s_lshl_b32 s48, s45, 17
    s_lshl_b32 s4, s46, 7
    s_add_u32 s57, s4, 2048
    s_sub_u32 s5, s4, 1024
    s_cmp_ge_u32 s46, 8
    s_cselect_b32 s57, s5, s57
    s_mul_i32 s5, s4, 3
    s_sub_u32 s5, s5, 4096
    s_lshl_b32 s58, s46, 8
    s_mov_b32 s59, s58
    s_add_u32 s60, s58, 128
    s_add_u32 s6, s5, 128
    s_add_u32 s7, s5, 256
    s_add_u32 s4, s4, 1536
    s_mov_b32 s53, 229376
    s_movk_i32 s40, 3584
    s_cmp_ge_u32 s46, 12
    s_cselect_b32 s57, s5, s57
    s_cselect_b32 s58, s6, s58
    s_cselect_b32 s59, s7, s59
    s_cselect_b32 s60, s4, s60
    s_cselect_b32 s53, 196608, s53
    s_cselect_b32 s40, 3072, s40
    s_and_b32 s50, s45, 7
    v_lshrrev_b32 v2, 3, v0
    v_lshrrev_b32 v3, 4, v0
    v_and_b32 v4, 7, v0
    s_lshl_b32 s3, s42, 4
    v_add_u32 v12, s3, v2
    v_lshlrev_b32 v12, 10, v12
    v_xor_b32 v13, v4, v3
    v_lshl_add_u32 v5, v13, 4, v12
    v_xor_b32 v6, 64, v5
    v_add_u32 v6, 8192, v6
    s_lshl_b32 s3, s42, 3
    v_add_u32 v12, s3, v2
    v_and_b32 v13, 1, v3
    v_lshlrev_b32 v13, 2, v13
    v_xor_b32 v13, v13, v4
    v_lshlrev_b32 v13, 4, v13
    v_xor_b32 v14, 32, v13
    v_mul_u32_u24 v15, 3072, v12
    v_add_u32 v7, v15, v13
    v_mul_u32_u24 v15, s40, v12
    v_add_u32 v8, v15, v13
    v_add_u32 v9, v15, v14
    v_mul_u32_u24 v15, 3584, v12
    v_add_u32 v10, v15, v13
    v_add_u32 v11, v15, v14
    v_lshlrev_b32 v24, 4, v0
    s_lshl_b32 s4, s2, 13
    s_add_u32 s4, s4, s56
    s_lshl_b32 s3, s2, 3
    s_add_u32 s3, s3, s42
    s_cmp_eq_u32 s3, 0
    s_cselect_b32 s5, 0, 0x7fffff00
    s_waitcnt lgkmcnt(0)
    s_mov_b32 s8, s64
    s_and_b32 s9, s65, 0xffff
    s_mov_b32 s10, 0x200000
    s_mov_b32 s11, 0x20000
    s_mov_b32 s12, s66
    s_and_b32 s13, s67, 0xffff
    s_mov_b32 s14, 0x180000
    s_mov_b32 s15, 0x20000
    s_lshl_b32 s51, s50, 7
    s_add_u32 m0, s52, 0
    s_add_u32 s51, s51, s48
    buffer_load_dwordx4 v5, s[8:11], s51 offen lds
    s_add_u32 m0, s52, 1024
    s_mul_i32 s49, s50, 196608
    buffer_load_dwordx4 v6, s[8:11], s51 offen lds
    s_add_u32 m0, s56, 65536
    s_add_u32 s49, s49, s57
    buffer_load_dwordx4 v7, s[12:15], s49 offen lds
    s_mul_i32 s51, s50, s53
    s_mov_b32 s24, s72
    s_and_b32 s25, s73, 0xffff
    s_mov_b32 s26, 0x1c0000
    s_mov_b32 s27, 0x20000
    s_mov_b32 s28, s74
    s_and_b32 s29, s75, 0xffff
    s_mov_b32 s30, 0x1c0000
    s_mov_b32 s31, 0x20000
    s_cmp_ge_u32 s46, 12
    s_cselect_b32 s16, s12, s24
    s_cselect_b32 s17, s13, s25
    s_cselect_b32 s18, s14, s26
    s_mov_b32 s19, 0x20000
    s_cselect_b32 s20, s12, s28
    s_cselect_b32 s21, s13, s29
    s_cselect_b32 s22, s14, s30
    s_mov_b32 s23, 0x20000
    s_add_u32 m0, s56, 98304
    s_add_u32 s49, s51, s58
    buffer_load_dwordx4 v8, s[16:19], s49 offen lds
    s_add_u32 m0, s56, 131072
    s_add_u32 s49, s51, s59
    buffer_load_dwordx4 v9, s[20:23], s49 offen lds
    s_add_u32 s50, s50, 1
    s_and_b32 s50, s50, 7
    buffer_load_dwordx4 v[56:59], v24, s[8:11], s4 offen
    s_lshl_b32 s51, s50, 7
    s_add_u32 m0, s52, 8192
    s_add_u32 s51, s51, s48
    buffer_load_dwordx4 v5, s[8:11], s51 offen lds
    s_add_u32 m0, s52, 9216
    s_mul_i32 s49, s50, 196608
    buffer_load_dwordx4 v6, s[8:11], s51 offen lds
    s_add_u32 m0, s56, 73728
    s_add_u32 s49, s49, s57
    buffer_load_dwordx4 v7, s[12:15], s49 offen lds
    s_mul_i32 s51, s50, s53
    s_add_u32 m0, s56, 106496
    s_add_u32 s49, s51, s58
    buffer_load_dwordx4 v8, s[16:19], s49 offen lds
    s_add_u32 m0, s56, 139264
    s_add_u32 s49, s51, s59
    buffer_load_dwordx4 v9, s[20:23], s49 offen lds
    s_add_u32 s50, s50, 1
    s_and_b32 s50, s50, 7
    s_mov_b32 s36, s80
    s_and_b32 s37, s81, 0xffff
    s_mov_b32 s38, 0x100
    s_mov_b32 s39, 0x20000
    s_or_b32 s6, s62, 1
    v_mov_b32 v21, s6
    v_mov_b32 v22, 0
    s_mov_b64 exec, 1
    buffer_store_dword v21, v22, s[36:39], s5 offen sc1
    s_mov_b64 exec, -1
    s_getpc_b64 s[6:7]
L_PC:
    s_lshr_b32 s3, s2, 3
    s_lshl_b32 s3, s3, 13
    v_lshl_add_u32 v26, v0, 7, s3
    v_min_u32 v26, L_CODE_END - L_PC - 4, v26
    v_mov_b32 v27, s7
    v_add_co_u32 v26, vcc, s6, v26
    s_nop 1
    v_addc_co_u32 v27, vcc, 0, v27, vcc
    s_cmp_lt_u32 s3, L_CODE_END - L_PC
    s_cselect_b32 s3, 6, 99
    s_cmp_eq_u32 s42, s3
    s_cselect_b64 exec, -1, 1
    global_load_dword v251, v[26:27], off
    s_mov_b64 exec, -1
    s_and_b32 s62, s2, 7
    s_lshl_b32 s62, s62, 2
    s_bfe_u32 s3, s2, 0x20003
    s_add_u32 s62, s62, s3
    s_lshr_b32 s63, s2, 5
    s_lshl_b32 s47, s63, 3
    s_add_u32 s47, s47, s42
    s_lshl_b32 s61, s45, 2
    s_add_u32 s61, s61, s43
    s_and_b32 s3, s2, 3
    s_lshl_b32 s54, s63, 2
    s_add_u32 s54, s54, s3
    s_and_b32 s55, s62, 3
    s_lshl_b32 s55, s55, 1
    s_bfe_u32 s3, s2, 0x10002
    s_add_u32 s55, s55, s3
    s_mov_b32 s32, s82
    s_and_b32 s33, s83, 0xffff
    s_mov_b32 s34, 0x1800000
    s_mov_b32 s35, 0x20000
    s_cmp_eq_u32 s42, 7
    s_cselect_b32 s70, 0, 0x7fffff00
    s_lshl_b32 s3, s44, 1
    s_xor_b32 s41, s43, s3
    v_and_b32 v12, 31, v0
    v_lshrrev_b32 v13, 5, v0
    s_lshl_b32 s3, s41, 1
    v_add_u32 v14, s3, v13
    v_bfe_u32 v15, v12, 1, 3
    v_xor_b32 v14, v14, v15
    s_and_b32 s3, s43, 1
    s_lshl_b32 s3, s3, 12
    s_lshr_b32 s4, s43, 1
    s_lshl_b32 s4, s4, 15
    s_add_u32 s3, s3, s4
    v_lshlrev_b32 v15, 7, v12
    v_add_u32 v15, s3, v15
    v_lshl_add_u32 v64, v14, 4, v15
    v_xor_b32 v65, 32, v64
    v_xor_b32 v66, 64, v64
    v_xor_b32 v67, 96, v64
    v_bfe_u32 v14, v0, 2, 2
    v_lshl_add_u32 v14, v13, 3, v14
    v_lshlrev_b32 v14, 7, v14
    v_and_b32 v15, 3, v0
    v_lshl_add_u32 v14, v15, 3, v14
    s_lshl_b32 s3, s41, 11
    v_add_u32 v14, s3, v14
    v_bfe_u32 v15, v0, 3, 1
    v_lshlrev_b32 v15, 1, v15
    v_bfe_u32 v25, v0, 4, 1
    s_lshl_b32 s3, s44, 1
    v_add_u32 v26, s3, v25
    v_xor_b32 v26, v26, v15
    v_lshl_add_u32 v68, v26, 5, v14
    v_add_u32 v68, 65536, v68
    v_xor_b32 v24, v15, v25
    v_xor_b32 v24, s3, v24
    v_lshlrev_b32 v26, 15, v25
    v_add_u32 v26, v26, v14
    v_lshl_add_u32 v1, v24, 5, v26
    v_xor_b32 v2, 2048, v1
    v_xor_b32 v69, 2048, v68
    v_xor_b32 v3, 4096, v1
    v_xor_b32 v70, 4096, v68
    v_xor_b32 v4, 6144, v1
    v_xor_b32 v71, 6144, v68
    v_bfe_u32 v24, v0, 1, 3
    v_lshrrev_b32 v25, 5, v0
    v_lshl_add_u32 v27, v25, 3, v24
    v_lshlrev_b32 v25, 1, v25
    v_sub_u32 v24, v24, v25
    v_mov_b32 v26, 0x3f803f80
    v_cmp_eq_u32 vcc, 0, v24
    s_nop 1
    v_cndmask_b32 v16, 0, v26, vcc
    v_mov_b32 v17, v16
    v_cmp_eq_u32 vcc, 1, v24
    s_nop 1
    v_cndmask_b32 v18, 0, v26, vcc
    v_mov_b32 v19, v18
    v_cmp_eq_u32 vcc, 4, v27
    s_nop 1
    v_cndmask_b32 v48, 0, v26, vcc
    v_mov_b32 v49, v48
    v_cmp_eq_u32 vcc, 5, v27
    s_nop 1
    v_cndmask_b32 v50, 0, v26, vcc
    v_mov_b32 v51, v50
    v_and_b32 v24, 1, v0
    v_mul_u32_u24 v24, 0xaaaa, v24
    v_add_u32 v24, 0x4444, v24
    v_lshl_or_b32 v52, v24, 16, v24
    v_mov_b32 v12, 0
    v_mov_b32 v13, 0
    v_mov_b32 v14, 0
    v_mov_b32 v15, 0
    s_cmp_ge_u32 s46, 12
    s_cbranch_scc1 L_QK3
    s_cmp_ge_u32 s46, 8
    s_cbranch_scc1 L_QK1
    v_add_u32 v72, 98304, v1
    v_xor_b32 v76, 32, v72
    v_add_u32 v73, 98304, v2
    v_xor_b32 v77, 32, v73
    v_add_u32 v74, 98304, v3
    v_xor_b32 v78, 32, v74
    v_add_u32 v75, 98304, v4
    v_xor_b32 v79, 32, v75
    s_lshr_b32 s0, s57, 7
    s_and_b32 s1, s0, 7
    s_lshl_b32 s1, s1, 1
    s_add_u32 s1, s1, s44
    s_lshl_b32 s1, s1, 7
    s_add_u32 s1, s1, s61
    s_lshl_b32 s66, s1, 11
    s_add_u32 s66, s66, 2098176
    s_add_u32 s67, s66, 131072
    s_lshr_b32 s40, s58, 5
    s_lshl_b32 s71, s44, 1
    s_add_u32 s40, s40, s71
    s_mul_i32 s71, s61, 144
    s_add_u32 s40, s40, s71
    s_lshl_b32 s40, s40, 10
    s_add_u32 s40, s40, 6324224
    s_lshr_b32 s41, s60, 5
    s_lshl_b32 s71, s44, 1
    s_add_u32 s41, s41, s71
    s_mul_i32 s71, s61, 144
    s_add_u32 s41, s41, s71
    s_lshl_b32 s41, s41, 10
    s_add_u32 s41, s41, 6324224
    s_waitcnt vmcnt(8)
    s_barrier
    ds_read_b128 v[128:131], v64 offset:0
    ds_read_b64_tr_b16 v[24:25], v68 offset:0
    ds_read_b64_tr_b16 v[26:27], v68 offset:512
    ds_read_b64_tr_b16 v[28:29], v72 offset:0
    ds_read_b64_tr_b16 v[30:31], v72 offset:512
    ds_read_b64_tr_b16 v[32:33], v76 offset:0
    ds_read_b64_tr_b16 v[34:35], v76 offset:512
    s_waitcnt lgkmcnt(4)
    v_mfma_f32_32x32x16_bf16 v[80:95], v[128:131], v[24:27], 0
    ds_read_b128 v[132:135], v65 offset:0
    ds_read_b64_tr_b16 v[36:37], v69 offset:0
    ds_read_b64_tr_b16 v[38:39], v69 offset:512
    s_waitcnt lgkmcnt(5)
    v_mfma_f32_32x32x16_bf16 v[96:111], v[28:31], v[128:131], 0
    ds_read_b64_tr_b16 v[40:41], v73 offset:0
    ds_read_b64_tr_b16 v[42:43], v73 offset:512
    s_lshl_b32 s51, s50, 7
    s_add_u32 m0, s52, 16384
    s_add_u32 s51, s51, s48
    buffer_load_dwordx4 v5, s[8:11], s51 offen lds
    s_waitcnt lgkmcnt(5)
    v_mfma_f32_32x32x16_bf16 v[112:127], v[32:35], v[128:131], 0
    ds_read_b64_tr_b16 v[44:45], v77 offset:0
    ds_read_b64_tr_b16 v[46:47], v77 offset:512
    s_add_u32 m0, s52, 17408
    s_mul_i32 s49, s50, 196608
    buffer_load_dwordx4 v6, s[8:11], s51 offen lds
    v_smfmac_f32_16x16x64_bf16 v[12:15], v[16:19], v[24:31], v52
    s_waitcnt lgkmcnt(4)
    v_mfma_f32_32x32x16_bf16 v[80:95], v[132:135], v[36:39], v[80:95]
    ds_read_b128 v[136:139], v66 offset:0
    ds_read_b64_tr_b16 v[24:25], v70 offset:0
    ds_read_b64_tr_b16 v[26:27], v70 offset:512
    s_waitcnt vmcnt(9)
    v_lshlrev_b32 v60, 16, v56
    v_and_b32 v61, 0xffff0000, v56
    v_add_f32 v62, v60, v61
    v_mul_f32 v63, v60, v60
    s_waitcnt lgkmcnt(5)
    v_mfma_f32_32x32x16_bf16 v[96:111], v[40:43], v[132:135], v[96:111]
    ds_read_b64_tr_b16 v[28:29], v74 offset:0
    ds_read_b64_tr_b16 v[30:31], v74 offset:512
    s_add_u32 m0, s56, 81920
    s_add_u32 s49, s49, s57
    buffer_load_dwordx4 v7, s[12:15], s49 offen lds
    s_mul_i32 s51, s50, s53
    v_fmac_f32 v63, v61, v61
    v_lshlrev_b32 v60, 16, v57
    v_and_b32 v61, 0xffff0000, v57
    v_add_f32 v62, v62, v60
    s_waitcnt lgkmcnt(5)
    v_mfma_f32_32x32x16_bf16 v[112:127], v[44:47], v[132:135], v[112:127]
    ds_read_b64_tr_b16 v[32:33], v78 offset:0
    ds_read_b64_tr_b16 v[34:35], v78 offset:512
    s_add_u32 m0, s56, 114688
    s_add_u32 s49, s51, s58
    buffer_load_dwordx4 v8, s[16:19], s49 offen lds
    v_smfmac_f32_16x16x64_bf16 v[12:15], v[48:51], v[44:51], v52
    v_fmac_f32 v63, v60, v60
    v_add_f32 v62, v62, v61
    v_fmac_f32 v63, v61, v61
    v_lshlrev_b32 v60, 16, v58
    s_waitcnt lgkmcnt(4)
    v_mfma_f32_32x32x16_bf16 v[80:95], v[136:139], v[24:27], v[80:95]
    ds_read_b128 v[140:143], v67 offset:0
    ds_read_b64_tr_b16 v[36:37], v71 offset:0
    ds_read_b64_tr_b16 v[38:39], v71 offset:512
    v_and_b32 v61, 0xffff0000, v58
    v_add_f32 v62, v62, v60
    v_fmac_f32 v63, v60, v60
    v_add_f32 v62, v62, v61
    s_waitcnt lgkmcnt(5)
    v_mfma_f32_32x32x16_bf16 v[96:111], v[28:31], v[136:139], v[96:111]
    ds_read_b64_tr_b16 v[40:41], v75 offset:0
    ds_read_b64_tr_b16 v[42:43], v75 offset:512
    s_add_u32 m0, s56, 147456
    s_add_u32 s49, s51, s59
    buffer_load_dwordx4 v9, s[20:23], s49 offen lds
    s_add_u32 s50, s50, 1
    s_and_b32 s50, s50, 7
    v_fmac_f32 v63, v61, v61
    v_lshlrev_b32 v60, 16, v59
    v_and_b32 v61, 0xffff0000, v59
    v_add_f32 v62, v62, v60
    s_waitcnt lgkmcnt(5)
    v_mfma_f32_32x32x16_bf16 v[112:127], v[32:35], v[136:139], v[112:127]
    ds_read_b64_tr_b16 v[44:45], v79 offset:0
    ds_read_b64_tr_b16 v[46:47], v79 offset:512
    v_fmac_f32 v63, v60, v60
    v_add_f32 v62, v62, v61
    v_fmac_f32 v63, v61, v61
    s_nop 0
    v_add_f32_dpp v62, v62, v62 row_shr:1 bound_ctrl:0
    s_waitcnt vmcnt(7)
    s_waitcnt lgkmcnt(4)
    v_mfma_f32_32x32x16_bf16 v[80:95], v[140:143], v[36:39], v[80:95]
    s_barrier
    ds_read_b128 v[144:147], v64 offset:8192
    ds_read_b64_tr_b16 v[24:25], v68 offset:8192
    ds_read_b64_tr_b16 v[26:27], v68 offset:8704
    v_add_f32_dpp v63, v63, v63 row_shr:1 bound_ctrl:0
    v_add_f32_dpp v62, v62, v62 row_shr:2 bound_ctrl:0
    s_nop 0
    v_add_f32_dpp v63, v63, v63 row_shr:2 bound_ctrl:0
    v_add_f32_dpp v62, v62, v62 row_shr:4 bound_ctrl:0
    s_waitcnt lgkmcnt(5)
    v_mfma_f32_32x32x16_bf16 v[96:111], v[40:43], v[140:143], v[96:111]
    ds_read_b64_tr_b16 v[28:29], v72 offset:8192
    ds_read_b64_tr_b16 v[30:31], v72 offset:8704
    s_lshl_b32 s51, s50, 7
    s_add_u32 m0, s52, 24576
    s_add_u32 s51, s51, s48
    buffer_load_dwordx4 v5, s[8:11], s51 offen lds
    v_add_f32_dpp v63, v63, v63 row_shr:4 bound_ctrl:0
    v_add_f32_dpp v62, v62, v62 row_shr:8 bound_ctrl:0
    s_nop 0
    v_add_f32_dpp v63, v63, v63 row_shr:8 bound_ctrl:0
    v_add_f32_dpp v62, v62, v62 row_bcast:15 row_mask:0xa
    s_waitcnt lgkmcnt(5)
    v_mfma_f32_32x32x16_bf16 v[112:127], v[44:47], v[140:143], v[112:127]
    ds_read_b64_tr_b16 v[32:33], v76 offset:8192
    ds_read_b64_tr_b16 v[34:35], v76 offset:8704
    s_add_u32 m0, s52, 25600
    s_mul_i32 s49, s50, 196608
    buffer_load_dwordx4 v6, s[8:11], s51 offen lds
    v_add_f32_dpp v63, v63, v63 row_bcast:15 row_mask:0xa
    v_add_f32_dpp v62, v62, v62 row_bcast:31 row_mask:0xc
    s_nop 0
    v_add_f32_dpp v63, v63, v63 row_bcast:31 row_mask:0xc
    v_mul_f32 v62, 0x3b000000, v62
    s_waitcnt lgkmcnt(4)
    v_mfma_f32_32x32x16_bf16 v[80:95], v[144:147], v[24:27], v[80:95]
    ds_read_b128 v[148:151], v65 offset:8192
    ds_read_b64_tr_b16 v[36:37], v69 offset:8192
    ds_read_b64_tr_b16 v[38:39], v69 offset:8704
    v_mul_f32 v63, 0x3b000000, v63
    v_cvt_pk_bf16_f32 v56, -v62, -v62
    v_fma_f32 v63, -v62, v62, v63
    v_max_f32 v63, 0, v63
    s_waitcnt lgkmcnt(5)
    v_mfma_f32_32x32x16_bf16 v[96:111], v[28:31], v[144:147], v[96:111]
    ds_read_b64_tr_b16 v[40:41], v73 offset:8192
    ds_read_b64_tr_b16 v[42:43], v73 offset:8704
    s_add_u32 m0, s56, 90112
    s_add_u32 s49, s49, s57
    buffer_load_dwordx4 v7, s[12:15], s49 offen lds
    s_mul_i32 s51, s50, s53
    v_cvt_pk_bf16_f32 v60, v63, v63
    v_and_b32 v60, 0xffff0000, v60
    v_add_f32 v60, 0x3727c5ac, v60
    v_cvt_pk_bf16_f32 v60, v60, v60
    s_waitcnt lgkmcnt(5)
    v_mfma_f32_32x32x16_bf16 v[112:127], v[32:35], v[144:147], v[112:127]
    ds_read_b64_tr_b16 v[44:45], v77 offset:8192
    ds_read_b64_tr_b16 v[46:47], v77 offset:8704
    v_smfmac_f32_16x16x64_bf16 v[12:15], v[16:19], v[24:31], v52
    v_and_b32 v60, 0xffff0000, v60
    v_sqrt_f32 v60, v60
    s_nop 0
    v_cvt_pk_bf16_f32 v60, v60, v60
    v_and_b32 v60, 0xffff0000, v60
    s_waitcnt lgkmcnt(4)
    v_mfma_f32_32x32x16_bf16 v[80:95], v[148:151], v[36:39], v[80:95]
    ds_read_b128 v[152:155], v66 offset:8192
    ds_read_b64_tr_b16 v[24:25], v70 offset:8192
    ds_read_b64_tr_b16 v[26:27], v70 offset:8704
    v_rcp_f32 v57, v60
    v_mul_f32 v58, v60, v60
    s_waitcnt lgkmcnt(5)
    v_mfma_f32_32x32x16_bf16 v[96:111], v[40:43], v[148:151], v[96:111]
    ds_read_b64_tr_b16 v[28:29], v74 offset:8192
    ds_read_b64_tr_b16 v[30:31], v74 offset:8704
    s_add_u32 m0, s56, 122880
    s_add_u32 s49, s51, s58
    buffer_load_dwordx4 v8, s[16:19], s49 offen lds
    s_waitcnt lgkmcnt(5)
    v_mfma_f32_32x32x16_bf16 v[112:127], v[44:47], v[148:151], v[112:127]
    ds_read_b64_tr_b16 v[32:33], v78 offset:8192
    ds_read_b64_tr_b16 v[34:35], v78 offset:8704
    v_smfmac_f32_16x16x64_bf16 v[12:15], v[48:51], v[44:51], v52
    s_waitcnt lgkmcnt(4)
    v_mfma_f32_32x32x16_bf16 v[80:95], v[152:155], v[24:27], v[80:95]
    ds_read_b128 v[156:159], v67 offset:8192
    ds_read_b64_tr_b16 v[36:37], v71 offset:8192
    ds_read_b64_tr_b16 v[38:39], v71 offset:8704
    s_waitcnt lgkmcnt(5)
    v_mfma_f32_32x32x16_bf16 v[96:111], v[28:31], v[152:155], v[96:111]
    ds_read_b64_tr_b16 v[40:41], v75 offset:8192
    ds_read_b64_tr_b16 v[42:43], v75 offset:8704
    s_add_u32 m0, s56, 155648
    s_add_u32 s49, s51, s59
    buffer_load_dwordx4 v9, s[20:23], s49 offen lds
    s_add_u32 s50, s50, 1
    s_and_b32 s50, s50, 7
    s_waitcnt lgkmcnt(5)
    v_mfma_f32_32x32x16_bf16 v[112:127], v[32:35], v[152:155], v[112:127]
    ds_read_b64_tr_b16 v[44:45], v79 offset:8192
    ds_read_b64_tr_b16 v[46:47], v79 offset:8704
    buffer_load_dword v23, v22, s[36:39], 0 offen sc1
    s_waitcnt vmcnt(6)
    s_waitcnt lgkmcnt(4)
    v_mfma_f32_32x32x16_bf16 v[80:95], v[156:159], v[36:39], v[80:95]
    s_barrier
    ds_read_b128 v[160:163], v64 offset:16384
    ds_read_b64_tr_b16 v[24:25], v68 offset:16384
    ds_read_b64_tr_b16 v[26:27], v68 offset:16896
    s_waitcnt lgkmcnt(5)
    v_mfma_f32_32x32x16_bf16 v[96:111], v[40:43], v[156:159], v[96:111]
    ds_read_b64_tr_b16 v[28:29], v72 offset:16384
    ds_read_b64_tr_b16 v[30:31], v72 offset:16896
    s_lshl_b32 s51, s50, 7
    s_add_u32 m0, s52, 0
    s_add_u32 s51, s51, s48
    buffer_load_dwordx4 v5, s[8:11], s51 offen lds
    s_waitcnt lgkmcnt(5)
    v_mfma_f32_32x32x16_bf16 v[112:127], v[44:47], v[156:159], v[112:127]
    ds_read_b64_tr_b16 v[32:33], v76 offset:16384
    ds_read_b64_tr_b16 v[34:35], v76 offset:16896
    s_add_u32 m0, s52, 1024
    s_mul_i32 s49, s50, 196608
    buffer_load_dwordx4 v6, s[8:11], s51 offen lds
    s_waitcnt lgkmcnt(4)
    v_mfma_f32_32x32x16_bf16 v[80:95], v[160:163], v[24:27], v[80:95]
    ds_read_b128 v[164:167], v65 offset:16384
    ds_read_b64_tr_b16 v[36:37], v69 offset:16384
    ds_read_b64_tr_b16 v[38:39], v69 offset:16896
    s_waitcnt lgkmcnt(5)
    v_mfma_f32_32x32x16_bf16 v[96:111], v[28:31], v[160:163], v[96:111]
    ds_read_b64_tr_b16 v[40:41], v73 offset:16384
    ds_read_b64_tr_b16 v[42:43], v73 offset:16896
    s_add_u32 m0, s56, 65536
    s_add_u32 s49, s49, s57
    buffer_load_dwordx4 v7, s[12:15], s49 offen lds
    s_mul_i32 s51, s50, s53
    s_waitcnt lgkmcnt(5)
    v_mfma_f32_32x32x16_bf16 v[112:127], v[32:35], v[160:163], v[112:127]
    ds_read_b64_tr_b16 v[44:45], v77 offset:16384
    ds_read_b64_tr_b16 v[46:47], v77 offset:16896
    v_smfmac_f32_16x16x64_bf16 v[12:15], v[16:19], v[24:31], v52
    s_waitcnt lgkmcnt(4)
    v_mfma_f32_32x32x16_bf16 v[80:95], v[164:167], v[36:39], v[80:95]
    ds_read_b128 v[168:171], v66 offset:16384
    ds_read_b64_tr_b16 v[24:25], v70 offset:16384
    ds_read_b64_tr_b16 v[26:27], v70 offset:16896
    s_waitcnt lgkmcnt(5)
    v_mfma_f32_32x32x16_bf16 v[96:111], v[40:43], v[164:167], v[96:111]
    ds_read_b64_tr_b16 v[28:29], v74 offset:16384
    ds_read_b64_tr_b16 v[30:31], v74 offset:16896
    s_add_u32 m0, s56, 98304
    s_add_u32 s49, s51, s58
    buffer_load_dwordx4 v8, s[16:19], s49 offen lds
    s_waitcnt lgkmcnt(5)
    v_mfma_f32_32x32x16_bf16 v[112:127], v[44:47], v[164:167], v[112:127]
    ds_read_b64_tr_b16 v[32:33], v78 offset:16384
    ds_read_b64_tr_b16 v[34:35], v78 offset:16896
    v_smfmac_f32_16x16x64_bf16 v[12:15], v[48:51], v[44:51], v52
    s_waitcnt lgkmcnt(4)
    v_mfma_f32_32x32x16_bf16 v[80:95], v[168:171], v[24:27], v[80:95]
    ds_read_b128 v[172:175], v67 offset:16384
    ds_read_b64_tr_b16 v[36:37], v71 offset:16384
    ds_read_b64_tr_b16 v[38:39], v71 offset:16896
    s_waitcnt lgkmcnt(5)
    v_mfma_f32_32x32x16_bf16 v[96:111], v[28:31], v[168:171], v[96:111]
    ds_read_b64_tr_b16 v[40:41], v75 offset:16384
    ds_read_b64_tr_b16 v[42:43], v75 offset:16896
    s_add_u32 m0, s56, 131072
    s_add_u32 s49, s51, s59
    buffer_load_dwordx4 v9, s[20:23], s49 offen lds
    s_add_u32 s50, s50, 1
    s_and_b32 s50, s50, 7
    s_waitcnt lgkmcnt(5)
    v_mfma_f32_32x32x16_bf16 v[112:127], v[32:35], v[168:171], v[112:127]
    ds_read_b64_tr_b16 v[44:45], v79 offset:16384
    ds_read_b64_tr_b16 v[46:47], v79 offset:16896
    s_waitcnt vmcnt(5)
    v_cmp_eq_u32 vcc, 0, v23
    s_nop 1
    s_cbranch_vccz L_BACK_tag_V1
    s_mov_b32 s3, 20000
L_SPIN_tag_V1:
    s_sleep 1
    buffer_load_dword v23, v22, s[36:39], 0 offen sc1
    s_waitcnt vmcnt(0)
    v_cmp_eq_u32 vcc, 0, v23
    s_nop 0
    s_sub_u32 s3, s3, 1
    s_cbranch_vccz L_BACK_tag_V1
    s_cmp_lg_u32 s3, 0
    s_cbranch_scc1 L_SPIN_tag_V1
L_BACK_tag_V1:
    v_readfirstlane_b32 s64, v23
    v_mov_b32 v59, v23
    v_readlane_b32 s3, v56, 63
    v_readlane_b32 s4, v57, 63
    v_readlane_b32 s5, v58, 63
    v_lshlrev_b32 v61, 4, v0
    v_mov_b32 v56, s3
    v_mov_b32 v57, s4
    v_mov_b32 v58, s5
    s_lshl_b32 s3, s2, 10
    s_lshl_b32 s4, s42, 7
    s_add_u32 s3, s3, s4
    s_add_u32 s3, s3, 23134208
    s_mov_b64 exec, 0xff
    buffer_store_dwordx4 v[56:59], v61, s[32:35], s3 offen sc1
    s_mov_b64 exec, -1
    s_waitcnt vmcnt(6)
    s_waitcnt lgkmcnt(4)
    v_mfma_f32_32x32x16_bf16 v[80:95], v[172:175], v[36:39], v[80:95]
    s_barrier
    ds_read_b128 v[176:179], v64 offset:24576
    ds_read_b64_tr_b16 v[24:25], v68 offset:24576
    ds_read_b64_tr_b16 v[26:27], v68 offset:25088
    s_waitcnt lgkmcnt(5)
    v_mfma_f32_32x32x16_bf16 v[96:111], v[40:43], v[172:175], v[96:111]
    ds_read_b64_tr_b16 v[28:29], v72 offset:24576
    ds_read_b64_tr_b16 v[30:31], v72 offset:25088
    s_lshl_b32 s51, s50, 7
    s_add_u32 m0, s52, 8192
    s_add_u32 s51, s51, s48
    buffer_load_dwordx4 v5, s[8:11], s51 offen lds
    s_waitcnt lgkmcnt(5)
    v_mfma_f32_32x32x16_bf16 v[112:127], v[44:47], v[172:175], v[112:127]
    ds_read_b64_tr_b16 v[32:33], v76 offset:24576
    ds_read_b64_tr_b16 v[34:35], v76 offset:25088
    s_add_u32 m0, s52, 9216
    s_mul_i32 s49, s50, 196608
    buffer_load_dwordx4 v6, s[8:11], s51 offen lds
    s_waitcnt lgkmcnt(4)
    v_mfma_f32_32x32x16_bf16 v[80:95], v[176:179], v[24:27], v[80:95]
    ds_read_b128 v[180:183], v65 offset:24576
    ds_read_b64_tr_b16 v[36:37], v69 offset:24576
    ds_read_b64_tr_b16 v[38:39], v69 offset:25088
    s_waitcnt lgkmcnt(5)
    v_mfma_f32_32x32x16_bf16 v[96:111], v[28:31], v[176:179], v[96:111]
    ds_read_b64_tr_b16 v[40:41], v73 offset:24576
    ds_read_b64_tr_b16 v[42:43], v73 offset:25088
    s_add_u32 m0, s56, 73728
    s_add_u32 s49, s49, s57
    buffer_load_dwordx4 v7, s[12:15], s49 offen lds
    s_mul_i32 s51, s50, s53
    s_waitcnt lgkmcnt(5)
    v_mfma_f32_32x32x16_bf16 v[112:127], v[32:35], v[176:179], v[112:127]
    ds_read_b64_tr_b16 v[44:45], v77 offset:24576
    ds_read_b64_tr_b16 v[46:47], v77 offset:25088
    v_smfmac_f32_16x16x64_bf16 v[12:15], v[16:19], v[24:31], v52
    s_waitcnt lgkmcnt(4)
    v_mfma_f32_32x32x16_bf16 v[80:95], v[180:183], v[36:39], v[80:95]
    ds_read_b128 v[184:187], v66 offset:24576
    ds_read_b64_tr_b16 v[24:25], v70 offset:24576
    ds_read_b64_tr_b16 v[26:27], v70 offset:25088
    s_waitcnt lgkmcnt(5)
    v_mfma_f32_32x32x16_bf16 v[96:111], v[40:43], v[180:183], v[96:111]
    ds_read_b64_tr_b16 v[28:29], v74 offset:24576
    ds_read_b64_tr_b16 v[30:31], v74 offset:25088
    s_add_u32 m0, s56, 106496
    s_add_u32 s49, s51, s58
    buffer_load_dwordx4 v8, s[16:19], s49 offen lds
    s_waitcnt lgkmcnt(5)
    v_mfma_f32_32x32x16_bf16 v[112:127], v[44:47], v[180:183], v[112:127]
    ds_read_b64_tr_b16 v[32:33], v78 offset:24576
    ds_read_b64_tr_b16 v[34:35], v78 offset:25088
    v_smfmac_f32_16x16x64_bf16 v[12:15], v[48:51], v[44:51], v52
    s_waitcnt lgkmcnt(4)
    v_mfma_f32_32x32x16_bf16 v[80:95], v[184:187], v[24:27], v[80:95]
    ds_read_b128 v[188:191], v67 offset:24576
    ds_read_b64_tr_b16 v[36:37], v71 offset:24576
    ds_read_b64_tr_b16 v[38:39], v71 offset:25088
    s_waitcnt lgkmcnt(5)
    v_mfma_f32_32x32x16_bf16 v[96:111], v[28:31], v[184:187], v[96:111]
    ds_read_b64_tr_b16 v[40:41], v75 offset:24576
    ds_read_b64_tr_b16 v[42:43], v75 offset:25088
    s_add_u32 m0, s56, 139264
    s_add_u32 s49, s51, s59
    buffer_load_dwordx4 v9, s[20:23], s49 offen lds
    s_add_u32 s50, s50, 1
    s_and_b32 s50, s50, 7
    s_waitcnt lgkmcnt(5)
    v_mfma_f32_32x32x16_bf16 v[112:127], v[32:35], v[184:187], v[112:127]
    ds_read_b64_tr_b16 v[44:45], v79 offset:24576
    ds_read_b64_tr_b16 v[46:47], v79 offset:25088
    s_and_b32 s3, s45, 7
    s_lshl_b32 s3, s3, 3
    s_add_u32 s3, s3, s42
    s_lshl_b32 s3, s3, 3
    v_add_u32 v20, s3, v0
    v_mul_u32_u24 v20, 3584, v20
    s_mov_b64 exec, 0xff
    buffer_load_dword v252, v20, s[24:27], s60 offen
    buffer_load_dword v253, v20, s[28:31], s60 offen
    s_mov_b64 exec, -1
    s_waitcnt vmcnt(8)
    s_waitcnt lgkmcnt(4)
    v_mfma_f32_32x32x16_bf16 v[80:95], v[188:191], v[36:39], v[80:95]
    s_barrier
    ds_read_b128 v[192:195], v64 offset:0
    ds_read_b64_tr_b16 v[24:25], v68 offset:0
    ds_read_b64_tr_b16 v[26:27], v68 offset:512
    s_waitcnt lgkmcnt(5)
    v_mfma_f32_32x32x16_bf16 v[96:111], v[40:43], v[188:191], v[96:111]
    ds_read_b64_tr_b16 v[28:29], v72 offset:0
    ds_read_b64_tr_b16 v[30:31], v72 offset:512
    s_lshl_b32 s51, s50, 7
    s_add_u32 m0, s52, 16384
    s_add_u32 s51, s51, s48
    buffer_load_dwordx4 v5, s[8:11], s51 offen lds
    s_waitcnt lgkmcnt(5)
    v_mfma_f32_32x32x16_bf16 v[112:127], v[44:47], v[188:191], v[112:127]
    ds_read_b64_tr_b16 v[32:33], v76 offset:0
    ds_read_b64_tr_b16 v[34:35], v76 offset:512
    s_add_u32 m0, s52, 17408
    s_mul_i32 s49, s50, 196608
    buffer_load_dwordx4 v6, s[8:11], s51 offen lds
    s_waitcnt lgkmcnt(4)
    v_mfma_f32_32x32x16_bf16 v[80:95], v[192:195], v[24:27], v[80:95]
    ds_read_b128 v[196:199], v65 offset:0
    ds_read_b64_tr_b16 v[36:37], v69 offset:0
    ds_read_b64_tr_b16 v[38:39], v69 offset:512
    s_waitcnt lgkmcnt(5)
    v_mfma_f32_32x32x16_bf16 v[96:111], v[28:31], v[192:195], v[96:111]
    ds_read_b64_tr_b16 v[40:41], v73 offset:0
    ds_read_b64_tr_b16 v[42:43], v73 offset:512
    s_add_u32 m0, s56, 81920
    s_add_u32 s49, s49, s57
    buffer_load_dwordx4 v7, s[12:15], s49 offen lds
    s_mul_i32 s51, s50, s53
    s_waitcnt lgkmcnt(5)
    v_mfma_f32_32x32x16_bf16 v[112:127], v[32:35], v[192:195], v[112:127]
    ds_read_b64_tr_b16 v[44:45], v77 offset:0
    ds_read_b64_tr_b16 v[46:47], v77 offset:512
    v_smfmac_f32_16x16x64_bf16 v[12:15], v[16:19], v[24:31], v52
    s_waitcnt lgkmcnt(4)
    v_mfma_f32_32x32x16_bf16 v[80:95], v[196:199], v[36:39], v[80:95]
    ds_read_b128 v[200:203], v66 offset:0
    ds_read_b64_tr_b16 v[24:25], v70 offset:0
    ds_read_b64_tr_b16 v[26:27], v70 offset:512
    s_waitcnt lgkmcnt(5)
    v_mfma_f32_32x32x16_bf16 v[96:111], v[40:43], v[196:199], v[96:111]
    ds_read_b64_tr_b16 v[28:29], v74 offset:0
    ds_read_b64_tr_b16 v[30:31], v74 offset:512
    s_add_u32 m0, s56, 114688
    s_add_u32 s49, s51, s58
    buffer_load_dwordx4 v8, s[16:19], s49 offen lds
    s_waitcnt lgkmcnt(5)
    v_mfma_f32_32x32x16_bf16 v[112:127], v[44:47], v[196:199], v[112:127]
    ds_read_b64_tr_b16 v[32:33], v78 offset:0
    ds_read_b64_tr_b16 v[34:35], v78 offset:512
    v_smfmac_f32_16x16x64_bf16 v[12:15], v[48:51], v[44:51], v52
    s_waitcnt lgkmcnt(4)
    v_mfma_f32_32x32x16_bf16 v[80:95], v[200:203], v[24:27], v[80:95]
    ds_read_b128 v[204:207], v67 offset:0
    ds_read_b64_tr_b16 v[36:37], v71 offset:0
    ds_read_b64_tr_b16 v[38:39], v71 offset:512
    s_waitcnt lgkmcnt(5)
    v_mfma_f32_32x32x16_bf16 v[96:111], v[28:31], v[200:203], v[96:111]
    ds_read_b64_tr_b16 v[40:41], v75 offset:0
    ds_read_b64_tr_b16 v[42:43], v75 offset:512
    s_add_u32 m0, s56, 147456
    s_add_u32 s49, s51, s59
    buffer_load_dwordx4 v9, s[20:23], s49 offen lds
    s_add_u32 s50, s50, 1
    s_and_b32 s50, s50, 7
    s_waitcnt lgkmcnt(5)
    v_mfma_f32_32x32x16_bf16 v[112:127], v[32:35], v[200:203], v[112:127]
    ds_read_b64_tr_b16 v[44:45], v79 offset:0
    ds_read_b64_tr_b16 v[46:47], v79 offset:512
    s_waitcnt vmcnt(7)
    s_waitcnt lgkmcnt(4)
    v_mfma_f32_32x32x16_bf16 v[80:95], v[204:207], v[36:39], v[80:95]
    s_barrier
    ds_read_b128 v[208:211], v64 offset:8192
    ds_read_b64_tr_b16 v[24:25], v68 offset:8192
    ds_read_b64_tr_b16 v[26:27], v68 offset:8704
    s_waitcnt lgkmcnt(5)
    v_mfma_f32_32x32x16_bf16 v[96:111], v[40:43], v[204:207], v[96:111]
    ds_read_b64_tr_b16 v[28:29], v72 offset:8192
    ds_read_b64_tr_b16 v[30:31], v72 offset:8704
    s_lshl_b32 s51, s50, 7
    s_add_u32 m0, s52, 24576
    s_add_u32 s51, s51, s48
    buffer_load_dwordx4 v5, s[8:11], s51 offen lds
    s_waitcnt lgkmcnt(5)
    v_mfma_f32_32x32x16_bf16 v[112:127], v[44:47], v[204:207], v[112:127]
    ds_read_b64_tr_b16 v[32:33], v76 offset:8192
    ds_read_b64_tr_b16 v[34:35], v76 offset:8704
    s_add_u32 m0, s52, 25600
    s_mul_i32 s49, s50, 196608
    buffer_load_dwordx4 v6, s[8:11], s51 offen lds
    s_waitcnt lgkmcnt(4)
    v_mfma_f32_32x32x16_bf16 v[80:95], v[208:211], v[24:27], v[80:95]
    ds_read_b128 v[212:215], v65 offset:8192
    ds_read_b64_tr_b16 v[36:37], v69 offset:8192
    ds_read_b64_tr_b16 v[38:39], v69 offset:8704
    s_waitcnt lgkmcnt(5)
    v_mfma_f32_32x32x16_bf16 v[96:111], v[28:31], v[208:211], v[96:111]
    ds_read_b64_tr_b16 v[40:41], v73 offset:8192
    ds_read_b64_tr_b16 v[42:43], v73 offset:8704
    s_add_u32 m0, s56, 90112
    s_add_u32 s49, s49, s57
    buffer_load_dwordx4 v7, s[12:15], s49 offen lds
    s_mul_i32 s51, s50, s53
    s_waitcnt lgkmcnt(5)
    v_mfma_f32_32x32x16_bf16 v[112:127], v[32:35], v[208:211], v[112:127]
    ds_read_b64_tr_b16 v[44:45], v77 offset:8192
    ds_read_b64_tr_b16 v[46:47], v77 offset:8704
    v_smfmac_f32_16x16x64_bf16 v[12:15], v[16:19], v[24:31], v52
    s_waitcnt lgkmcnt(4)
    v_mfma_f32_32x32x16_bf16 v[80:95], v[212:215], v[36:39], v[80:95]
    ds_read_b128 v[216:219], v66 offset:8192
    ds_read_b64_tr_b16 v[24:25], v70 offset:8192
    ds_read_b64_tr_b16 v[26:27], v70 offset:8704
    s_waitcnt lgkmcnt(5)
    v_mfma_f32_32x32x16_bf16 v[96:111], v[40:43], v[212:215], v[96:111]
    ds_read_b64_tr_b16 v[28:29], v74 offset:8192
    ds_read_b64_tr_b16 v[30:31], v74 offset:8704
    s_add_u32 m0, s56, 122880
    s_add_u32 s49, s51, s58
    buffer_load_dwordx4 v8, s[16:19], s49 offen lds
    s_waitcnt lgkmcnt(5)
    v_mfma_f32_32x32x16_bf16 v[112:127], v[44:47], v[212:215], v[112:127]
    ds_read_b64_tr_b16 v[32:33], v78 offset:8192
    ds_read_b64_tr_b16 v[34:35], v78 offset:8704
    v_smfmac_f32_16x16x64_bf16 v[12:15], v[48:51], v[44:51], v52
    v_and_b32 v61, 15, v0
    v_lshlrev_b32 v61, 4, v61
    v_lshrrev_b32 v62, 4, v0
    v_lshl_add_u32 v61, v62, 9, v61
    s_mul_i32 s71, s44, 1536
    s_lshl_b32 s0, s43, 2
    s_add_u32 s71, s71, s0
    s_add_u32 s71, s71, 133120
    v_add_u32 v61, s71, v61
    s_waitcnt lgkmcnt(4)
    v_mfma_f32_32x32x16_bf16 v[80:95], v[216:219], v[24:27], v[80:95]
    ds_read_b128 v[220:223], v67 offset:8192
    ds_read_b64_tr_b16 v[36:37], v71 offset:8192
    ds_read_b64_tr_b16 v[38:39], v71 offset:8704
    s_waitcnt lgkmcnt(5)
    v_mfma_f32_32x32x16_bf16 v[96:111], v[28:31], v[216:219], v[96:111]
    ds_read_b64_tr_b16 v[40:41], v75 offset:8192
    ds_read_b64_tr_b16 v[42:43], v75 offset:8704
    s_add_u32 m0, s56, 155648
    s_add_u32 s49, s51, s59
    buffer_load_dwordx4 v9, s[20:23], s49 offen lds
    s_add_u32 s50, s50, 1
    s_and_b32 s50, s50, 7
    s_waitcnt lgkmcnt(5)
    v_mfma_f32_32x32x16_bf16 v[112:127], v[32:35], v[216:219], v[112:127]
    ds_read_b64_tr_b16 v[44:45], v79 offset:8192
    ds_read_b64_tr_b16 v[46:47], v79 offset:8704
    s_waitcnt vmcnt(5)
    s_waitcnt lgkmcnt(4)
    v_mfma_f32_32x32x16_bf16 v[80:95], v[220:223], v[36:39], v[80:95]
    s_barrier
    ds_read_b128 v[224:227], v64 offset:16384
    ds_read_b64_tr_b16 v[24:25], v68 offset:16384
    ds_read_b64_tr_b16 v[26:27], v68 offset:16896
    s_waitcnt lgkmcnt(5)
    v_mfma_f32_32x32x16_bf16 v[96:111], v[40:43], v[220:223], v[96:111]
    ds_read_b64_tr_b16 v[28:29], v72 offset:16384
    ds_read_b64_tr_b16 v[30:31], v72 offset:16896
    s_mul_i32 s49, s50, 229376
    s_add_u32 m0, s56, 0
    s_add_u32 s49, s49, s60
    buffer_load_dwordx4 v10, s[24:27], s49 offen lds
    s_waitcnt lgkmcnt(5)
    v_mfma_f32_32x32x16_bf16 v[112:127], v[44:47], v[220:223], v[112:127]
    ds_read_b64_tr_b16 v[32:33], v76 offset:16384
    ds_read_b64_tr_b16 v[34:35], v76 offset:16896
    v_and_b32 v62, 31, v0
    s_mul_i32 s3, s44, 1536
    s_add_u32 s3, s3, 133120
    v_lshl_add_u32 v9, v62, 4, s3
    s_lshl_b32 s3, s61, 12
    s_add_u32 s3, s3, 23134208
    v_lshl_add_u32 v60, v62, 7, s3
    buffer_load_dwordx4 v[56:59], v60, s[32:35], 0 offen sc1
    s_waitcnt lgkmcnt(4)
    v_mfma_f32_32x32x16_bf16 v[80:95], v[224:227], v[24:27], v[80:95]
    ds_read_b128 v[228:231], v65 offset:16384
    ds_read_b64_tr_b16 v[36:37], v69 offset:16384
    ds_read_b64_tr_b16 v[38:39], v69 offset:16896
    s_waitcnt lgkmcnt(5)
    v_mfma_f32_32x32x16_bf16 v[96:111], v[28:31], v[224:227], v[96:111]
    ds_read_b64_tr_b16 v[40:41], v73 offset:16384
    ds_read_b64_tr_b16 v[42:43], v73 offset:16896
    s_add_u32 m0, s56, 32768
    s_add_u32 s50, s50, 1
    buffer_load_dwordx4 v11, s[28:31], s49 offen lds
    s_and_b32 s50, s50, 7
    s_waitcnt lgkmcnt(5)
    v_mfma_f32_32x32x16_bf16 v[112:127], v[32:35], v[224:227], v[112:127]
    ds_read_b64_tr_b16 v[44:45], v77 offset:16384
    ds_read_b64_tr_b16 v[46:47], v77 offset:16896
    v_smfmac_f32_16x16x64_bf16 v[12:15], v[16:19], v[24:31], v52
    s_waitcnt lgkmcnt(4)
    v_mfma_f32_32x32x16_bf16 v[80:95], v[228:231], v[36:39], v[80:95]
    ds_read_b128 v[232:235], v66 offset:16384
    ds_read_b64_tr_b16 v[24:25], v70 offset:16384
    ds_read_b64_tr_b16 v[26:27], v70 offset:16896
    s_waitcnt lgkmcnt(5)
    v_mfma_f32_32x32x16_bf16 v[96:111], v[40:43], v[228:231], v[96:111]
    ds_read_b64_tr_b16 v[28:29], v74 offset:16384
    ds_read_b64_tr_b16 v[30:31], v74 offset:16896
    s_mul_i32 s49, s50, 229376
    s_add_u32 m0, s56, 65536
    s_add_u32 s49, s49, s60
    buffer_load_dwordx4 v10, s[24:27], s49 offen lds
    s_waitcnt lgkmcnt(5)
    v_mfma_f32_32x32x16_bf16 v[112:127], v[44:47], v[228:231], v[112:127]
    ds_read_b64_tr_b16 v[32:33], v78 offset:16384
    ds_read_b64_tr_b16 v[34:35], v78 offset:16896
    v_smfmac_f32_16x16x64_bf16 v[12:15], v[48:51], v[44:51], v52
    s_waitcnt lgkmcnt(4)
    v_mfma_f32_32x32x16_bf16 v[80:95], v[232:235], v[24:27], v[80:95]
    ds_read_b128 v[236:239], v67 offset:16384
    ds_read_b64_tr_b16 v[36:37], v71 offset:16384
    ds_read_b64_tr_b16 v[38:39], v71 offset:16896
    s_waitcnt lgkmcnt(5)
    v_mfma_f32_32x32x16_bf16 v[96:111], v[28:31], v[232:235], v[96:111]
    ds_read_b64_tr_b16 v[40:41], v75 offset:16384
    ds_read_b64_tr_b16 v[42:43], v75 offset:16896
    s_add_u32 m0, s56, 98304
    s_add_u32 s50, s50, 1
    buffer_load_dwordx4 v11, s[28:31], s49 offen lds
    s_and_b32 s50, s50, 7
    s_waitcnt lgkmcnt(5)
    v_mfma_f32_32x32x16_bf16 v[112:127], v[32:35], v[232:235], v[112:127]
    ds_read_b64_tr_b16 v[44:45], v79 offset:16384
    ds_read_b64_tr_b16 v[46:47], v79 offset:16896
    s_waitcnt vmcnt(5)
    s_waitcnt lgkmcnt(4)
    v_mfma_f32_32x32x16_bf16 v[80:95], v[236:239], v[36:39], v[80:95]
    s_barrier
    ds_read_b128 v[240:243], v64 offset:24576
    ds_read_b64_tr_b16 v[24:25], v68 offset:24576
    ds_read_b64_tr_b16 v[26:27], v68 offset:25088
    s_waitcnt lgkmcnt(5)
    v_mfma_f32_32x32x16_bf16 v[96:111], v[40:43], v[236:239], v[96:111]
    ds_read_b64_tr_b16 v[28:29], v72 offset:24576
    ds_read_b64_tr_b16 v[30:31], v72 offset:25088
    s_mul_i32 s49, s50, 229376
    s_add_u32 m0, s56, 8192
    s_add_u32 s49, s49, s60
    buffer_load_dwordx4 v10, s[24:27], s49 offen lds
    s_waitcnt lgkmcnt(5)
    v_mfma_f32_32x32x16_bf16 v[112:127], v[44:47], v[236:239], v[112:127]
    ds_read_b64_tr_b16 v[32:33], v76 offset:24576
    ds_read_b64_tr_b16 v[34:35], v76 offset:25088
    s_waitcnt vmcnt(4)
    v_cmp_ne_u32 vcc, s64, v59
    s_nop 1
    s_cbranch_vccz L_BACK_rec_V
    s_mov_b32 s3, 20000
L_SPIN_rec_V:
    s_sleep 1
    buffer_load_dwordx4 v[56:59], v60, s[32:35], 0 offen sc1
    s_waitcnt vmcnt(0)
    v_cmp_ne_u32 vcc, s64, v59
    s_nop 0
    s_sub_u32 s3, s3, 1
    s_cbranch_vccz L_BACK_rec_V
    s_cmp_lg_u32 s3, 0
    s_cbranch_scc1 L_SPIN_rec_V
L_BACK_rec_V:
    s_waitcnt lgkmcnt(4)
    v_mfma_f32_32x32x16_bf16 v[80:95], v[240:243], v[24:27], v[80:95]
    ds_read_b128 v[244:247], v65 offset:24576
    ds_read_b64_tr_b16 v[36:37], v69 offset:24576
    ds_read_b64_tr_b16 v[38:39], v69 offset:25088
    v_cmp_gt_u32 vcc, 32, v0
    v_mov_b32 v5, v57
    v_mov_b32 v8, v58
    v_cndmask_b32 v20, 0, v56, vcc
    v_cndmask_b32 v21, 0, v56, vcc
    v_cndmask_b32 v22, 0, v56, vcc
    v_cndmask_b32 v23, 0, v56, vcc
    s_waitcnt lgkmcnt(5)
    v_mfma_f32_32x32x16_bf16 v[96:111], v[28:31], v[240:243], v[96:111]
    ds_read_b64_tr_b16 v[40:41], v73 offset:24576
    ds_read_b64_tr_b16 v[42:43], v73 offset:25088
    s_add_u32 m0, s56, 40960
    s_add_u32 s50, s50, 1
    buffer_load_dwordx4 v11, s[28:31], s49 offen lds
    s_and_b32 s50, s50, 7
    v_mul_f32 v6, 0xc0135761, v5
    v_mul_f32 v7, v5, v5
    v_mul_f32 v7, v7, v6
    v_mul_f32 v7, 0x3d372713, v7
    s_waitcnt lgkmcnt(5)
    v_mfma_f32_32x32x16_bf16 v[112:127], v[32:35], v[240:243], v[112:127]
    ds_read_b64_tr_b16 v[44:45], v77 offset:24576
    ds_read_b64_tr_b16 v[46:47], v77 offset:25088
    v_smfmac_f32_16x16x64_bf16 v[12:15], v[16:19], v[24:31], v52
    s_waitcnt lgkmcnt(4)
    v_mfma_f32_32x32x16_bf16 v[80:95], v[244:247], v[36:39], v[80:95]
    ds_read_b128 v[248:251], v66 offset:24576
    ds_read_b64_tr_b16 v[24:25], v70 offset:24576
    ds_read_b64_tr_b16 v[26:27], v70 offset:25088
    s_waitcnt lgkmcnt(5)
    v_mfma_f32_32x32x16_bf16 v[96:111], v[40:43], v[244:247], v[96:111]
    ds_read_b64_tr_b16 v[28:29], v74 offset:24576
    ds_read_b64_tr_b16 v[30:31], v74 offset:25088
    s_mul_i32 s49, s50, 229376
    s_add_u32 m0, s56, 73728
    s_add_u32 s49, s49, s60
    buffer_load_dwordx4 v10, s[24:27], s49 offen lds
    s_waitcnt lgkmcnt(5)
    v_mfma_f32_32x32x16_bf16 v[112:127], v[44:47], v[244:247], v[112:127]
    ds_read_b64_tr_b16 v[32:33], v78 offset:24576
    ds_read_b64_tr_b16 v[34:35], v78 offset:25088
    v_smfmac_f32_16x16x64_bf16 v[12:15], v[48:51], v[44:51], v52
    s_waitcnt lgkmcnt(4)
    v_mfma_f32_32x32x16_bf16 v[80:95], v[248:251], v[24:27], v[80:95]
    ds_read_b128 v[252:255], v67 offset:24576
    ds_read_b64_tr_b16 v[36:37], v71 offset:24576
    ds_read_b64_tr_b16 v[38:39], v71 offset:25088
    s_nop 2
    v_add_f32 v12, v12, v13
    v_and_b32 v62, 0xffff0000, v12
    v_sub_f32 v63, v12, v62
    v_cvt_pk_bf16_f32 v12, v62, v63
    v_add_f32 v14, v14, v15
    v_and_b32 v62, 0xffff0000, v14
    v_sub_f32 v63, v14, v62
    v_cvt_pk_bf16_f32 v14, v62, v63
    s_waitcnt lgkmcnt(5)
    v_mfma_f32_32x32x16_bf16 v[96:111], v[28:31], v[248:251], v[96:111]
    ds_read_b64_tr_b16 v[40:41], v75 offset:24576
    ds_read_b64_tr_b16 v[42:43], v75 offset:25088
    s_add_u32 m0, s56, 106496
    s_add_u32 s50, s50, 1
    buffer_load_dwordx4 v11, s[28:31], s49 offen lds
    s_and_b32 s50, s50, 7
    s_mov_b32 exec_hi, 65535
    ds_write_b32 v61, v12 offset:0
    ds_write_b32 v61, v14 offset:256
    s_mov_b64 exec, -1
    s_waitcnt lgkmcnt(7)
    v_mfma_f32_32x32x16_bf16 v[112:127], v[32:35], v[248:251], v[112:127]
    ds_read_b64_tr_b16 v[44:45], v79 offset:24576
    ds_read_b64_tr_b16 v[46:47], v79 offset:25088
    v_add_u32 v28, 65536, v1
    v_add_u32 v29, 65536, v2
    v_add_u32 v30, 65536, v3
    v_add_u32 v31, 65536, v4
    s_waitcnt vmcnt(4)
    s_waitcnt lgkmcnt(2)
    v_mfma_f32_32x32x16_bf16 v[80:95], v[252:255], v[36:39], v[80:95]
    s_barrier
    ds_read_b128 v[68:71], v9 offset:0
    ds_read_b128 v[72:75], v9 offset:512
    ds_read_b128 v[76:79], v9 offset:1024
    v_mfma_f32_32x32x16_bf16 v[96:111], v[40:43], v[252:255], v[96:111]
    ds_read_b64_tr_b16 v[32:33], v1 offset:0
    ds_read_b64_tr_b16 v[34:35], v1 offset:512
    s_mul_i32 s49, s50, 229376
    s_add_u32 m0, s56, 16384
    s_add_u32 s49, s49, s60
    buffer_load_dwordx4 v10, s[24:27], s49 offen lds
    s_waitcnt lgkmcnt(5)
    v_mfma_f32_32x32x16_bf16 v[112:127], v[44:47], v[252:255], v[112:127]
    v_xor_b32 v24, 32, v1
    ds_read_b64_tr_b16 v[36:37], v24 offset:0
    ds_read_b64_tr_b16 v[38:39], v24 offset:512
    s_add_u32 m0, s56, 49152
    s_add_u32 s50, s50, 1
    buffer_load_dwordx4 v11, s[28:31], s49 offen lds
    s_and_b32 s50, s50, 7
    s_waitcnt lgkmcnt(4)
    v_mfma_f32_32x32x16_bf16 v[80:95], v[20:23], v[68:71], v[80:95]
    s_mul_i32 s49, s50, 229376
    s_add_u32 m0, s56, 81920
    s_add_u32 s49, s49, s60
    buffer_load_dwordx4 v10, s[24:27], s49 offen lds
    v_mfma_f32_32x32x16_bf16 v[96:111], v[72:75], v[20:23], v[96:111]
    s_add_u32 m0, s56, 114688
    s_add_u32 s50, s50, 1
    buffer_load_dwordx4 v11, s[28:31], s49 offen lds
    s_and_b32 s50, s50, 7
    v_mfma_f32_32x32x16_bf16 v[112:127], v[76:79], v[20:23], v[112:127]
    v_lshlrev_b32 v9, 4, v0
    s_waitcnt lgkmcnt(2)
    v_mfma_f32_32x32x16_bf16 v[48:63], v[32:35], v[128:131], 0
    ds_read_b64_tr_b16 v[40:41], v2 offset:0
    ds_read_b64_tr_b16 v[42:43], v2 offset:512
    s_mov_b32 s12, s68
    s_and_b32 s13, s69, 0xffff
    s_mov_b32 s14, 524288
    s_mov_b32 s15, 0x20000
    s_mov_b32 s16, s76
    s_and_b32 s17, s77, 0xffff
    s_mov_b32 s18, 1835008
    s_mov_b32 s19, 0x20000
    s_mov_b32 s20, s78
    s_and_b32 s21, s79, 0xffff
    s_mov_b32 s22, 2097152
    s_mov_b32 s23, 0x20000
    s_waitcnt lgkmcnt(2)
    v_mfma_f32_32x32x16_bf16 v[64:79], v[36:39], v[128:131], 0
    v_xor_b32 v24, 32, v2
    ds_read_b64_tr_b16 v[44:45], v24 offset:0
    ds_read_b64_tr_b16 v[46:47], v24 offset:512
    v_and_b32 v26, 1, v0
    v_mul_u32_u24 v26, 0xaaaa, v26
    v_add_u32 v26, 0x4444, v26
    v_lshl_or_b32 v128, v26, 16, v26
    v_mov_b32 v12, 0
    v_mov_b32 v13, 0
    v_mov_b32 v14, 0
    v_mov_b32 v15, 0
    s_waitcnt lgkmcnt(2)
    v_mfma_f32_32x32x16_bf16 v[48:63], v[40:43], v[132:135], v[48:63]
    ds_read_b64_tr_b16 v[32:33], v3 offset:0
    ds_read_b64_tr_b16 v[34:35], v3 offset:512
    s_lshl_b32 s48, s62, 17
    s_add_u32 s48, s48, 2097152
    s_add_u32 s48, s48, s56
    s_lshl_b32 s51, s63, 14
    s_waitcnt lgkmcnt(2)
    v_mfma_f32_32x32x16_bf16 v[64:79], v[44:47], v[132:135], v[64:79]
    v_smfmac_f32_16x16x64_bf16 v[12:15], v[16:19], v[40:47], v128
    v_xor_b32 v24, 32, v3
    ds_read_b64_tr_b16 v[36:37], v24 offset:0
    ds_read_b64_tr_b16 v[38:39], v24 offset:512
    s_waitcnt lgkmcnt(2)
    v_mfma_f32_32x32x16_bf16 v[48:63], v[32:35], v[136:139], v[48:63]
    ds_read_b64_tr_b16 v[40:41], v4 offset:0
    ds_read_b64_tr_b16 v[42:43], v4 offset:512
    s_waitcnt lgkmcnt(2)
    v_mfma_f32_32x32x16_bf16 v[64:79], v[36:39], v[136:139], v[64:79]
    v_xor_b32 v24, 32, v4
    ds_read_b64_tr_b16 v[44:45], v24 offset:0
    ds_read_b64_tr_b16 v[46:47], v24 offset:512
    s_waitcnt lgkmcnt(2)
    v_mfma_f32_32x32x16_bf16 v[48:63], v[40:43], v[140:143], v[48:63]
    ds_read_b64_tr_b16 v[32:33], v28 offset:0
    ds_read_b64_tr_b16 v[34:35], v28 offset:512
    s_waitcnt lgkmcnt(2)
    v_mfma_f32_32x32x16_bf16 v[64:79], v[44:47], v[140:143], v[64:79]
    v_xor_b32 v24, 32, v28
    ds_read_b64_tr_b16 v[36:37], v24 offset:0
    ds_read_b64_tr_b16 v[38:39], v24 offset:512
    s_waitcnt lgkmcnt(2)
    v_mfma_f32_32x32x16_bf16 v[48:63], v[32:35], v[144:147], v[48:63]
    ds_read_b64_tr_b16 v[40:41], v29 offset:0
    ds_read_b64_tr_b16 v[42:43], v29 offset:512
    s_waitcnt lgkmcnt(2)
    v_mfma_f32_32x32x16_bf16 v[64:79], v[36:39], v[144:147], v[64:79]
    v_xor_b32 v24, 32, v29
    ds_read_b64_tr_b16 v[44:45], v24 offset:0
    ds_read_b64_tr_b16 v[46:47], v24 offset:512
    v_and_b32 v25, 31, v0
    s_lshl_b32 s71, s42, 7
    s_add_u32 s71, s71, 138240
    v_lshl_add_u32 v25, v25, 2, s71
    ds_write_b32 v25, v5
    v_lshrrev_b32 v26, 5, v0
    v_lshl_add_u32 v25, v26, 4, s71
    ds_read_b128 v[132:135], v25 offset:0
    ds_read_b128 v[136:139], v25 offset:32
    ds_read_b128 v[140:143], v25 offset:64
    ds_read_b128 v[144:147], v25 offset:96
    v_lshlrev_b32 v26, 8, v26
    s_waitcnt lgkmcnt(7)
    v_mfma_f32_32x32x16_bf16 v[48:63], v[40:43], v[148:151], v[48:63]
    ds_read_b64_tr_b16 v[32:33], v30 offset:0
    ds_read_b64_tr_b16 v[34:35], v30 offset:512
    v_bfe_u32 v25, v0, 4, 1
    v_lshl_add_u32 v26, v25, 17, v26
    v_and_b32 v25, 15, v0
    v_lshl_add_u32 v26, v25, 4, v26
    s_waitcnt lgkmcnt(2)
    v_mul_f32 v80, v132, v80
    v_mul_f32 v81, v133, v81
    v_cvt_pk_bf16_f32 v80, v80, v81
    v_mfma_f32_32x32x16_bf16 v[64:79], v[44:47], v[148:151], v[64:79]
    v_smfmac_f32_16x16x64_bf16 v[12:15], v[16:19], v[40:47], v128
    v_xor_b32 v24, 32, v30
    ds_read_b64_tr_b16 v[36:37], v24 offset:0
    ds_read_b64_tr_b16 v[38:39], v24 offset:512
    v_mul_f32 v82, v134, v82
    v_mul_f32 v83, v135, v83
    v_cvt_pk_bf16_f32 v81, v82, v83
    v_mul_f32 v84, v136, v84
    v_mul_f32 v85, v137, v85
    v_cvt_pk_bf16_f32 v82, v84, v85
    s_waitcnt lgkmcnt(2)
    v_mfma_f32_32x32x16_bf16 v[48:63], v[32:35], v[152:155], v[48:63]
    ds_read_b64_tr_b16 v[40:41], v31 offset:0
    ds_read_b64_tr_b16 v[42:43], v31 offset:512
    v_mul_f32 v86, v138, v86
    v_mul_f32 v87, v139, v87
    v_cvt_pk_bf16_f32 v83, v86, v87
    buffer_store_dwordx4 v[80:83], v26, s[32:35], s66 offen offset:0 sc1
    v_mul_f32 v88, v140, v88
    v_mul_f32 v89, v141, v89
    v_cvt_pk_bf16_f32 v84, v88, v89
    s_waitcnt lgkmcnt(2)
    v_mfma_f32_32x32x16_bf16 v[64:79], v[36:39], v[152:155], v[64:79]
    v_xor_b32 v24, 32, v31
    ds_read_b64_tr_b16 v[44:45], v24 offset:0
    ds_read_b64_tr_b16 v[46:47], v24 offset:512
    v_mul_f32 v90, v142, v90
    v_mul_f32 v91, v143, v91
    v_cvt_pk_bf16_f32 v85, v90, v91
    v_mul_f32 v92, v144, v92
    v_mul_f32 v93, v145, v93
    v_cvt_pk_bf16_f32 v86, v92, v93
    s_waitcnt vmcnt(5)
    s_waitcnt lgkmcnt(2)
    v_mfma_f32_32x32x16_bf16 v[48:63], v[40:43], v[156:159], v[48:63]
    s_barrier
    ds_read_b64_tr_b16 v[32:33], v1 offset:8192
    ds_read_b64_tr_b16 v[34:35], v1 offset:8704
    v_mul_f32 v94, v146, v94
    v_mul_f32 v95, v147, v95
    v_cvt_pk_bf16_f32 v87, v94, v95
    buffer_store_dwordx4 v[84:87], v26, s[32:35], s66 offen offset:512 sc1
    s_waitcnt lgkmcnt(2)
    v_mfma_f32_32x32x16_bf16 v[64:79], v[44:47], v[156:159], v[64:79]
    v_xor_b32 v24, 32, v1
    ds_read_b64_tr_b16 v[36:37], v24 offset:8192
    ds_read_b64_tr_b16 v[38:39], v24 offset:8704
    s_mul_i32 s49, s50, 229376
    s_add_u32 m0, s56, 24576
    s_add_u32 s49, s49, s60
    buffer_load_dwordx4 v10, s[24:27], s49 offen lds
    s_add_u32 m0, s56, 57344
    s_add_u32 s50, s50, 1
    buffer_load_dwordx4 v11, s[28:31], s49 offen lds
    s_and_b32 s50, s50, 7
    s_mul_i32 s49, s50, 229376
    s_add_u32 m0, s56, 90112
    s_add_u32 s49, s49, s60
    buffer_load_dwordx4 v10, s[24:27], s49 offen lds
    s_add_u32 m0, s56, 122880
    s_add_u32 s50, s50, 1
    buffer_load_dwordx4 v11, s[28:31], s49 offen lds
    s_and_b32 s50, s50, 7
    s_waitcnt lgkmcnt(2)
    v_mfma_f32_32x32x16_bf16 v[48:63], v[32:35], v[160:163], v[48:63]
    ds_read_b64_tr_b16 v[40:41], v2 offset:8192
    ds_read_b64_tr_b16 v[42:43], v2 offset:8704
    s_waitcnt lgkmcnt(2)
    v_mfma_f32_32x32x16_bf16 v[64:79], v[36:39], v[160:163], v[64:79]
    v_xor_b32 v24, 32, v2
    ds_read_b64_tr_b16 v[44:45], v24 offset:8192
    ds_read_b64_tr_b16 v[46:47], v24 offset:8704
    s_lshr_b32 s0, s62, 2
    s_add_u32 s1, s0, 4
    s_mul_i32 s1, s1, 43
    s_lshr_b32 s1, s1, 7
    s_add_u32 s1, s1, 12
    s_sub_u32 s6, s0, 4
    s_mul_i32 s6, s6, 43
    s_lshr_b32 s6, s6, 7
    s_add_u32 s6, s6, 12
    s_add_u32 s7, s0, 8
    s_cmp_lt_u32 s0, 4
    s_cselect_b32 s6, s7, s6
    s_waitcnt lgkmcnt(2)
    v_mfma_f32_32x32x16_bf16 v[48:63], v[40:43], v[164:167], v[48:63]
    ds_read_b64_tr_b16 v[32:33], v3 offset:8192
    ds_read_b64_tr_b16 v[34:35], v3 offset:8704
    s_lshl_b32 s1, s1, 4
    s_lshl_b32 s0, s0, 4
    s_sub_u32 s0, s0, 16
    s_lshl_b32 s6, s6, 4
    s_lshl_b32 s7, s63, 1
    s_add_u32 s6, s6, s7
    s_sub_u32 s6, s6, 32
    v_mov_b32 v154, s1
    v_cmp_le_u32 vcc, 16, v0
    v_mov_b32 v27, s0
    s_nop 0
    v_cndmask_b32 v154, v154, v27, vcc
    v_cmp_le_u32 vcc, 32, v0
    v_mov_b32 v27, s6
    s_nop 0
    v_cndmask_b32 v154, v154, v27, vcc
    s_waitcnt lgkmcnt(2)
    v_mfma_f32_32x32x16_bf16 v[64:79], v[44:47], v[164:167], v[64:79]
    v_smfmac_f32_16x16x64_bf16 v[12:15], v[16:19], v[40:47], v128
    v_xor_b32 v24, 32, v3
    ds_read_b64_tr_b16 v[36:37], v24 offset:8192
    ds_read_b64_tr_b16 v[38:39], v24 offset:8704
    v_min_u32 v27, 33, v0
    v_add_u32 v154, v154, v27
    v_lshlrev_b32 v154, 7, v154
    v_add_u32 v154, 23068672, v154
    v_and_b32 v150, 15, v0
    v_lshlrev_b32 v150, 4, v150
    v_lshrrev_b32 v151, 4, v0
    s_waitcnt lgkmcnt(2)
    v_mfma_f32_32x32x16_bf16 v[48:63], v[32:35], v[168:171], v[48:63]
    ds_read_b64_tr_b16 v[40:41], v4 offset:8192
    ds_read_b64_tr_b16 v[42:43], v4 offset:8704
    v_lshl_add_u32 v150, v151, 9, v150
    s_mul_i32 s71, s44, 1024
    s_lshl_b32 s0, s43, 2
    s_add_u32 s71, s71, s0
    s_add_u32 s71, s71, 136192
    v_add_u32 v150, s71, v150
    v_and_b32 v151, 31, v0
    s_lshl_b32 s71, s44, 10
    s_add_u32 s71, s71, 136192
    v_lshl_add_u32 v151, v151, 4, s71
    s_waitcnt lgkmcnt(2)
    v_mfma_f32_32x32x16_bf16 v[64:79], v[36:39], v[168:171], v[64:79]
    v_xor_b32 v24, 32, v4
    ds_read_b64_tr_b16 v[44:45], v24 offset:8192
    ds_read_b64_tr_b16 v[46:47], v24 offset:8704
    v_mul_f32 v84, v96, v96
    v_mul_f32 v85, v97, v97
    v_mul_f32 v86, v98, v98
    v_mul_f32 v87, v99, v99
    v_fma_f32 v84, v84, v7, v6
    s_waitcnt lgkmcnt(2)
    v_mfma_f32_32x32x16_bf16 v[48:63], v[40:43], v[172:175], v[48:63]
    ds_read_b64_tr_b16 v[32:33], v28 offset:8192
    ds_read_b64_tr_b16 v[34:35], v28 offset:8704
    v_fma_f32 v85, v85, v7, v6
    v_fma_f32 v86, v86, v7, v6
    v_fma_f32 v87, v87, v7, v6
    v_mul_f32 v84, v84, v96
    v_mul_f32 v85, v85, v97
    v_mul_f32 v86, v86, v98
    s_waitcnt lgkmcnt(2)
    v_mfma_f32_32x32x16_bf16 v[64:79], v[44:47], v[172:175], v[64:79]
    v_xor_b32 v24, 32, v28
    ds_read_b64_tr_b16 v[36:37], v24 offset:8192
    ds_read_b64_tr_b16 v[38:39], v24 offset:8704
    v_mul_f32 v87, v87, v99
    v_exp_f32 v84, v84
    v_exp_f32 v85, v85
    s_waitcnt lgkmcnt(2)
    v_mfma_f32_32x32x16_bf16 v[48:63], v[32:35], v[176:179], v[48:63]
    ds_read_b64_tr_b16 v[40:41], v29 offset:8192
    ds_read_b64_tr_b16 v[42:43], v29 offset:8704
    v_exp_f32 v86, v86
    v_exp_f32 v87, v87
    v_mul_f32 v96, v96, v104
    v_mul_f32 v97, v97, v105
    s_waitcnt lgkmcnt(2)
    v_mfma_f32_32x32x16_bf16 v[64:79], v[36:39], v[176:179], v[64:79]
    v_xor_b32 v24, 32, v29
    ds_read_b64_tr_b16 v[44:45], v24 offset:8192
    ds_read_b64_tr_b16 v[46:47], v24 offset:8704
    v_mul_f32 v98, v98, v106
    v_mul_f32 v99, v99, v107
    v_fma_f32 v84, v84, v8, v8
    v_fma_f32 v85, v85, v8, v8
    v_fma_f32 v86, v86, v8, v8
    s_waitcnt lgkmcnt(2)
    v_mfma_f32_32x32x16_bf16 v[48:63], v[40:43], v[180:183], v[48:63]
    ds_read_b64_tr_b16 v[32:33], v30 offset:8192
    ds_read_b64_tr_b16 v[34:35], v30 offset:8704
    v_fma_f32 v87, v87, v8, v8
    v_rcp_f32 v84, v84
    v_rcp_f32 v85, v85
    v_rcp_f32 v86, v86
    s_waitcnt lgkmcnt(2)
    v_mfma_f32_32x32x16_bf16 v[64:79], v[44:47], v[180:183], v[64:79]
    v_smfmac_f32_16x16x64_bf16 v[12:15], v[16:19], v[40:47], v128
    v_xor_b32 v24, 32, v30
    ds_read_b64_tr_b16 v[36:37], v24 offset:8192
    ds_read_b64_tr_b16 v[38:39], v24 offset:8704
    s_waitcnt vmcnt(4)
    s_barrier
    s_lshl_b32 s3, s46, 4
    s_add_u32 s3, s3, s45
    s_lshl_b32 s3, s3, 7
    s_add_u32 s3, s3, 23068672
    s_cmp_eq_u32 s42, 0
    s_cselect_b32 s3, s3, 0x7fffff00
    v_mov_b32 v152, s64
    v_lshlrev_b32 v153, 2, v0
    s_mov_b32 exec_hi, 0
    buffer_store_dword v152, v153, s[32:35], s3 offen sc1
    s_mov_b64 exec, -1
    s_waitcnt lgkmcnt(2)
    v_mfma_f32_32x32x16_bf16 v[48:63], v[32:35], v[184:187], v[48:63]
    ds_read_b64_tr_b16 v[40:41], v31 offset:8192
    ds_read_b64_tr_b16 v[42:43], v31 offset:8704
    v_rcp_f32 v87, v87
    v_mul_f32 v96, v96, v84
    v_mul_f32 v97, v97, v85
    v_mul_f32 v98, v98, v86
    v_mul_f32 v99, v99, v87
    v_mul_f32 v88, v100, v100
    s_waitcnt lgkmcnt(2)
    v_mfma_f32_32x32x16_bf16 v[64:79], v[36:39], v[184:187], v[64:79]
    v_xor_b32 v24, 32, v31
    ds_read_b64_tr_b16 v[44:45], v24 offset:8192
    ds_read_b64_tr_b16 v[46:47], v24 offset:8704
    v_mul_f32 v89, v101, v101
    v_mul_f32 v90, v102, v102
    v_mul_f32 v91, v103, v103
    v_fma_f32 v88, v88, v7, v6
    v_fma_f32 v89, v89, v7, v6
    s_waitcnt vmcnt(5)
    s_waitcnt lgkmcnt(2)
    v_mfma_f32_32x32x16_bf16 v[48:63], v[40:43], v[188:191], v[48:63]
    s_barrier
    ds_read_b64_tr_b16 v[32:33], v1 offset:16384
    ds_read_b64_tr_b16 v[34:35], v1 offset:16896
    v_fma_f32 v90, v90, v7, v6
    v_fma_f32 v91, v91, v7, v6
    v_mul_f32 v88, v88, v100
    v_mul_f32 v89, v89, v101
    v_mul_f32 v90, v90, v102
    v_mul_f32 v91, v91, v103
    s_waitcnt lgkmcnt(2)
    v_mfma_f32_32x32x16_bf16 v[64:79], v[44:47], v[188:191], v[64:79]
    v_xor_b32 v24, 32, v1
    ds_read_b64_tr_b16 v[36:37], v24 offset:16384
    ds_read_b64_tr_b16 v[38:39], v24 offset:16896
    v_exp_f32 v88, v88
    v_exp_f32 v89, v89
    v_exp_f32 v90, v90
    s_waitcnt lgkmcnt(2)
    v_mfma_f32_32x32x16_bf16 v[48:63], v[32:35], v[192:195], v[48:63]
    ds_read_b64_tr_b16 v[40:41], v2 offset:16384
    ds_read_b64_tr_b16 v[42:43], v2 offset:16896
    v_exp_f32 v91, v91
    v_mul_f32 v100, v100, v108
    v_mul_f32 v101, v101, v109
    v_mul_f32 v102, v102, v110
    s_waitcnt lgkmcnt(2)
    v_mfma_f32_32x32x16_bf16 v[64:79], v[36:39], v[192:195], v[64:79]
    v_xor_b32 v24, 32, v2
    ds_read_b64_tr_b16 v[44:45], v24 offset:16384
    ds_read_b64_tr_b16 v[46:47], v24 offset:16896
    v_mul_f32 v103, v103, v111
    v_fma_f32 v88, v88, v8, v8
    v_fma_f32 v89, v89, v8, v8
    v_fma_f32 v90, v90, v8, v8
    v_fma_f32 v91, v91, v8, v8
    s_waitcnt lgkmcnt(2)
    v_mfma_f32_32x32x16_bf16 v[48:63], v[40:43], v[196:199], v[48:63]
    ds_read_b64_tr_b16 v[32:33], v3 offset:16384
    ds_read_b64_tr_b16 v[34:35], v3 offset:16896
    v_rcp_f32 v88, v88
    v_rcp_f32 v89, v89
    v_rcp_f32 v90, v90
    s_waitcnt lgkmcnt(2)
    v_mfma_f32_32x32x16_bf16 v[64:79], v[44:47], v[196:199], v[64:79]
    v_smfmac_f32_16x16x64_bf16 v[12:15], v[16:19], v[40:47], v128
    v_xor_b32 v24, 32, v3
    ds_read_b64_tr_b16 v[36:37], v24 offset:16384
    ds_read_b64_tr_b16 v[38:39], v24 offset:16896
    v_rcp_f32 v91, v91
    v_cvt_pk_bf16_f32 v132, v96, v97
    v_cvt_pk_bf16_f32 v133, v98, v99
    v_mul_f32 v100, v100, v88
    s_waitcnt lgkmcnt(2)
    v_mfma_f32_32x32x16_bf16 v[48:63], v[32:35], v[200:203], v[48:63]
    ds_read_b64_tr_b16 v[40:41], v4 offset:16384
    ds_read_b64_tr_b16 v[42:43], v4 offset:16896
    v_mul_f32 v101, v101, v89
    v_mul_f32 v102, v102, v90
    v_mul_f32 v103, v103, v91
    v_cvt_pk_bf16_f32 v134, v100, v101
    v_cvt_pk_bf16_f32 v135, v102, v103
    v_mul_f32 v84, v112, v112
    s_waitcnt lgkmcnt(2)
    v_mfma_f32_32x32x16_bf16 v[64:79], v[36:39], v[200:203], v[64:79]
    v_xor_b32 v24, 32, v4
    ds_read_b64_tr_b16 v[44:45], v24 offset:16384
    ds_read_b64_tr_b16 v[46:47], v24 offset:16896
    v_mul_f32 v85, v113, v113
    v_mul_f32 v86, v114, v114
    v_mul_f32 v87, v115, v115
    v_fma_f32 v84, v84, v7, v6
    v_fma_f32 v85, v85, v7, v6
    s_waitcnt lgkmcnt(2)
    v_mfma_f32_32x32x16_bf16 v[48:63], v[40:43], v[204:207], v[48:63]
    ds_read_b64_tr_b16 v[32:33], v28 offset:16384
    ds_read_b64_tr_b16 v[34:35], v28 offset:16896
    v_fma_f32 v86, v86, v7, v6
    v_fma_f32 v87, v87, v7, v6
    v_mul_f32 v84, v84, v112
    v_mul_f32 v85, v85, v113
    v_mul_f32 v86, v86, v114
    v_mul_f32 v87, v87, v115
    s_waitcnt lgkmcnt(2)
    v_mfma_f32_32x32x16_bf16 v[64:79], v[44:47], v[204:207], v[64:79]
    v_xor_b32 v24, 32, v28
    ds_read_b64_tr_b16 v[36:37], v24 offset:16384
    ds_read_b64_tr_b16 v[38:39], v24 offset:16896
    v_exp_f32 v84, v84
    v_exp_f32 v85, v85
    v_exp_f32 v86, v86
    s_waitcnt lgkmcnt(2)
    v_mfma_f32_32x32x16_bf16 v[48:63], v[32:35], v[208:211], v[48:63]
    ds_read_b64_tr_b16 v[40:41], v29 offset:16384
    ds_read_b64_tr_b16 v[42:43], v29 offset:16896
    v_exp_f32 v87, v87
    v_mul_f32 v112, v112, v120
    v_mul_f32 v113, v113, v121
    v_mul_f32 v114, v114, v122
    s_waitcnt lgkmcnt(2)
    v_mfma_f32_32x32x16_bf16 v[64:79], v[36:39], v[208:211], v[64:79]
    v_xor_b32 v24, 32, v29
    ds_read_b64_tr_b16 v[44:45], v24 offset:16384
    ds_read_b64_tr_b16 v[46:47], v24 offset:16896
    v_mul_f32 v115, v115, v123
    v_fma_f32 v84, v84, v8, v8
    v_fma_f32 v85, v85, v8, v8
    v_fma_f32 v86, v86, v8, v8
    v_fma_f32 v87, v87, v8, v8
    s_waitcnt lgkmcnt(2)
    v_mfma_f32_32x32x16_bf16 v[48:63], v[40:43], v[212:215], v[48:63]
    ds_read_b64_tr_b16 v[32:33], v30 offset:16384
    ds_read_b64_tr_b16 v[34:35], v30 offset:16896
    v_rcp_f32 v84, v84
    v_rcp_f32 v85, v85
    v_rcp_f32 v86, v86
    s_waitcnt lgkmcnt(2)
    v_mfma_f32_32x32x16_bf16 v[64:79], v[44:47], v[212:215], v[64:79]
    v_smfmac_f32_16x16x64_bf16 v[12:15], v[16:19], v[40:47], v128
    v_xor_b32 v24, 32, v30
    ds_read_b64_tr_b16 v[36:37], v24 offset:16384
    ds_read_b64_tr_b16 v[38:39], v24 offset:16896
    v_rcp_f32 v87, v87
    v_mul_f32 v112, v112, v84
    v_mul_f32 v113, v113, v85
    v_mul_f32 v114, v114, v86
    s_waitcnt lgkmcnt(2)
    v_mfma_f32_32x32x16_bf16 v[48:63], v[32:35], v[216:219], v[48:63]
    ds_read_b64_tr_b16 v[40:41], v31 offset:16384
    ds_read_b64_tr_b16 v[42:43], v31 offset:16896
    v_mul_f32 v115, v115, v87
    v_mul_f32 v88, v116, v116
    v_mul_f32 v89, v117, v117
    v_mul_f32 v90, v118, v118
    v_mul_f32 v91, v119, v119
    v_fma_f32 v88, v88, v7, v6
    s_waitcnt lgkmcnt(2)
    v_mfma_f32_32x32x16_bf16 v[64:79], v[36:39], v[216:219], v[64:79]
    v_xor_b32 v24, 32, v31
    ds_read_b64_tr_b16 v[44:45], v24 offset:16384
    ds_read_b64_tr_b16 v[46:47], v24 offset:16896
    v_fma_f32 v89, v89, v7, v6
    v_fma_f32 v90, v90, v7, v6
    v_fma_f32 v91, v91, v7, v6
    v_mul_f32 v88, v88, v116
    v_mul_f32 v89, v89, v117
    s_waitcnt vmcnt(1)
    s_waitcnt lgkmcnt(2)
    v_mfma_f32_32x32x16_bf16 v[48:63], v[40:43], v[220:223], v[48:63]
    s_barrier
    ds_read_b64_tr_b16 v[32:33], v1 offset:24576
    ds_read_b64_tr_b16 v[34:35], v1 offset:25088
    v_mul_f32 v90, v90, v118
    v_mul_f32 v91, v91, v119
    v_exp_f32 v88, v88
    v_exp_f32 v89, v89
    s_waitcnt lgkmcnt(2)
    v_mfma_f32_32x32x16_bf16 v[64:79], v[44:47], v[220:223], v[64:79]
    v_xor_b32 v24, 32, v1
    ds_read_b64_tr_b16 v[36:37], v24 offset:24576
    ds_read_b64_tr_b16 v[38:39], v24 offset:25088
    buffer_load_dword v155, v154, s[32:35], s70 offen sc1
    v_exp_f32 v90, v90
    v_exp_f32 v91, v91
    v_mul_f32 v116, v116, v124
    s_waitcnt lgkmcnt(2)
    v_mfma_f32_32x32x16_bf16 v[48:63], v[32:35], v[224:227], v[48:63]
    ds_read_b64_tr_b16 v[40:41], v2 offset:24576
    ds_read_b64_tr_b16 v[42:43], v2 offset:25088
    v_mul_f32 v117, v117, v125
    v_mul_f32 v118, v118, v126
    v_mul_f32 v119, v119, v127
    v_fma_f32 v88, v88, v8, v8
    v_fma_f32 v89, v89, v8, v8
    v_fma_f32 v90, v90, v8, v8
    s_waitcnt lgkmcnt(2)
    v_mfma_f32_32x32x16_bf16 v[64:79], v[36:39], v[224:227], v[64:79]
    v_xor_b32 v24, 32, v2
    ds_read_b64_tr_b16 v[44:45], v24 offset:24576
    ds_read_b64_tr_b16 v[46:47], v24 offset:25088
    v_fma_f32 v91, v91, v8, v8
    v_rcp_f32 v88, v88
    v_rcp_f32 v89, v89
    s_waitcnt lgkmcnt(2)
    v_mfma_f32_32x32x16_bf16 v[48:63], v[40:43], v[228:231], v[48:63]
    ds_read_b64_tr_b16 v[32:33], v3 offset:24576
    ds_read_b64_tr_b16 v[34:35], v3 offset:25088
    v_rcp_f32 v90, v90
    v_rcp_f32 v91, v91
    v_cvt_pk_bf16_f32 v136, v112, v113
    v_cvt_pk_bf16_f32 v137, v114, v115
    s_waitcnt lgkmcnt(2)
    v_mfma_f32_32x32x16_bf16 v[64:79], v[44:47], v[228:231], v[64:79]
    v_smfmac_f32_16x16x64_bf16 v[12:15], v[16:19], v[40:47], v128
    v_xor_b32 v24, 32, v3
    ds_read_b64_tr_b16 v[36:37], v24 offset:24576
    ds_read_b64_tr_b16 v[38:39], v24 offset:25088
    v_mul_f32 v116, v116, v88
    v_mul_f32 v117, v117, v89
    v_mul_f32 v118, v118, v90
    v_mul_f32 v119, v119, v91
    v_cvt_pk_bf16_f32 v138, v116, v117
    s_waitcnt lgkmcnt(2)
    v_mfma_f32_32x32x16_bf16 v[48:63], v[32:35], v[232:235], v[48:63]
    ds_read_b64_tr_b16 v[40:41], v4 offset:24576
    ds_read_b64_tr_b16 v[42:43], v4 offset:25088
    v_cvt_pk_bf16_f32 v139, v118, v119
    s_mul_i32 s71, s47, 144
    s_add_u32 s71, s71, s62
    s_lshl_b32 s71, s71, 10
    s_add_u32 s58, s71, 6291456
    s_lshl_b32 s57, s54, 1
    s_and_b32 s71, s42, 1
    s_add_u32 s57, s57, s71
    s_lshl_b32 s57, s57, 15
    s_lshl_b32 s71, s55, 7
    s_add_u32 s57, s57, s71
    s_lshr_b32 s71, s42, 1
    s_lshl_b32 s71, s71, 5
    s_waitcnt lgkmcnt(2)
    v_mfma_f32_32x32x16_bf16 v[64:79], v[36:39], v[232:235], v[64:79]
    v_xor_b32 v24, 32, v4
    ds_read_b64_tr_b16 v[44:45], v24 offset:24576
    ds_read_b64_tr_b16 v[46:47], v24 offset:25088
    s_add_u32 s57, s57, s71
    v_mov_b32 v104, v0
    v_mov_b32 v105, v9
    v_mov_b32 v116, v9
    v_add_u32 v117, 65536, v9
    v_add_u32 v118, 131072, v9
    v_lshrrev_b32 v96, 5, v0
    v_and_b32 v97, 15, v0
    v_lshlrev_b32 v97, 4, v97
    v_lshl_add_u32 v119, v96, 8, v97
    s_waitcnt lgkmcnt(2)
    v_mfma_f32_32x32x16_bf16 v[48:63], v[40:43], v[236:239], v[48:63]
    ds_read_b64_tr_b16 v[32:33], v28 offset:24576
    ds_read_b64_tr_b16 v[34:35], v28 offset:25088
    v_add_u32 v120, 65536, v119
    v_add_u32 v121, 131072, v119
    v_and_b32 v97, 31, v0
    s_waitcnt lgkmcnt(2)
    v_mfma_f32_32x32x16_bf16 v[64:79], v[44:47], v[236:239], v[64:79]
    v_xor_b32 v24, 32, v28
    ds_read_b64_tr_b16 v[36:37], v24 offset:24576
    ds_read_b64_tr_b16 v[38:39], v24 offset:25088
    v_lshlrev_b32 v97, 10, v97
    v_lshl_add_u32 v125, v96, 4, v97
    v_lshrrev_b32 v97, 3, v0
    v_bfe_u32 v98, v0, 4, 1
    v_lshlrev_b32 v98, 2, v98
    v_and_b32 v122, 7, v0
    s_waitcnt lgkmcnt(2)
    v_mfma_f32_32x32x16_bf16 v[48:63], v[32:35], v[240:243], v[48:63]
    ds_read_b64_tr_b16 v[40:41], v29 offset:24576
    ds_read_b64_tr_b16 v[42:43], v29 offset:25088
    v_xor_b32 v98, v98, v122
    v_lshlrev_b32 v98, 4, v98
    v_lshl_add_u32 v122, v97, 10, v98
    v_bfe_u32 v97, v0, 2, 2
    v_lshl_add_u32 v96, v96, 2, v97
    v_lshlrev_b32 v96, 7, v96
    s_waitcnt lgkmcnt(2)
    v_mfma_f32_32x32x16_bf16 v[64:79], v[36:39], v[240:243], v[64:79]
    v_smfmac_f32_16x16x64_bf16 v[12:15], v[16:19], v[32:39], v128
    v_xor_b32 v24, 32, v29
    ds_read_b64_tr_b16 v[44:45], v24 offset:24576
    ds_read_b64_tr_b16 v[46:47], v24 offset:25088
    buffer_load_dword v164, v154, s[32:35], s70 offen sc1
    v_and_b32 v97, 3, v0
    v_lshl_add_u32 v96, v97, 3, v96
    v_bfe_u32 v97, v0, 3, 1
    v_lshlrev_b32 v97, 1, v97
    v_bfe_u32 v98, v0, 4, 1
    v_xor_b32 v97, v97, v98
    s_waitcnt lgkmcnt(2)
    v_mfma_f32_32x32x16_bf16 v[48:63], v[40:43], v[244:247], v[48:63]
    ds_read_b64_tr_b16 v[32:33], v30 offset:24576
    ds_read_b64_tr_b16 v[34:35], v30 offset:25088
    v_lshl_add_u32 v96, v97, 5, v96
    s_lshl_b32 s53, s42, 12
    s_add_u32 s53, s53, 106496
    v_add_u32 v123, s53, v96
    v_xor_b32 v124, 64, v123
    v_add_u32 v96, 16, v0
    s_waitcnt lgkmcnt(2)
    v_mfma_f32_32x32x16_bf16 v[64:79], v[44:47], v[244:247], v[64:79]
    v_xor_b32 v24, 32, v30
    ds_read_b64_tr_b16 v[36:37], v24 offset:24576
    ds_read_b64_tr_b16 v[38:39], v24 offset:25088
    v_add_f32 v12, v12, v13
    v_and_b32 v26, 0xffff0000, v12
    v_sub_f32 v27, v12, v26
    v_cvt_pk_bf16_f32 v12, v26, v27
    v_add_f32 v14, v14, v15
    v_and_b32 v26, 0xffff0000, v14
    v_sub_f32 v27, v14, v26
    v_cvt_pk_bf16_f32 v14, v26, v27
    s_mov_b32 exec_hi, 0
    ds_write_b32 v150, v12 offset:0
    ds_write_b32 v150, v14 offset:256
    s_mov_b64 exec, -1
    s_waitcnt lgkmcnt(4)
    v_mfma_f32_32x32x16_bf16 v[48:63], v[32:35], v[248:251], v[48:63]
    ds_read_b64_tr_b16 v[40:41], v31 offset:24576
    ds_read_b64_tr_b16 v[42:43], v31 offset:25088
    v_and_b32 v96, 31, v96
    v_lshrrev_b32 v97, 2, v96
    v_and_b32 v96, 3, v96
    s_waitcnt lgkmcnt(4)
    v_mfma_f32_32x32x16_bf16 v[64:79], v[36:39], v[248:251], v[64:79]
    v_xor_b32 v24, 32, v31
    ds_read_b64_tr_b16 v[44:45], v24 offset:24576
    ds_read_b64_tr_b16 v[46:47], v24 offset:25088
    s_waitcnt lgkmcnt(4)
    s_barrier
    ds_read_b128 v[156:159], v151 offset:0
    ds_read_b128 v[160:163], v151 offset:512
    s_and_b32 s71, s63, 1
    s_lshl_b32 s71, s71, 2
    v_add_u32 v96, s71, v96
    v_and_b32 v98, 1, v97
    v_lshl_add_u32 v96, v98, 3, v96
    v_lshrrev_b32 v97, 1, v97
    v_lshl_add_u32 v96, v96, 4, v97
    s_lshr_b32 s71, s63, 1
    s_lshl_b32 s71, s71, 2
    s_waitcnt lgkmcnt(4)
    v_mfma_f32_32x32x16_bf16 v[48:63], v[40:43], v[252:255], v[48:63]
    v_add_u32 v96, s71, v96
    s_lshr_b32 s71, s54, 1
    s_lshl_b32 s71, s71, 4
    v_add_u32 v97, s71, v0
    v_cmp_gt_u32 vcc, 16, v0
    s_nop 1
    v_cndmask_b32 v96, v96, v97, vcc
    v_lshlrev_b32 v96, 7, v96
    v_add_u32 v126, 23101440, v96
    s_lshr_b32 s71, s42, 1
    s_waitcnt lgkmcnt(2)
    v_mfma_f32_32x32x16_bf16 v[64:79], v[44:47], v[252:255], v[64:79]
    s_waitcnt vmcnt(1)
    v_cmp_ne_u32 vcc, s64, v155
    s_cmp_eq_u32 s70, 0
    s_cselect_b64 vcc, vcc, 0
    s_cbranch_vccz L_BACK_pfa_V2
    s_waitcnt vmcnt(0)
    v_cmp_ne_u32 vcc, s64, v164
    s_nop 1
    s_cbranch_vccz L_BACK_pfa_V2
    s_mov_b32 s3, 20000
L_SPIN_pfa_V2:
    s_sleep 1
    buffer_load_dword v155, v154, s[32:35], s70 offen sc1
    s_waitcnt vmcnt(0)
    v_cmp_ne_u32 vcc, s64, v155
    s_nop 0
    s_sub_u32 s3, s3, 1
    s_cbranch_vccz L_BACK_pfa_V2
    s_cmp_lg_u32 s3, 0
    s_cbranch_scc1 L_SPIN_pfa_V2
L_BACK_pfa_V2:
    s_barrier
    s_lshl_b32 s3, s62, 6
    s_add_u32 s3, s3, s47
    s_lshl_b32 s3, s3, 10
    buffer_load_dwordx4 v[108:111], v9, s[32:35], s3 offen sc1
    s_add_u32 s49, s51, 0
    s_and_b32 s49, s49, 0x1ffff
    s_add_u32 m0, s56, 139264
    s_add_u32 s49, s49, s48
    buffer_load_dwordx4 v9, s[32:35], s49 offen sc1 lds
    s_add_u32 s49, s51, 8192
    s_and_b32 s49, s49, 0x1ffff
    s_add_u32 m0, s56, 147456
    s_add_u32 s49, s49, s48
    buffer_load_dwordx4 v9, s[32:35], s49 offen sc1 lds
    s_add_u32 s49, s51, 16384
    s_and_b32 s49, s49, 0x1ffff
    s_add_u32 m0, s56, 155648
    s_add_u32 s49, s49, s48
    buffer_load_dwordx4 v9, s[32:35], s49 offen sc1 lds
    s_waitcnt lgkmcnt(0)
    v_mfma_f32_32x32x16_bf16 v[48:63], v[156:159], v[20:23], v[48:63]
    v_mfma_f32_32x32x16_bf16 v[64:79], v[160:163], v[20:23], v[64:79]
    s_lshl_b32 s71, s71, 14
    s_sub_u32 s71, s71, s53
    v_add_u32 v102, s71, v123
    v_xor_b32 v103, 64, v102
    s_lshl_b32 s71, s55, 7
    s_mul_i32 s50, s42, 229376
    s_add_u32 s50, s50, s71
    s_lshl_b32 s59, s42, 16
    s_add_u32 s59, s59, s71
    s_mul_i32 s71, s54, 288
    s_mul_i32 s52, s42, 14
    s_add_u32 s52, s52, s71
    s_lshl_b32 s52, s52, 10
    s_add_u32 s52, s52, 6324224
    v_and_b32 v96, 27, v0
    v_cmp_eq_u32 vcc, 16, v96
    v_mov_b32 v97, 0x3f803f80
    s_nop 0
    v_cndmask_b32 v16, 0, v97, vcc
    v_cndmask_b32 v17, 0, v97, vcc
    v_cndmask_b32 v18, 0, v97, vcc
    v_cndmask_b32 v19, 0, v97, vcc
    v_cndmask_b32 v20, 0, v97, vcc
    v_cndmask_b32 v21, 0, v97, vcc
    v_cndmask_b32 v22, 0, v97, vcc
    v_cndmask_b32 v23, 0, v97, vcc
    v_cndmask_b32 v24, 0, v97, vcc
    v_cndmask_b32 v25, 0, v97, vcc
    v_cndmask_b32 v26, 0, v97, vcc
    v_cndmask_b32 v27, 0, v97, vcc
    v_cndmask_b32 v28, 0, v97, vcc
    v_cndmask_b32 v29, 0, v97, vcc
    v_cndmask_b32 v30, 0, v97, vcc
    v_cndmask_b32 v31, 0, v97, vcc
    s_and_b32 s3, s62, 3
    s_mul_i32 s3, s3, 3
    s_lshl_b32 s6, s63, 1
    s_add_u32 s6, s6, s3
    s_sub_u32 s3, s6, 14
    s_cmp_ge_u32 s6, 14
    s_cselect_b32 s60, s3, s6
    v_mov_b32 v184, v6
    v_mov_b32 v186, v7
    v_mov_b32 v188, v8
    v_pk_mul_f32 v[168:169], v[48:49], v[48:49]
    v_pk_mul_f32 v[170:171], v[50:51], v[50:51]
    v_pk_mul_f32 v[172:173], v[52:53], v[52:53]
    v_pk_mul_f32 v[174:175], v[54:55], v[54:55]
    v_pk_fma_f32 v[168:169], v[168:169], v[186:187], v[184:185] op_sel_hi:[1,0,0]
    v_pk_fma_f32 v[170:171], v[170:171], v[186:187], v[184:185] op_sel_hi:[1,0,0]
    v_pk_fma_f32 v[172:173], v[172:173], v[186:187], v[184:185] op_sel_hi:[1,0,0]
    v_pk_fma_f32 v[174:175], v[174:175], v[186:187], v[184:185] op_sel_hi:[1,0,0]
    v_pk_mul_f32 v[168:169], v[168:169], v[48:49]
    v_pk_mul_f32 v[170:171], v[170:171], v[50:51]
    v_pk_mul_f32 v[172:173], v[172:173], v[52:53]
    v_pk_mul_f32 v[174:175], v[174:175], v[54:55]
    v_exp_f32 v168, v168
    v_exp_f32 v169, v169
    v_exp_f32 v170, v170
    v_exp_f32 v171, v171
    v_exp_f32 v172, v172
    v_exp_f32 v173, v173
    v_exp_f32 v174, v174
    v_exp_f32 v175, v175
    v_pk_mul_f32 v[48:49], v[48:49], v[56:57]
    v_pk_mul_f32 v[50:51], v[50:51], v[58:59]
    v_pk_mul_f32 v[52:53], v[52:53], v[60:61]
    v_pk_mul_f32 v[54:55], v[54:55], v[62:63]
    v_pk_fma_f32 v[168:169], v[168:169], v[188:189], v[188:189] op_sel_hi:[1,0,0]
    v_pk_fma_f32 v[170:171], v[170:171], v[188:189], v[188:189] op_sel_hi:[1,0,0]
    v_pk_fma_f32 v[172:173], v[172:173], v[188:189], v[188:189] op_sel_hi:[1,0,0]
    v_pk_fma_f32 v[174:175], v[174:175], v[188:189], v[188:189] op_sel_hi:[1,0,0]
    v_rcp_f32 v168, v168
    v_rcp_f32 v169, v169
    v_rcp_f32 v170, v170
    v_rcp_f32 v171, v171
    v_rcp_f32 v172, v172
    v_rcp_f32 v173, v173
    v_rcp_f32 v174, v174
    v_rcp_f32 v175, v175
    v_pk_mul_f32 v[48:49], v[48:49], v[168:169]
    v_pk_mul_f32 v[50:51], v[50:51], v[170:171]
    v_pk_mul_f32 v[52:53], v[52:53], v[172:173]
    v_pk_mul_f32 v[54:55], v[54:55], v[174:175]
    v_cvt_pk_bf16_f32 v140, v48, v49
    v_cvt_pk_bf16_f32 v141, v50, v51
    v_cvt_pk_bf16_f32 v142, v52, v53
    v_cvt_pk_bf16_f32 v143, v54, v55
L_COMMON:
    s_waitcnt vmcnt(1)
    s_barrier
    ds_read_b128 v[32:35], v118 offset:8192
    ds_read_b128 v[36:39], v118 offset:10240
    s_mov_b32 s4, 0x0000ffff
    s_mov_b32 s5, 0x0000ffff
    s_mov_b64 exec, s[4:5]
    ds_read_b128 v[16:19], v121 offset:9216
    ds_read_b128 v[20:23], v121 offset:9728
    s_mov_b64 exec, -1
    s_add_u32 s49, s51, 24576
    s_and_b32 s49, s49, 0x1ffff
    s_add_u32 m0, s56, 0
    s_add_u32 s49, s49, s48
    buffer_load_dwordx4 v105, s[32:35], s49 offen sc1 lds
    s_waitcnt lgkmcnt(3)
    v_mfma_f32_32x32x16_bf16 v[48:63], v[32:35], v[108:111], 0
    s_add_u32 s49, s51, 32768
    s_and_b32 s49, s49, 0x1ffff
    s_add_u32 m0, s56, 8192
    s_add_u32 s49, s49, s48
    buffer_load_dwordx4 v105, s[32:35], s49 offen sc1 lds
    v_pk_mul_f32 v[176:177], v[64:65], v[64:65]
    v_pk_mul_f32 v[178:179], v[66:67], v[66:67]
    v_pk_mul_f32 v[180:181], v[68:69], v[68:69]
    v_pk_mul_f32 v[182:183], v[70:71], v[70:71]
    v_pk_fma_f32 v[176:177], v[176:177], v[186:187], v[184:185] op_sel_hi:[1,0,0]
    v_pk_fma_f32 v[178:179], v[178:179], v[186:187], v[184:185] op_sel_hi:[1,0,0]
    v_pk_fma_f32 v[180:181], v[180:181], v[186:187], v[184:185] op_sel_hi:[1,0,0]
    v_pk_fma_f32 v[182:183], v[182:183], v[186:187], v[184:185] op_sel_hi:[1,0,0]
    v_pk_mul_f32 v[176:177], v[176:177], v[64:65]
    v_pk_mul_f32 v[178:179], v[178:179], v[66:67]
    v_pk_mul_f32 v[180:181], v[180:181], v[68:69]
    v_pk_mul_f32 v[182:183], v[182:183], v[70:71]
    v_exp_f32 v176, v176
    v_exp_f32 v177, v177
    v_exp_f32 v178, v178
    v_exp_f32 v179, v179
    v_exp_f32 v180, v180
    v_exp_f32 v181, v181
    v_exp_f32 v182, v182
    v_exp_f32 v183, v183
    v_pk_mul_f32 v[64:65], v[64:65], v[72:73]
    v_pk_mul_f32 v[66:67], v[66:67], v[74:75]
    v_pk_mul_f32 v[68:69], v[68:69], v[76:77]
    v_pk_mul_f32 v[70:71], v[70:71], v[78:79]
    v_pk_fma_f32 v[176:177], v[176:177], v[188:189], v[188:189] op_sel_hi:[1,0,0]
    v_pk_fma_f32 v[178:179], v[178:179], v[188:189], v[188:189] op_sel_hi:[1,0,0]
    v_pk_fma_f32 v[180:181], v[180:181], v[188:189], v[188:189] op_sel_hi:[1,0,0]
    v_pk_fma_f32 v[182:183], v[182:183], v[188:189], v[188:189] op_sel_hi:[1,0,0]
    v_rcp_f32 v176, v176
    v_rcp_f32 v177, v177
    v_rcp_f32 v178, v178
    v_rcp_f32 v179, v179
    v_rcp_f32 v180, v180
    v_rcp_f32 v181, v181
    v_rcp_f32 v182, v182
    v_rcp_f32 v183, v183
    v_pk_mul_f32 v[64:65], v[64:65], v[176:177]
    v_pk_mul_f32 v[66:67], v[66:67], v[178:179]
    v_pk_mul_f32 v[68:69], v[68:69], v[180:181]
    v_pk_mul_f32 v[70:71], v[70:71], v[182:183]
    v_cvt_pk_bf16_f32 v144, v64, v65
    v_cvt_pk_bf16_f32 v145, v66, v67
    v_cvt_pk_bf16_f32 v146, v68, v69
    v_cvt_pk_bf16_f32 v147, v70, v71
    v_max3_f32 v96, v48, v49, v50
    v_max3_f32 v97, v51, v52, v53
    v_max3_f32 v96, v96, v54, v55
    v_max3_f32 v97, v97, v56, v57
    v_max3_f32 v96, v96, v58, v59
    v_max3_f32 v97, v97, v60, v61
    v_max3_f32 v96, v96, v62, v63
    v_max_f32 v96, v96, v97
    v_mov_b32 v97, v96
    s_nop 1
    v_permlane32_swap_b32 v96, v97
    v_max_f32 v96, v96, v97
    v_sub_f32 v96, 0, v96
    v_pk_add_f32 v[48:49], v[48:49], v[96:97] op_sel_hi:[1,0]
    v_pk_add_f32 v[50:51], v[50:51], v[96:97] op_sel_hi:[1,0]
    v_pk_add_f32 v[52:53], v[52:53], v[96:97] op_sel_hi:[1,0]
    v_pk_add_f32 v[54:55], v[54:55], v[96:97] op_sel_hi:[1,0]
    v_pk_add_f32 v[56:57], v[56:57], v[96:97] op_sel_hi:[1,0]
    v_pk_add_f32 v[58:59], v[58:59], v[96:97] op_sel_hi:[1,0]
    v_pk_add_f32 v[60:61], v[60:61], v[96:97] op_sel_hi:[1,0]
    v_pk_add_f32 v[62:63], v[62:63], v[96:97] op_sel_hi:[1,0]
    v_pk_mov_b32 v[0:1], v[96:97], v[96:97] op_sel:[0,0]
    v_pk_mov_b32 v[2:3], v[96:97], v[96:97] op_sel:[0,0]
    v_pk_mov_b32 v[4:5], v[96:97], v[96:97] op_sel:[0,0]
    v_pk_mov_b32 v[6:7], v[96:97], v[96:97] op_sel:[0,0]
    v_pk_mov_b32 v[8:9], v[96:97], v[96:97] op_sel:[0,0]
    v_pk_mov_b32 v[10:11], v[96:97], v[96:97] op_sel:[0,0]
    v_pk_mov_b32 v[12:13], v[96:97], v[96:97] op_sel:[0,0]
    v_pk_mov_b32 v[14:15], v[96:97], v[96:97] op_sel:[0,0]
    s_setprio 3
    s_waitcnt lgkmcnt(2)
    v_mfma_f32_32x32x16_bf16 v[64:79], v[36:39], v[108:111], v[0:15]
    ds_read_b128 v[32:35], v118 offset:12288
    v_exp_f32 v48, v48
    v_exp_f32 v49, v49
    v_exp_f32 v50, v50
    s_add_u32 s49, s51, 40960
    s_and_b32 s49, s49, 0x1ffff
    s_add_u32 m0, s56, 16384
    s_add_u32 s49, s49, s48
    buffer_load_dwordx4 v105, s[32:35], s49 offen sc1 lds
    v_exp_f32 v51, v51
    v_exp_f32 v52, v52
    v_exp_f32 v53, v53
    v_exp_f32 v54, v54
    v_exp_f32 v55, v55
    v_exp_f32 v56, v56
    v_cvt_pk_bf16_f32 v40, v48, v49
    v_cvt_pk_bf16_f32 v41, v50, v51
    v_mov_b32 v112, -1
    v_mov_b32 v113, -1
    v_mov_b32 v114, -1
    v_mov_b32 v115, -1
    buffer_store_dwordx4 v[112:115], v105, s[32:35], s58 offen sc1
    v_cvt_pk_bf16_f32 v42, v52, v53
    v_cvt_pk_bf16_f32 v43, v54, v55
    v_exp_f32 v57, v57
    s_waitcnt lgkmcnt(1)
    v_exp_f32 v58, v58
    v_mfma_f32_32x32x16_bf16 v[80:95], v[16:19], v[40:43], 0
    s_mov_b64 exec, s[4:5]
    ds_read_b128 v[24:27], v121 offset:11264
    ds_read_b128 v[28:31], v121 offset:11776
    s_mov_b64 exec, -1
    v_exp_f32 v59, v59
    v_exp_f32 v60, v60
    v_exp_f32 v61, v61
    v_exp_f32 v62, v62
    v_exp_f32 v63, v63
    v_cvt_pk_bf16_f32 v44, v56, v57
    v_cvt_pk_bf16_f32 v45, v58, v59
    v_cvt_pk_bf16_f32 v46, v60, v61
    v_cvt_pk_bf16_f32 v47, v62, v63
    s_setprio 2
    s_waitcnt lgkmcnt(2)
    v_mfma_f32_32x32x16_bf16 v[48:63], v[32:35], v[108:111], v[0:15]
    ds_read_b128 v[36:39], v118 offset:14336
    v_exp_f32 v64, v64
    v_exp_f32 v65, v65
    v_exp_f32 v66, v66
    s_add_u32 s49, s51, 49152
    s_and_b32 s49, s49, 0x1ffff
    s_add_u32 m0, s56, 24576
    s_add_u32 s49, s49, s48
    buffer_load_dwordx4 v105, s[32:35], s49 offen sc1 lds
    v_exp_f32 v67, v67
    v_exp_f32 v68, v68
    v_exp_f32 v69, v69
    v_mfma_f32_32x32x16_bf16 v[80:95], v[20:23], v[44:47], v[80:95]
    v_exp_f32 v70, v70
    v_exp_f32 v71, v71
    v_exp_f32 v72, v72
    v_cvt_pk_bf16_f32 v40, v64, v65
    v_cvt_pk_bf16_f32 v41, v66, v67
    buffer_store_dwordx4 v[132:135], v105, s[32:35], s40 offen offset:0 sc1
    v_cvt_pk_bf16_f32 v42, v68, v69
    v_cvt_pk_bf16_f32 v43, v70, v71
    v_exp_f32 v73, v73
    s_waitcnt lgkmcnt(1)
    v_exp_f32 v74, v74
    v_mfma_f32_32x32x16_bf16 v[80:95], v[24:27], v[40:43], v[80:95]
    s_mov_b64 exec, s[4:5]
    ds_read_b128 v[16:19], v121 offset:13312
    ds_read_b128 v[20:23], v121 offset:13824
    s_mov_b64 exec, -1
    v_exp_f32 v75, v75
    v_exp_f32 v76, v76
    v_exp_f32 v77, v77
    v_exp_f32 v78, v78
    v_exp_f32 v79, v79
    v_cvt_pk_bf16_f32 v44, v72, v73
    v_cvt_pk_bf16_f32 v45, v74, v75
    v_cvt_pk_bf16_f32 v46, v76, v77
    v_cvt_pk_bf16_f32 v47, v78, v79
    s_waitcnt vmcnt(7)
    s_barrier
    s_setprio 1
    s_waitcnt lgkmcnt(2)
    v_mfma_f32_32x32x16_bf16 v[64:79], v[36:39], v[108:111], v[0:15]
    ds_read_b128 v[32:35], v118 offset:16384
    v_exp_f32 v48, v48
    v_exp_f32 v49, v49
    v_exp_f32 v50, v50
    s_add_u32 s49, s51, 57344
    s_and_b32 s49, s49, 0x1ffff
    s_add_u32 m0, s56, 32768
    s_add_u32 s49, s49, s48
    buffer_load_dwordx4 v105, s[32:35], s49 offen sc1 lds
    v_exp_f32 v51, v51
    v_exp_f32 v52, v52
    v_exp_f32 v53, v53
    v_mfma_f32_32x32x16_bf16 v[80:95], v[28:31], v[44:47], v[80:95]
    v_exp_f32 v54, v54
    v_exp_f32 v55, v55
    v_exp_f32 v56, v56
    v_cvt_pk_bf16_f32 v40, v48, v49
    v_cvt_pk_bf16_f32 v41, v50, v51
    buffer_store_dwordx4 v[136:139], v105, s[32:35], s40 offen offset:1024 sc1
    v_cvt_pk_bf16_f32 v42, v52, v53
    v_cvt_pk_bf16_f32 v43, v54, v55
    v_exp_f32 v57, v57
    s_waitcnt lgkmcnt(1)
    v_exp_f32 v58, v58
    v_mfma_f32_32x32x16_bf16 v[80:95], v[16:19], v[40:43], v[80:95]
    s_mov_b64 exec, s[4:5]
    ds_read_b128 v[24:27], v121 offset:15360
    ds_read_b128 v[28:31], v121 offset:15872
    s_mov_b64 exec, -1
    v_exp_f32 v59, v59
    v_exp_f32 v60, v60
    v_exp_f32 v61, v61
    v_exp_f32 v62, v62
    v_exp_f32 v63, v63
    v_cvt_pk_bf16_f32 v44, v56, v57
    v_cvt_pk_bf16_f32 v45, v58, v59
    v_cvt_pk_bf16_f32 v46, v60, v61
    v_cvt_pk_bf16_f32 v47, v62, v63
    s_setprio 0
    s_waitcnt lgkmcnt(2)
    v_mfma_f32_32x32x16_bf16 v[48:63], v[32:35], v[108:111], v[0:15]
    ds_read_b128 v[36:39], v118 offset:18432
    v_exp_f32 v64, v64
    v_exp_f32 v65, v65
    v_exp_f32 v66, v66
    s_add_u32 s49, s51, 65536
    s_and_b32 s49, s49, 0x1ffff
    s_add_u32 m0, s56, 40960
    s_add_u32 s49, s49, s48
    buffer_load_dwordx4 v105, s[32:35], s49 offen sc1 lds
    v_exp_f32 v67, v67
    v_exp_f32 v68, v68
    v_exp_f32 v69, v69
    v_mfma_f32_32x32x16_bf16 v[80:95], v[20:23], v[44:47], v[80:95]
    v_exp_f32 v70, v70
    v_exp_f32 v71, v71
    v_exp_f32 v72, v72
    v_cvt_pk_bf16_f32 v40, v64, v65
    v_cvt_pk_bf16_f32 v41, v66, v67
    buffer_store_dwordx4 v[140:143], v105, s[32:35], s41 offen offset:0 sc1
    v_cvt_pk_bf16_f32 v42, v68, v69
    v_cvt_pk_bf16_f32 v43, v70, v71
    v_exp_f32 v73, v73
    s_waitcnt lgkmcnt(1)
    v_exp_f32 v74, v74
    v_mfma_f32_32x32x16_bf16 v[80:95], v[24:27], v[40:43], v[80:95]
    s_mov_b64 exec, s[4:5]
    ds_read_b128 v[16:19], v121 offset:17408
    ds_read_b128 v[20:23], v121 offset:17920
    s_mov_b64 exec, -1
    v_exp_f32 v75, v75
    v_exp_f32 v76, v76
    v_exp_f32 v77, v77
    v_exp_f32 v78, v78
    v_exp_f32 v79, v79
    v_cvt_pk_bf16_f32 v44, v72, v73
    v_cvt_pk_bf16_f32 v45, v74, v75
    v_cvt_pk_bf16_f32 v46, v76, v77
    v_cvt_pk_bf16_f32 v47, v78, v79
    s_setprio 3
    s_waitcnt lgkmcnt(2)
    v_mfma_f32_32x32x16_bf16 v[64:79], v[36:39], v[108:111], v[0:15]
    ds_read_b128 v[32:35], v118 offset:20480
    v_exp_f32 v48, v48
    v_exp_f32 v49, v49
    v_exp_f32 v50, v50
    s_add_u32 s49, s51, 73728
    s_and_b32 s49, s49, 0x1ffff
    s_add_u32 m0, s56, 49152
    s_add_u32 s49, s49, s48
    buffer_load_dwordx4 v105, s[32:35], s49 offen sc1 lds
    v_exp_f32 v51, v51
    v_exp_f32 v52, v52
    v_exp_f32 v53, v53
    v_mfma_f32_32x32x16_bf16 v[80:95], v[28:31], v[44:47], v[80:95]
    v_exp_f32 v54, v54
    v_exp_f32 v55, v55
    v_exp_f32 v56, v56
    v_cvt_pk_bf16_f32 v40, v48, v49
    v_cvt_pk_bf16_f32 v41, v50, v51
    buffer_store_dwordx4 v[144:147], v105, s[32:35], s41 offen offset:1024 sc1
    v_cvt_pk_bf16_f32 v42, v52, v53
    v_cvt_pk_bf16_f32 v43, v54, v55
    v_exp_f32 v57, v57
    s_waitcnt lgkmcnt(1)
    v_exp_f32 v58, v58
    v_mfma_f32_32x32x16_bf16 v[80:95], v[16:19], v[40:43], v[80:95]
    s_mov_b64 exec, s[4:5]
    ds_read_b128 v[24:27], v121 offset:19456
    ds_read_b128 v[28:31], v121 offset:19968
    s_mov_b64 exec, -1
    v_exp_f32 v59, v59
    v_exp_f32 v60, v60
    v_exp_f32 v61, v61
    v_exp_f32 v62, v62
    v_exp_f32 v63, v63
    v_cvt_pk_bf16_f32 v44, v56, v57
    v_cvt_pk_bf16_f32 v45, v58, v59
    v_cvt_pk_bf16_f32 v46, v60, v61
    v_cvt_pk_bf16_f32 v47, v62, v63
    s_setprio 2
    s_waitcnt lgkmcnt(2)
    v_mfma_f32_32x32x16_bf16 v[48:63], v[32:35], v[108:111], v[0:15]
    ds_read_b128 v[36:39], v118 offset:22528
    v_exp_f32 v64, v64
    v_exp_f32 v65, v65
    v_exp_f32 v66, v66
    s_add_u32 s49, s51, 81920
    s_and_b32 s49, s49, 0x1ffff
    s_add_u32 m0, s56, 57344
    s_add_u32 s49, s49, s48
    buffer_load_dwordx4 v105, s[32:35], s49 offen sc1 lds
    v_exp_f32 v67, v67
    v_exp_f32 v68, v68
    v_exp_f32 v69, v69
    v_mfma_f32_32x32x16_bf16 v[80:95], v[20:23], v[44:47], v[80:95]
    v_exp_f32 v70, v70
    v_exp_f32 v71, v71
    v_exp_f32 v72, v72
    v_cvt_pk_bf16_f32 v40, v64, v65
    v_cvt_pk_bf16_f32 v41, v66, v67
    buffer_load_dwordx4 v[112:115], v125, s[8:11], s57 offen
    v_cvt_pk_bf16_f32 v42, v68, v69
    v_cvt_pk_bf16_f32 v43, v70, v71
    v_exp_f32 v73, v73
    s_waitcnt lgkmcnt(1)
    v_exp_f32 v74, v74
    v_mfma_f32_32x32x16_bf16 v[80:95], v[24:27], v[40:43], v[80:95]
    s_mov_b64 exec, s[4:5]
    ds_read_b128 v[16:19], v121 offset:21504
    ds_read_b128 v[20:23], v121 offset:22016
    s_mov_b64 exec, -1
    v_exp_f32 v75, v75
    v_exp_f32 v76, v76
    v_exp_f32 v77, v77
    v_exp_f32 v78, v78
    v_exp_f32 v79, v79
    v_cvt_pk_bf16_f32 v44, v72, v73
    v_cvt_pk_bf16_f32 v45, v74, v75
    v_cvt_pk_bf16_f32 v46, v76, v77
    v_cvt_pk_bf16_f32 v47, v78, v79
    s_setprio 1
    s_waitcnt lgkmcnt(2)
    v_mfma_f32_32x32x16_bf16 v[64:79], v[36:39], v[108:111], v[0:15]
    ds_read_b128 v[32:35], v118 offset:24576
    v_exp_f32 v48, v48
    v_exp_f32 v49, v49
    v_exp_f32 v50, v50
    v_exp_f32 v51, v51
    v_exp_f32 v52, v52
    v_exp_f32 v53, v53
    v_mfma_f32_32x32x16_bf16 v[80:95], v[28:31], v[44:47], v[80:95]
    v_exp_f32 v54, v54
    v_exp_f32 v55, v55
    v_exp_f32 v56, v56
    v_cvt_pk_bf16_f32 v40, v48, v49
    v_cvt_pk_bf16_f32 v41, v50, v51
    v_cvt_pk_bf16_f32 v42, v52, v53
    v_cvt_pk_bf16_f32 v43, v54, v55
    v_exp_f32 v57, v57
    s_waitcnt lgkmcnt(1)
    v_exp_f32 v58, v58
    v_mfma_f32_32x32x16_bf16 v[80:95], v[16:19], v[40:43], v[80:95]
    s_mov_b64 exec, s[4:5]
    ds_read_b128 v[24:27], v121 offset:23552
    ds_read_b128 v[28:31], v121 offset:24064
    s_mov_b64 exec, -1
    v_exp_f32 v59, v59
    v_exp_f32 v60, v60
    v_exp_f32 v61, v61
    v_exp_f32 v62, v62
    v_exp_f32 v63, v63
    v_cvt_pk_bf16_f32 v44, v56, v57
    v_cvt_pk_bf16_f32 v45, v58, v59
    v_cvt_pk_bf16_f32 v46, v60, v61
    v_cvt_pk_bf16_f32 v47, v62, v63
    s_setprio 0
    s_waitcnt lgkmcnt(2)
    v_mfma_f32_32x32x16_bf16 v[48:63], v[32:35], v[108:111], v[0:15]
    ds_read_b128 v[36:39], v118 offset:26624
    v_exp_f32 v64, v64
    v_exp_f32 v65, v65
    v_exp_f32 v66, v66
    s_add_u32 s49, s51, 90112
    s_and_b32 s49, s49, 0x1ffff
    s_add_u32 m0, s56, 65536
    s_add_u32 s49, s49, s48
    buffer_load_dwordx4 v105, s[32:35], s49 offen sc1 lds
    v_exp_f32 v67, v67
    v_exp_f32 v68, v68
    v_exp_f32 v69, v69
    v_mfma_f32_32x32x16_bf16 v[80:95], v[20:23], v[44:47], v[80:95]
    v_exp_f32 v70, v70
    v_exp_f32 v71, v71
    v_exp_f32 v72, v72
    v_cvt_pk_bf16_f32 v40, v64, v65
    v_cvt_pk_bf16_f32 v41, v66, v67
    v_cvt_pk_bf16_f32 v42, v68, v69
    v_cvt_pk_bf16_f32 v43, v70, v71
    v_exp_f32 v73, v73
    s_waitcnt lgkmcnt(1)
    v_exp_f32 v74, v74
    v_mfma_f32_32x32x16_bf16 v[80:95], v[24:27], v[40:43], v[80:95]
    s_mov_b64 exec, s[4:5]
    ds_read_b128 v[16:19], v121 offset:25600
    ds_read_b128 v[20:23], v121 offset:26112
    s_mov_b64 exec, -1
    v_exp_f32 v75, v75
    v_exp_f32 v76, v76
    v_exp_f32 v77, v77
    v_exp_f32 v78, v78
    v_exp_f32 v79, v79
    v_cvt_pk_bf16_f32 v44, v72, v73
    v_cvt_pk_bf16_f32 v45, v74, v75
    v_cvt_pk_bf16_f32 v46, v76, v77
    v_cvt_pk_bf16_f32 v47, v78, v79
    s_setprio 3
    s_waitcnt lgkmcnt(2)
    v_mfma_f32_32x32x16_bf16 v[64:79], v[36:39], v[108:111], v[0:15]
    ds_read_b128 v[32:35], v118 offset:28672
    v_exp_f32 v48, v48
    v_exp_f32 v49, v49
    v_exp_f32 v50, v50
    s_add_u32 s49, s51, 98304
    s_and_b32 s49, s49, 0x1ffff
    s_add_u32 m0, s56, 73728
    s_add_u32 s49, s49, s48
    buffer_load_dwordx4 v105, s[32:35], s49 offen sc1 lds
    v_exp_f32 v51, v51
    v_exp_f32 v52, v52
    v_exp_f32 v53, v53
    v_mfma_f32_32x32x16_bf16 v[80:95], v[28:31], v[44:47], v[80:95]
    v_exp_f32 v54, v54
    v_exp_f32 v55, v55
    v_exp_f32 v56, v56
    v_cvt_pk_bf16_f32 v40, v48, v49
    v_cvt_pk_bf16_f32 v41, v50, v51
    v_cvt_pk_bf16_f32 v42, v52, v53
    v_cvt_pk_bf16_f32 v43, v54, v55
    v_exp_f32 v57, v57
    s_waitcnt lgkmcnt(1)
    v_exp_f32 v58, v58
    v_mfma_f32_32x32x16_bf16 v[80:95], v[16:19], v[40:43], v[80:95]
    s_mov_b64 exec, s[4:5]
    ds_read_b128 v[24:27], v121 offset:27648
    ds_read_b128 v[28:31], v121 offset:28160
    s_mov_b64 exec, -1
    v_exp_f32 v59, v59
    v_exp_f32 v60, v60
    v_exp_f32 v61, v61
    v_exp_f32 v62, v62
    v_exp_f32 v63, v63
    v_cvt_pk_bf16_f32 v44, v56, v57
    v_cvt_pk_bf16_f32 v45, v58, v59
    v_cvt_pk_bf16_f32 v46, v60, v61
    v_cvt_pk_bf16_f32 v47, v62, v63
    s_setprio 2
    s_waitcnt lgkmcnt(2)
    v_mfma_f32_32x32x16_bf16 v[48:63], v[32:35], v[108:111], v[0:15]
    ds_read_b128 v[36:39], v118 offset:30720
    v_exp_f32 v64, v64
    v_exp_f32 v65, v65
    v_exp_f32 v66, v66
    s_add_u32 s49, s51, 106496
    s_and_b32 s49, s49, 0x1ffff
    s_add_u32 m0, s56, 81920
    s_add_u32 s49, s49, s48
    buffer_load_dwordx4 v105, s[32:35], s49 offen sc1 lds
    v_exp_f32 v67, v67
    v_exp_f32 v68, v68
    v_exp_f32 v69, v69
    v_mfma_f32_32x32x16_bf16 v[80:95], v[20:23], v[44:47], v[80:95]
    v_exp_f32 v70, v70
    v_exp_f32 v71, v71
    v_exp_f32 v72, v72
    v_cvt_pk_bf16_f32 v40, v64, v65
    v_cvt_pk_bf16_f32 v41, v66, v67
    v_cvt_pk_bf16_f32 v42, v68, v69
    v_cvt_pk_bf16_f32 v43, v70, v71
    v_exp_f32 v73, v73
    s_waitcnt lgkmcnt(1)
    v_exp_f32 v74, v74
    v_mfma_f32_32x32x16_bf16 v[80:95], v[24:27], v[40:43], v[80:95]
    s_mov_b64 exec, s[4:5]
    ds_read_b128 v[16:19], v121 offset:29696
    ds_read_b128 v[20:23], v121 offset:30208
    s_mov_b64 exec, -1
    v_exp_f32 v75, v75
    v_exp_f32 v76, v76
    v_exp_f32 v77, v77
    v_exp_f32 v78, v78
    v_exp_f32 v79, v79
    v_cvt_pk_bf16_f32 v44, v72, v73
    v_cvt_pk_bf16_f32 v45, v74, v75
    v_cvt_pk_bf16_f32 v46, v76, v77
    v_cvt_pk_bf16_f32 v47, v78, v79
    s_waitcnt vmcnt(5)
    s_barrier
    s_lshl_b32 s3, s45, 4
    s_add_u32 s3, s3, s46
    s_lshl_b32 s3, s3, 7
    s_add_u32 s3, s3, 23101440
    s_cmp_eq_u32 s42, 0
    s_cselect_b32 s3, s3, 0x7fffff00
    v_mov_b32 v98, s64
    v_lshlrev_b32 v99, 2, v104
    s_mov_b32 exec_hi, 0
    buffer_store_dword v98, v99, s[32:35], s3 offen sc1
    s_mov_b64 exec, -1
    s_setprio 1
    s_waitcnt lgkmcnt(2)
    v_mfma_f32_32x32x16_bf16 v[64:79], v[36:39], v[108:111], v[0:15]
    ds_read_b128 v[32:35], v116 offset:0
    v_exp_f32 v48, v48
    v_exp_f32 v49, v49
    v_exp_f32 v50, v50
    s_add_u32 s49, s51, 114688
    s_and_b32 s49, s49, 0x1ffff
    s_add_u32 m0, s56, 90112
    s_add_u32 s49, s49, s48
    buffer_load_dwordx4 v105, s[32:35], s49 offen sc1 lds
    v_exp_f32 v51, v51
    v_exp_f32 v52, v52
    v_exp_f32 v53, v53
    v_mfma_f32_32x32x16_bf16 v[80:95], v[28:31], v[44:47], v[80:95]
    v_exp_f32 v54, v54
    v_exp_f32 v55, v55
    v_exp_f32 v56, v56
    v_cvt_pk_bf16_f32 v40, v48, v49
    v_cvt_pk_bf16_f32 v41, v50, v51
    v_cvt_pk_bf16_f32 v42, v52, v53
    v_cvt_pk_bf16_f32 v43, v54, v55
    v_exp_f32 v57, v57
    s_waitcnt lgkmcnt(1)
    v_exp_f32 v58, v58
    v_mfma_f32_32x32x16_bf16 v[80:95], v[16:19], v[40:43], v[80:95]
    s_mov_b64 exec, s[4:5]
    ds_read_b128 v[24:27], v121 offset:31744
    ds_read_b128 v[28:31], v121 offset:32256
    s_mov_b64 exec, -1
    v_exp_f32 v59, v59
    v_exp_f32 v60, v60
    v_exp_f32 v61, v61
    v_exp_f32 v62, v62
    v_exp_f32 v63, v63
    v_cvt_pk_bf16_f32 v44, v56, v57
    v_cvt_pk_bf16_f32 v45, v58, v59
    v_cvt_pk_bf16_f32 v46, v60, v61
    v_cvt_pk_bf16_f32 v47, v62, v63
    s_setprio 0
    s_waitcnt lgkmcnt(2)
    v_mfma_f32_32x32x16_bf16 v[48:63], v[32:35], v[108:111], v[0:15]
    ds_read_b128 v[36:39], v116 offset:2048
    v_exp_f32 v64, v64
    v_exp_f32 v65, v65
    v_exp_f32 v66, v66
    s_add_u32 s49, s51, 122880
    s_and_b32 s49, s49, 0x1ffff
    s_add_u32 m0, s56, 98304
    s_add_u32 s49, s49, s48
    buffer_load_dwordx4 v105, s[32:35], s49 offen sc1 lds
    v_exp_f32 v67, v67
    v_exp_f32 v68, v68
    v_exp_f32 v69, v69
    v_mfma_f32_32x32x16_bf16 v[80:95], v[20:23], v[44:47], v[80:95]
    v_exp_f32 v70, v70
    v_exp_f32 v71, v71
    v_exp_f32 v72, v72
    v_cvt_pk_bf16_f32 v40, v64, v65
    v_cvt_pk_bf16_f32 v41, v66, v67
    v_cvt_pk_bf16_f32 v42, v68, v69
    v_cvt_pk_bf16_f32 v43, v70, v71
    v_exp_f32 v73, v73
    s_waitcnt lgkmcnt(1)
    v_exp_f32 v74, v74
    v_mfma_f32_32x32x16_bf16 v[80:95], v[24:27], v[40:43], v[80:95]
    s_mov_b64 exec, s[4:5]
    ds_read_b128 v[16:19], v119 offset:1024
    ds_read_b128 v[20:23], v119 offset:1536
    s_mov_b64 exec, -1
    v_exp_f32 v75, v75
    v_exp_f32 v76, v76
    v_exp_f32 v77, v77
    v_exp_f32 v78, v78
    v_exp_f32 v79, v79
    v_cvt_pk_bf16_f32 v44, v72, v73
    v_cvt_pk_bf16_f32 v45, v74, v75
    v_cvt_pk_bf16_f32 v46, v76, v77
    v_cvt_pk_bf16_f32 v47, v78, v79
    s_setprio 3
    s_waitcnt lgkmcnt(2)
    v_mfma_f32_32x32x16_bf16 v[64:79], v[36:39], v[108:111], v[0:15]
    ds_read_b128 v[32:35], v116 offset:4096
    v_exp_f32 v48, v48
    v_exp_f32 v49, v49
    v_exp_f32 v50, v50
    s_mul_i32 s6, s63, 224
    s_mul_i32 s7, s42, 56
    s_add_u32 s6, s6, s7
    v_min_u32 v96, 55, v104
    v_add_u32 v96, s6, v96
    v_exp_f32 v51, v51
    v_exp_f32 v52, v52
    v_exp_f32 v53, v53
    v_mfma_f32_32x32x16_bf16 v[80:95], v[28:31], v[44:47], v[80:95]
    v_exp_f32 v54, v54
    v_exp_f32 v55, v55
    v_exp_f32 v56, v56
    v_cvt_pk_bf16_f32 v40, v48, v49
    v_cvt_pk_bf16_f32 v41, v50, v51
    v_lshlrev_b32 v96, 10, v96
    s_lshl_b32 s7, s55, 7
    s_cmp_lt_u32 s42, 4
    s_cselect_b32 s6, s7, 0x7fffff00
    buffer_load_dword v146, v96, s[16:19], s6 offen
    v_cvt_pk_bf16_f32 v42, v52, v53
    v_cvt_pk_bf16_f32 v43, v54, v55
    v_exp_f32 v57, v57
    s_waitcnt lgkmcnt(1)
    v_exp_f32 v58, v58
    v_mfma_f32_32x32x16_bf16 v[80:95], v[16:19], v[40:43], v[80:95]
    s_mov_b64 exec, s[4:5]
    ds_read_b128 v[24:27], v119 offset:3072
    ds_read_b128 v[28:31], v119 offset:3584
    s_mov_b64 exec, -1
    v_exp_f32 v59, v59
    v_exp_f32 v60, v60
    v_exp_f32 v61, v61
    v_exp_f32 v62, v62
    v_exp_f32 v63, v63
    v_cvt_pk_bf16_f32 v44, v56, v57
    v_cvt_pk_bf16_f32 v45, v58, v59
    v_cvt_pk_bf16_f32 v46, v60, v61
    v_cvt_pk_bf16_f32 v47, v62, v63
    s_setprio 2
    s_waitcnt lgkmcnt(2)
    v_mfma_f32_32x32x16_bf16 v[48:63], v[32:35], v[108:111], v[0:15]
    ds_read_b128 v[36:39], v116 offset:6144
    v_exp_f32 v64, v64
    v_exp_f32 v65, v65
    v_exp_f32 v66, v66
    s_lshl_b32 s6, s63, 6
    v_add_u32 v96, s6, v104
    v_lshlrev_b32 v96, 10, v96
    s_cmp_eq_u32 s42, 4
    s_cselect_b32 s6, s7, 0x7fffff00
    v_exp_f32 v67, v67
    v_exp_f32 v68, v68
    v_exp_f32 v69, v69
    v_mfma_f32_32x32x16_bf16 v[80:95], v[20:23], v[44:47], v[80:95]
    v_exp_f32 v70, v70
    v_exp_f32 v71, v71
    v_exp_f32 v72, v72
    v_cvt_pk_bf16_f32 v40, v64, v65
    v_cvt_pk_bf16_f32 v41, v66, v67
    buffer_load_dword v147, v96, s[12:15], s6 offen
    v_cvt_pk_bf16_f32 v42, v68, v69
    v_cvt_pk_bf16_f32 v43, v70, v71
    v_exp_f32 v73, v73
    s_waitcnt lgkmcnt(1)
    v_exp_f32 v74, v74
    v_mfma_f32_32x32x16_bf16 v[80:95], v[24:27], v[40:43], v[80:95]
    s_mov_b64 exec, s[4:5]
    ds_read_b128 v[16:19], v119 offset:5120
    ds_read_b128 v[20:23], v119 offset:5632
    s_mov_b64 exec, -1
    v_exp_f32 v75, v75
    v_exp_f32 v76, v76
    v_exp_f32 v77, v77
    v_exp_f32 v78, v78
    v_exp_f32 v79, v79
    v_cvt_pk_bf16_f32 v44, v72, v73
    v_cvt_pk_bf16_f32 v45, v74, v75
    v_cvt_pk_bf16_f32 v46, v76, v77
    v_cvt_pk_bf16_f32 v47, v78, v79
    s_setprio 1
    s_waitcnt lgkmcnt(2)
    v_mfma_f32_32x32x16_bf16 v[64:79], v[36:39], v[108:111], v[0:15]
    ds_read_b128 v[32:35], v116 offset:8192
    v_exp_f32 v48, v48
    v_exp_f32 v49, v49
    v_exp_f32 v50, v50
    v_exp_f32 v51, v51
    v_exp_f32 v52, v52
    v_exp_f32 v53, v53
    v_mfma_f32_32x32x16_bf16 v[80:95], v[28:31], v[44:47], v[80:95]
    v_exp_f32 v54, v54
    v_exp_f32 v55, v55
    v_exp_f32 v56, v56
    v_cvt_pk_bf16_f32 v40, v48, v49
    v_cvt_pk_bf16_f32 v41, v50, v51
    v_cvt_pk_bf16_f32 v42, v52, v53
    v_cvt_pk_bf16_f32 v43, v54, v55
    v_exp_f32 v57, v57
    s_waitcnt lgkmcnt(1)
    v_exp_f32 v58, v58
    v_mfma_f32_32x32x16_bf16 v[80:95], v[16:19], v[40:43], v[80:95]
    s_mov_b64 exec, s[4:5]
    ds_read_b128 v[24:27], v119 offset:7168
    ds_read_b128 v[28:31], v119 offset:7680
    s_mov_b64 exec, -1
    v_exp_f32 v59, v59
    v_exp_f32 v60, v60
    v_exp_f32 v61, v61
    v_exp_f32 v62, v62
    v_exp_f32 v63, v63
    v_cvt_pk_bf16_f32 v44, v56, v57
    v_cvt_pk_bf16_f32 v45, v58, v59
    v_cvt_pk_bf16_f32 v46, v60, v61
    v_cvt_pk_bf16_f32 v47, v62, v63
    s_setprio 0
    s_waitcnt lgkmcnt(2)
    v_mfma_f32_32x32x16_bf16 v[48:63], v[32:35], v[108:111], v[0:15]
    ds_read_b128 v[36:39], v116 offset:10240
    v_exp_f32 v64, v64
    v_exp_f32 v65, v65
    v_exp_f32 v66, v66
    v_exp_f32 v67, v67
    v_exp_f32 v68, v68
    v_exp_f32 v69, v69
    v_mfma_f32_32x32x16_bf16 v[80:95], v[20:23], v[44:47], v[80:95]
    v_exp_f32 v70, v70
    v_exp_f32 v71, v71
    v_exp_f32 v72, v72
    v_cvt_pk_bf16_f32 v40, v64, v65
    v_cvt_pk_bf16_f32 v41, v66, v67
    v_cvt_pk_bf16_f32 v42, v68, v69
    v_cvt_pk_bf16_f32 v43, v70, v71
    v_exp_f32 v73, v73
    s_waitcnt lgkmcnt(1)
    v_exp_f32 v74, v74
    v_mfma_f32_32x32x16_bf16 v[80:95], v[24:27], v[40:43], v[80:95]
    s_mov_b64 exec, s[4:5]
    ds_read_b128 v[16:19], v119 offset:9216
    ds_read_b128 v[20:23], v119 offset:9728
    s_mov_b64 exec, -1
    v_exp_f32 v75, v75
    v_exp_f32 v76, v76
    v_exp_f32 v77, v77
    v_exp_f32 v78, v78
    v_exp_f32 v79, v79
    v_cvt_pk_bf16_f32 v44, v72, v73
    v_cvt_pk_bf16_f32 v45, v74, v75
    v_cvt_pk_bf16_f32 v46, v76, v77
    v_cvt_pk_bf16_f32 v47, v78, v79
    s_setprio 3
    s_waitcnt lgkmcnt(2)
    v_mfma_f32_32x32x16_bf16 v[64:79], v[36:39], v[108:111], v[0:15]
    ds_read_b128 v[32:35], v116 offset:12288
    v_exp_f32 v48, v48
    v_exp_f32 v49, v49
    v_exp_f32 v50, v50
    v_exp_f32 v51, v51
    v_exp_f32 v52, v52
    v_exp_f32 v53, v53
    v_mfma_f32_32x32x16_bf16 v[80:95], v[28:31], v[44:47], v[80:95]
    v_exp_f32 v54, v54
    v_exp_f32 v55, v55
    v_exp_f32 v56, v56
    v_cvt_pk_bf16_f32 v40, v48, v49
    v_cvt_pk_bf16_f32 v41, v50, v51
    v_cvt_pk_bf16_f32 v42, v52, v53
    v_cvt_pk_bf16_f32 v43, v54, v55
    v_exp_f32 v57, v57
    s_waitcnt lgkmcnt(1)
    v_exp_f32 v58, v58
    v_mfma_f32_32x32x16_bf16 v[80:95], v[16:19], v[40:43], v[80:95]
    s_mov_b64 exec, s[4:5]
    ds_read_b128 v[24:27], v119 offset:11264
    ds_read_b128 v[28:31], v119 offset:11776
    s_mov_b64 exec, -1
    v_exp_f32 v59, v59
    v_exp_f32 v60, v60
    v_exp_f32 v61, v61
    v_exp_f32 v62, v62
    v_exp_f32 v63, v63
    v_cvt_pk_bf16_f32 v44, v56, v57
    v_cvt_pk_bf16_f32 v45, v58, v59
    v_cvt_pk_bf16_f32 v46, v60, v61
    v_cvt_pk_bf16_f32 v47, v62, v63
    s_setprio 2
    s_waitcnt lgkmcnt(2)
    v_mfma_f32_32x32x16_bf16 v[48:63], v[32:35], v[108:111], v[0:15]
    ds_read_b128 v[36:39], v116 offset:14336
    v_exp_f32 v64, v64
    v_exp_f32 v65, v65
    v_exp_f32 v66, v66
    buffer_load_dword v101, v126, s[32:35], s70 offen sc1
    v_exp_f32 v67, v67
    v_exp_f32 v68, v68
    v_exp_f32 v69, v69
    v_mfma_f32_32x32x16_bf16 v[80:95], v[20:23], v[44:47], v[80:95]
    v_exp_f32 v70, v70
    v_exp_f32 v71, v71
    v_exp_f32 v72, v72
    v_cvt_pk_bf16_f32 v40, v64, v65
    v_cvt_pk_bf16_f32 v41, v66, v67
    v_cvt_pk_bf16_f32 v42, v68, v69
    v_cvt_pk_bf16_f32 v43, v70, v71
    v_exp_f32 v73, v73
    s_waitcnt lgkmcnt(1)
    v_exp_f32 v74, v74
    v_mfma_f32_32x32x16_bf16 v[80:95], v[24:27], v[40:43], v[80:95]
    s_mov_b64 exec, s[4:5]
    ds_read_b128 v[16:19], v119 offset:13312
    ds_read_b128 v[20:23], v119 offset:13824
    s_mov_b64 exec, -1
    v_exp_f32 v75, v75
    v_exp_f32 v76, v76
    v_exp_f32 v77, v77
    v_exp_f32 v78, v78
    v_exp_f32 v79, v79
    v_cvt_pk_bf16_f32 v44, v72, v73
    v_cvt_pk_bf16_f32 v45, v74, v75
    v_cvt_pk_bf16_f32 v46, v76, v77
    v_cvt_pk_bf16_f32 v47, v78, v79
    s_setprio 1
    s_waitcnt lgkmcnt(2)
    v_mfma_f32_32x32x16_bf16 v[64:79], v[36:39], v[108:111], v[0:15]
    ds_read_b128 v[32:35], v116 offset:16384
    v_exp_f32 v48, v48
    v_exp_f32 v49, v49
    v_exp_f32 v50, v50
    v_exp_f32 v51, v51
    v_exp_f32 v52, v52
    v_exp_f32 v53, v53
    v_mfma_f32_32x32x16_bf16 v[80:95], v[28:31], v[44:47], v[80:95]
    v_exp_f32 v54, v54
    v_exp_f32 v55, v55
    v_exp_f32 v56, v56
    v_cvt_pk_bf16_f32 v40, v48, v49
    v_cvt_pk_bf16_f32 v41, v50, v51
    v_cvt_pk_bf16_f32 v42, v52, v53
    v_cvt_pk_bf16_f32 v43, v54, v55
    v_exp_f32 v57, v57
    s_waitcnt lgkmcnt(1)
    v_exp_f32 v58, v58
    v_mfma_f32_32x32x16_bf16 v[80:95], v[16:19], v[40:43], v[80:95]
    s_mov_b64 exec, s[4:5]
    ds_read_b128 v[24:27], v119 offset:15360
    ds_read_b128 v[28:31], v119 offset:15872
    s_mov_b64 exec, -1
    v_exp_f32 v59, v59
    v_exp_f32 v60, v60
    v_exp_f32 v61, v61
    v_exp_f32 v62, v62
    v_exp_f32 v63, v63
    v_cvt_pk_bf16_f32 v44, v56, v57
    v_cvt_pk_bf16_f32 v45, v58, v59
    v_cvt_pk_bf16_f32 v46, v60, v61
    v_cvt_pk_bf16_f32 v47, v62, v63
    s_setprio 0
    s_waitcnt lgkmcnt(2)
    v_mfma_f32_32x32x16_bf16 v[48:63], v[32:35], v[108:111], v[0:15]
    ds_read_b128 v[36:39], v116 offset:18432
    v_exp_f32 v64, v64
    v_exp_f32 v65, v65
    v_exp_f32 v66, v66
    buffer_load_dword v100, v126, s[32:35], s70 offen sc1
    v_exp_f32 v67, v67
    v_exp_f32 v68, v68
    v_exp_f32 v69, v69
    v_mfma_f32_32x32x16_bf16 v[80:95], v[20:23], v[44:47], v[80:95]
    v_exp_f32 v70, v70
    v_exp_f32 v71, v71
    v_exp_f32 v72, v72
    v_cvt_pk_bf16_f32 v40, v64, v65
    v_cvt_pk_bf16_f32 v41, v66, v67
    v_cvt_pk_bf16_f32 v42, v68, v69
    v_cvt_pk_bf16_f32 v43, v70, v71
    v_exp_f32 v73, v73
    s_waitcnt lgkmcnt(1)
    v_exp_f32 v74, v74
    v_mfma_f32_32x32x16_bf16 v[80:95], v[24:27], v[40:43], v[80:95]
    s_mov_b64 exec, s[4:5]
    ds_read_b128 v[16:19], v119 offset:17408
    ds_read_b128 v[20:23], v119 offset:17920
    s_mov_b64 exec, -1
    v_exp_f32 v75, v75
    v_exp_f32 v76, v76
    v_exp_f32 v77, v77
    v_exp_f32 v78, v78
    v_exp_f32 v79, v79
    v_cvt_pk_bf16_f32 v44, v72, v73
    v_cvt_pk_bf16_f32 v45, v74, v75
    v_cvt_pk_bf16_f32 v46, v76, v77
    v_cvt_pk_bf16_f32 v47, v78, v79
    s_setprio 3
    s_waitcnt lgkmcnt(2)
    v_mfma_f32_32x32x16_bf16 v[64:79], v[36:39], v[108:111], v[0:15]
    ds_read_b128 v[32:35], v116 offset:20480
    v_exp_f32 v48, v48
    v_exp_f32 v49, v49
    v_exp_f32 v50, v50
    s_waitcnt vmcnt(1)
    v_cmp_ne_u32 vcc, s64, v101
    s_cmp_eq_u32 s70, 0
    s_cselect_b64 vcc, vcc, 0
    s_cbranch_vccz L_BACK_pfh_C101
    s_waitcnt vmcnt(0)
    v_cmp_ne_u32 vcc, s64, v100
    s_nop 1
    s_cbranch_vccz L_BACK_pfh_C101
    s_mov_b32 s3, 20000
L_SPIN_pfh_C101:
    s_sleep 1
    buffer_load_dword v101, v126, s[32:35], s70 offen sc1
    s_waitcnt vmcnt(0)
    v_cmp_ne_u32 vcc, s64, v101
    s_nop 0
    s_sub_u32 s3, s3, 1
    s_cbranch_vccz L_BACK_pfh_C101
    s_cmp_lg_u32 s3, 0
    s_cbranch_scc1 L_SPIN_pfh_C101
L_BACK_pfh_C101:
    s_waitcnt vmcnt(1)
    s_barrier
    s_lshl_b32 s49, s60, 14
    s_add_u32 m0, s53, 0
    s_add_u32 s49, s49, s50
    buffer_load_dwordx4 v122, s[16:19], s49 offen lds
    v_exp_f32 v51, v51
    v_exp_f32 v52, v52
    v_exp_f32 v53, v53
    v_mfma_f32_32x32x16_bf16 v[80:95], v[28:31], v[44:47], v[80:95]
    v_exp_f32 v54, v54
    v_exp_f32 v55, v55
    v_exp_f32 v56, v56
    v_cvt_pk_bf16_f32 v40, v48, v49
    v_cvt_pk_bf16_f32 v41, v50, v51
    s_add_u32 m0, s53, 1024
    s_add_u32 s49, s49, 8192
    buffer_load_dwordx4 v122, s[16:19], s49 offen lds
    s_lshl_b32 s49, s60, 10
    s_add_u32 s49, s49, s52
    buffer_load_dwordx4 v[200:203], v105, s[32:35], s49 offen sc1
    v_cvt_pk_bf16_f32 v42, v52, v53
    v_cvt_pk_bf16_f32 v43, v54, v55
    v_exp_f32 v57, v57
    s_waitcnt lgkmcnt(1)
    v_exp_f32 v58, v58
    v_mfma_f32_32x32x16_bf16 v[80:95], v[16:19], v[40:43], v[80:95]
    s_mov_b64 exec, s[4:5]
    ds_read_b128 v[24:27], v119 offset:19456
    ds_read_b128 v[28:31], v119 offset:19968
    s_mov_b64 exec, -1
    v_exp_f32 v59, v59
    v_exp_f32 v60, v60
    v_exp_f32 v61, v61
    s_add_u32 s49, s49, 147456
    buffer_load_dwordx4 v[204:207], v105, s[32:35], s49 offen sc1
    s_add_u32 s60, s60, 1
    s_cmp_eq_u32 s60, 14
    s_cselect_b32 s60, 0, s60
    v_exp_f32 v62, v62
    v_exp_f32 v63, v63
    v_cvt_pk_bf16_f32 v44, v56, v57
    v_cvt_pk_bf16_f32 v45, v58, v59
    v_cvt_pk_bf16_f32 v46, v60, v61
    v_cvt_pk_bf16_f32 v47, v62, v63
    s_setprio 2
    s_waitcnt lgkmcnt(2)
    v_mfma_f32_32x32x16_bf16 v[48:63], v[32:35], v[108:111], v[0:15]
    ds_read_b128 v[36:39], v116 offset:22528
    v_exp_f32 v64, v64
    v_exp_f32 v65, v65
    v_exp_f32 v66, v66
    s_lshl_b32 s49, s60, 14
    s_add_u32 m0, s53, 2048
    s_add_u32 s49, s49, s50
    buffer_load_dwordx4 v122, s[16:19], s49 offen lds
    s_add_u32 m0, s53, 3072
    s_add_u32 s49, s49, 8192
    buffer_load_dwordx4 v122, s[16:19], s49 offen lds
    v_exp_f32 v67, v67
    v_exp_f32 v68, v68
    v_exp_f32 v69, v69
    v_mfma_f32_32x32x16_bf16 v[80:95], v[20:23], v[44:47], v[80:95]
    v_exp_f32 v70, v70
    v_exp_f32 v71, v71
    v_exp_f32 v72, v72
    v_cvt_pk_bf16_f32 v40, v64, v65
    v_cvt_pk_bf16_f32 v41, v66, v67
    s_lshl_b32 s49, s60, 10
    s_add_u32 s49, s49, s52
    buffer_load_dwordx4 v[208:211], v105, s[32:35], s49 offen sc1
    v_cvt_pk_bf16_f32 v42, v68, v69
    v_cvt_pk_bf16_f32 v43, v70, v71
    v_exp_f32 v73, v73
    s_waitcnt lgkmcnt(1)
    v_exp_f32 v74, v74
    v_mfma_f32_32x32x16_bf16 v[80:95], v[24:27], v[40:43], v[80:95]
    s_mov_b64 exec, s[4:5]
    ds_read_b128 v[16:19], v119 offset:21504
    ds_read_b128 v[20:23], v119 offset:22016
    s_mov_b64 exec, -1
    v_exp_f32 v75, v75
    v_exp_f32 v76, v76
    v_exp_f32 v77, v77
    s_add_u32 s49, s49, 147456
    buffer_load_dwordx4 v[212:215], v105, s[32:35], s49 offen sc1
    s_add_u32 s60, s60, 1
    s_cmp_eq_u32 s60, 14
    s_cselect_b32 s60, 0, s60
    v_exp_f32 v78, v78
    v_exp_f32 v79, v79
    v_cvt_pk_bf16_f32 v44, v72, v73
    v_cvt_pk_bf16_f32 v45, v74, v75
    v_cvt_pk_bf16_f32 v46, v76, v77
    v_cvt_pk_bf16_f32 v47, v78, v79
    s_setprio 1
    s_waitcnt lgkmcnt(2)
    v_mfma_f32_32x32x16_bf16 v[64:79], v[36:39], v[108:111], v[0:15]
    ds_read_b128 v[32:35], v116 offset:24576
    v_exp_f32 v48, v48
    v_exp_f32 v49, v49
    v_exp_f32 v50, v50
    v_exp_f32 v51, v51
    v_exp_f32 v52, v52
    v_exp_f32 v53, v53
    v_mfma_f32_32x32x16_bf16 v[80:95], v[28:31], v[44:47], v[80:95]
    v_exp_f32 v54, v54
    v_exp_f32 v55, v55
    v_exp_f32 v56, v56
    v_cvt_pk_bf16_f32 v40, v48, v49
    v_cvt_pk_bf16_f32 v41, v50, v51
    v_cvt_pk_bf16_f32 v42, v52, v53
    v_cvt_pk_bf16_f32 v43, v54, v55
    v_exp_f32 v57, v57
    s_waitcnt lgkmcnt(1)
    v_exp_f32 v58, v58
    v_mfma_f32_32x32x16_bf16 v[80:95], v[16:19], v[40:43], v[80:95]
    s_mov_b64 exec, s[4:5]
    ds_read_b128 v[24:27], v119 offset:23552
    ds_read_b128 v[28:31], v119 offset:24064
    s_mov_b64 exec, -1
    v_exp_f32 v59, v59
    v_exp_f32 v60, v60
    v_exp_f32 v61, v61
    v_exp_f32 v62, v62
    v_exp_f32 v63, v63
    v_cvt_pk_bf16_f32 v44, v56, v57
    v_cvt_pk_bf16_f32 v45, v58, v59
    v_cvt_pk_bf16_f32 v46, v60, v61
    v_cvt_pk_bf16_f32 v47, v62, v63
    s_setprio 0
    s_waitcnt lgkmcnt(2)
    v_mfma_f32_32x32x16_bf16 v[48:63], v[32:35], v[108:111], v[0:15]
    ds_read_b128 v[36:39], v116 offset:26624
    v_exp_f32 v64, v64
    v_exp_f32 v65, v65
    v_exp_f32 v66, v66
    v_exp_f32 v67, v67
    v_exp_f32 v68, v68
    v_exp_f32 v69, v69
    v_mfma_f32_32x32x16_bf16 v[80:95], v[20:23], v[44:47], v[80:95]
    v_exp_f32 v70, v70
    v_exp_f32 v71, v71
    v_exp_f32 v72, v72
    v_cvt_pk_bf16_f32 v40, v64, v65
    v_cvt_pk_bf16_f32 v41, v66, v67
    v_cvt_pk_bf16_f32 v42, v68, v69
    v_cvt_pk_bf16_f32 v43, v70, v71
    v_exp_f32 v73, v73
    s_waitcnt lgkmcnt(1)
    v_exp_f32 v74, v74
    v_mfma_f32_32x32x16_bf16 v[80:95], v[24:27], v[40:43], v[80:95]
    s_mov_b64 exec, s[4:5]
    ds_read_b128 v[16:19], v119 offset:25600
    ds_read_b128 v[20:23], v119 offset:26112
    s_mov_b64 exec, -1
    v_exp_f32 v75, v75
    v_exp_f32 v76, v76
    v_exp_f32 v77, v77
    v_exp_f32 v78, v78
    v_exp_f32 v79, v79
    v_cvt_pk_bf16_f32 v44, v72, v73
    v_cvt_pk_bf16_f32 v45, v74, v75
    v_cvt_pk_bf16_f32 v46, v76, v77
    v_cvt_pk_bf16_f32 v47, v78, v79
    s_setprio 3
    s_waitcnt lgkmcnt(2)
    v_mfma_f32_32x32x16_bf16 v[64:79], v[36:39], v[108:111], v[0:15]
    ds_read_b128 v[32:35], v116 offset:28672
    v_exp_f32 v48, v48
    v_exp_f32 v49, v49
    v_exp_f32 v50, v50
    v_exp_f32 v51, v51
    v_exp_f32 v52, v52
    v_exp_f32 v53, v53
    v_mfma_f32_32x32x16_bf16 v[80:95], v[28:31], v[44:47], v[80:95]
    v_exp_f32 v54, v54
    v_exp_f32 v55, v55
    v_exp_f32 v56, v56
    v_cvt_pk_bf16_f32 v40, v48, v49
    v_cvt_pk_bf16_f32 v41, v50, v51
    v_cvt_pk_bf16_f32 v42, v52, v53
    v_cvt_pk_bf16_f32 v43, v54, v55
    v_exp_f32 v57, v57
    s_waitcnt lgkmcnt(1)
    v_exp_f32 v58, v58
    v_mfma_f32_32x32x16_bf16 v[80:95], v[16:19], v[40:43], v[80:95]
    s_mov_b64 exec, s[4:5]
    ds_read_b128 v[24:27], v119 offset:27648
    ds_read_b128 v[28:31], v119 offset:28160
    s_mov_b64 exec, -1
    v_exp_f32 v59, v59
    v_exp_f32 v60, v60
    v_exp_f32 v61, v61
    v_exp_f32 v62, v62
    v_exp_f32 v63, v63
    v_cvt_pk_bf16_f32 v44, v56, v57
    v_cvt_pk_bf16_f32 v45, v58, v59
    v_cvt_pk_bf16_f32 v46, v60, v61
    v_cvt_pk_bf16_f32 v47, v62, v63
    s_setprio 2
    s_waitcnt lgkmcnt(2)
    v_mfma_f32_32x32x16_bf16 v[48:63], v[32:35], v[108:111], v[0:15]
    ds_read_b128 v[36:39], v116 offset:30720
    v_exp_f32 v64, v64
    v_exp_f32 v65, v65
    v_exp_f32 v66, v66
    v_exp_f32 v67, v67
    v_exp_f32 v68, v68
    v_exp_f32 v69, v69
    v_mfma_f32_32x32x16_bf16 v[80:95], v[20:23], v[44:47], v[80:95]
    v_exp_f32 v70, v70
    v_exp_f32 v71, v71
    v_exp_f32 v72, v72
    v_cvt_pk_bf16_f32 v40, v64, v65
    v_cvt_pk_bf16_f32 v41, v66, v67
    v_cvt_pk_bf16_f32 v42, v68, v69
    v_cvt_pk_bf16_f32 v43, v70, v71
    v_exp_f32 v73, v73
    s_waitcnt lgkmcnt(1)
    v_exp_f32 v74, v74
    v_mfma_f32_32x32x16_bf16 v[80:95], v[24:27], v[40:43], v[80:95]
    s_mov_b64 exec, s[4:5]
    ds_read_b128 v[16:19], v119 offset:29696
    ds_read_b128 v[20:23], v119 offset:30208
    s_mov_b64 exec, -1
    v_exp_f32 v75, v75
    v_exp_f32 v76, v76
    v_exp_f32 v77, v77
    v_exp_f32 v78, v78
    v_exp_f32 v79, v79
    v_cvt_pk_bf16_f32 v44, v72, v73
    v_cvt_pk_bf16_f32 v45, v74, v75
    v_cvt_pk_bf16_f32 v46, v76, v77
    v_cvt_pk_bf16_f32 v47, v78, v79
    s_setprio 1
    s_waitcnt lgkmcnt(2)
    v_mfma_f32_32x32x16_bf16 v[64:79], v[36:39], v[108:111], v[0:15]
    ds_read_b128 v[32:35], v116 offset:32768
    v_exp_f32 v48, v48
    v_exp_f32 v49, v49
    v_exp_f32 v50, v50
    s_waitcnt vmcnt(4)
    ds_read_b64_tr_b16 v[192:193], v123 offset:0
    ds_read_b64_tr_b16 v[194:195], v123 offset:1024
    ds_read_b64_tr_b16 v[196:197], v124 offset:0
    ds_read_b64_tr_b16 v[198:199], v124 offset:1024
    s_waitcnt lgkmcnt(0)
    v_mfma_f32_32x32x16_bf16 v[128:143], v[192:195], v[200:203], 0
    v_exp_f32 v51, v51
    v_exp_f32 v52, v52
    v_exp_f32 v53, v53
    v_mfma_f32_32x32x16_bf16 v[80:95], v[28:31], v[44:47], v[80:95]
    v_exp_f32 v54, v54
    v_exp_f32 v55, v55
    v_exp_f32 v56, v56
    v_cvt_pk_bf16_f32 v40, v48, v49
    v_cvt_pk_bf16_f32 v41, v50, v51
    s_lshl_b32 s49, s60, 14
    s_add_u32 m0, s53, 0
    s_add_u32 s49, s49, s50
    buffer_load_dwordx4 v122, s[16:19], s49 offen lds
    v_cvt_pk_bf16_f32 v42, v52, v53
    v_cvt_pk_bf16_f32 v43, v54, v55
    v_exp_f32 v57, v57
    v_exp_f32 v58, v58
    v_mfma_f32_32x32x16_bf16 v[80:95], v[16:19], v[40:43], v[80:95]
    s_mov_b64 exec, s[4:5]
    ds_read_b128 v[24:27], v119 offset:31744
    ds_read_b128 v[28:31], v119 offset:32256
    s_mov_b64 exec, -1
    v_exp_f32 v59, v59
    v_exp_f32 v60, v60
    v_exp_f32 v61, v61
    v_mfma_f32_32x32x16_bf16 v[144:159], v[192:195], v[204:207], 0
    v_exp_f32 v62, v62
    v_exp_f32 v63, v63
    v_cvt_pk_bf16_f32 v44, v56, v57
    v_cvt_pk_bf16_f32 v45, v58, v59
    v_cvt_pk_bf16_f32 v46, v60, v61
    v_cvt_pk_bf16_f32 v47, v62, v63
    s_setprio 0
    v_mfma_f32_32x32x16_bf16 v[48:63], v[32:35], v[108:111], v[0:15]
    ds_read_b128 v[36:39], v116 offset:34816
    v_exp_f32 v64, v64
    v_exp_f32 v65, v65
    v_exp_f32 v66, v66
    s_add_u32 m0, s53, 1024
    s_add_u32 s49, s49, 8192
    buffer_load_dwordx4 v122, s[16:19], s49 offen lds
    v_mfma_f32_32x32x16_bf16 v[160:175], v[196:199], v[200:203], 0
    v_exp_f32 v67, v67
    v_exp_f32 v68, v68
    v_exp_f32 v69, v69
    v_mfma_f32_32x32x16_bf16 v[80:95], v[20:23], v[44:47], v[80:95]
    v_exp_f32 v70, v70
    v_exp_f32 v71, v71
    v_exp_f32 v72, v72
    v_cvt_pk_bf16_f32 v40, v64, v65
    v_cvt_pk_bf16_f32 v41, v66, v67
    s_lshl_b32 s49, s60, 10
    s_add_u32 s49, s49, s52
    buffer_load_dwordx4 v[216:219], v105, s[32:35], s49 offen sc1
    v_mfma_f32_32x32x16_bf16 v[176:191], v[196:199], v[204:207], 0
    v_cvt_pk_bf16_f32 v42, v68, v69
    v_cvt_pk_bf16_f32 v43, v70, v71
    v_exp_f32 v73, v73
    s_waitcnt lgkmcnt(1)
    v_exp_f32 v74, v74
    v_mfma_f32_32x32x16_bf16 v[80:95], v[24:27], v[40:43], v[80:95]
    s_mov_b64 exec, s[4:5]
    ds_read_b128 v[16:19], v119 offset:33792
    ds_read_b128 v[20:23], v119 offset:34304
    s_mov_b64 exec, -1
    v_exp_f32 v75, v75
    v_exp_f32 v76, v76
    v_exp_f32 v77, v77
    s_add_u32 s49, s49, 147456
    buffer_load_dwordx4 v[220:223], v105, s[32:35], s49 offen sc1
    s_add_u32 s60, s60, 1
    s_cmp_eq_u32 s60, 14
    s_cselect_b32 s60, 0, s60
    v_exp_f32 v78, v78
    v_exp_f32 v79, v79
    v_cvt_pk_bf16_f32 v44, v72, v73
    v_cvt_pk_bf16_f32 v45, v74, v75
    v_cvt_pk_bf16_f32 v46, v76, v77
    v_cvt_pk_bf16_f32 v47, v78, v79
    s_setprio 3
    s_waitcnt lgkmcnt(2)
    v_mfma_f32_32x32x16_bf16 v[64:79], v[36:39], v[108:111], v[0:15]
    ds_read_b128 v[32:35], v116 offset:36864
    v_exp_f32 v48, v48
    v_exp_f32 v49, v49
    v_exp_f32 v50, v50
    s_waitcnt vmcnt(4)
    ds_read_b64_tr_b16 v[192:193], v123 offset:2048
    ds_read_b64_tr_b16 v[194:195], v123 offset:3072
    ds_read_b64_tr_b16 v[196:197], v124 offset:2048
    ds_read_b64_tr_b16 v[198:199], v124 offset:3072
    v_exp_f32 v51, v51
    v_exp_f32 v52, v52
    v_exp_f32 v53, v53
    v_mfma_f32_32x32x16_bf16 v[80:95], v[28:31], v[44:47], v[80:95]
    v_exp_f32 v54, v54
    v_exp_f32 v55, v55
    v_exp_f32 v56, v56
    v_cvt_pk_bf16_f32 v40, v48, v49
    v_cvt_pk_bf16_f32 v41, v50, v51
    s_waitcnt lgkmcnt(0)
    v_mfma_f32_32x32x16_bf16 v[128:143], v[192:195], v[208:211], v[128:143]
    v_cvt_pk_bf16_f32 v42, v52, v53
    v_cvt_pk_bf16_f32 v43, v54, v55
    v_exp_f32 v57, v57
    v_exp_f32 v58, v58
    v_mfma_f32_32x32x16_bf16 v[80:95], v[16:19], v[40:43], v[80:95]
    s_mov_b64 exec, s[4:5]
    ds_read_b128 v[24:27], v119 offset:35840
    ds_read_b128 v[28:31], v119 offset:36352
    s_mov_b64 exec, -1
    v_exp_f32 v59, v59
    v_exp_f32 v60, v60
    v_exp_f32 v61, v61
    s_lshl_b32 s49, s60, 14
    s_add_u32 m0, s53, 2048
    s_add_u32 s49, s49, s50
    buffer_load_dwordx4 v122, s[16:19], s49 offen lds
    v_exp_f32 v62, v62
    v_exp_f32 v63, v63
    v_cvt_pk_bf16_f32 v44, v56, v57
    v_cvt_pk_bf16_f32 v45, v58, v59
    v_cvt_pk_bf16_f32 v46, v60, v61
    v_cvt_pk_bf16_f32 v47, v62, v63
    s_setprio 2
    v_mfma_f32_32x32x16_bf16 v[48:63], v[32:35], v[108:111], v[0:15]
    ds_read_b128 v[36:39], v116 offset:38912
    v_exp_f32 v64, v64
    v_exp_f32 v65, v65
    v_exp_f32 v66, v66
    v_mfma_f32_32x32x16_bf16 v[144:159], v[192:195], v[212:215], v[144:159]
    s_add_u32 m0, s53, 3072
    s_add_u32 s49, s49, 8192
    buffer_load_dwordx4 v122, s[16:19], s49 offen lds
    v_exp_f32 v67, v67
    v_exp_f32 v68, v68
    v_exp_f32 v69, v69
    v_mfma_f32_32x32x16_bf16 v[80:95], v[20:23], v[44:47], v[80:95]
    v_exp_f32 v70, v70
    v_exp_f32 v71, v71
    v_exp_f32 v72, v72
    v_cvt_pk_bf16_f32 v40, v64, v65
    v_cvt_pk_bf16_f32 v41, v66, v67
    v_mfma_f32_32x32x16_bf16 v[160:175], v[196:199], v[208:211], v[160:175]
    s_lshl_b32 s49, s60, 10
    s_add_u32 s49, s49, s52
    buffer_load_dwordx4 v[200:203], v105, s[32:35], s49 offen sc1
    v_cvt_pk_bf16_f32 v42, v68, v69
    v_cvt_pk_bf16_f32 v43, v70, v71
    v_exp_f32 v73, v73
    s_waitcnt lgkmcnt(1)
    v_exp_f32 v74, v74
    v_mfma_f32_32x32x16_bf16 v[80:95], v[24:27], v[40:43], v[80:95]
    s_mov_b64 exec, s[4:5]
    ds_read_b128 v[16:19], v119 offset:37888
    ds_read_b128 v[20:23], v119 offset:38400
    s_mov_b64 exec, -1
    v_exp_f32 v75, v75
    v_exp_f32 v76, v76
    v_exp_f32 v77, v77
    v_mfma_f32_32x32x16_bf16 v[176:191], v[196:199], v[212:215], v[176:191]
    v_exp_f32 v78, v78
    v_exp_f32 v79, v79
    v_cvt_pk_bf16_f32 v44, v72, v73
    v_cvt_pk_bf16_f32 v45, v74, v75
    v_cvt_pk_bf16_f32 v46, v76, v77
    v_cvt_pk_bf16_f32 v47, v78, v79
    s_setprio 1
    s_waitcnt lgkmcnt(2)
    v_mfma_f32_32x32x16_bf16 v[64:79], v[36:39], v[108:111], v[0:15]
    ds_read_b128 v[32:35], v116 offset:40960
    v_exp_f32 v48, v48
    v_exp_f32 v49, v49
    v_exp_f32 v50, v50
    s_add_u32 s49, s49, 147456
    buffer_load_dwordx4 v[204:207], v105, s[32:35], s49 offen sc1
    s_add_u32 s60, s60, 1
    s_cmp_eq_u32 s60, 14
    s_cselect_b32 s60, 0, s60
    s_waitcnt vmcnt(4)
    ds_read_b64_tr_b16 v[192:193], v123 offset:0
    ds_read_b64_tr_b16 v[194:195], v123 offset:1024
    ds_read_b64_tr_b16 v[196:197], v124 offset:0
    ds_read_b64_tr_b16 v[198:199], v124 offset:1024
    v_exp_f32 v51, v51
    v_exp_f32 v52, v52
    v_exp_f32 v53, v53
    v_mfma_f32_32x32x16_bf16 v[80:95], v[28:31], v[44:47], v[80:95]
    v_exp_f32 v54, v54
    v_exp_f32 v55, v55
    v_exp_f32 v56, v56
    v_cvt_pk_bf16_f32 v40, v48, v49
    v_cvt_pk_bf16_f32 v41, v50, v51
    s_waitcnt lgkmcnt(0)
    v_mfma_f32_32x32x16_bf16 v[128:143], v[192:195], v[216:219], v[128:143]
    v_cvt_pk_bf16_f32 v42, v52, v53
    v_cvt_pk_bf16_f32 v43, v54, v55
    v_exp_f32 v57, v57
    v_exp_f32 v58, v58
    v_mfma_f32_32x32x16_bf16 v[80:95], v[16:19], v[40:43], v[80:95]
    s_mov_b64 exec, s[4:5]
    ds_read_b128 v[24:27], v119 offset:39936
    ds_read_b128 v[28:31], v119 offset:40448
    s_mov_b64 exec, -1
    v_exp_f32 v59, v59
    v_exp_f32 v60, v60
    v_exp_f32 v61, v61
    s_lshl_b32 s49, s60, 14
    s_add_u32 m0, s53, 0
    s_add_u32 s49, s49, s50
    buffer_load_dwordx4 v122, s[16:19], s49 offen lds
    v_exp_f32 v62, v62
    v_exp_f32 v63, v63
    v_cvt_pk_bf16_f32 v44, v56, v57
    v_cvt_pk_bf16_f32 v45, v58, v59
    v_cvt_pk_bf16_f32 v46, v60, v61
    v_cvt_pk_bf16_f32 v47, v62, v63
    s_setprio 0
    v_mfma_f32_32x32x16_bf16 v[48:63], v[32:35], v[108:111], v[0:15]
    ds_read_b128 v[36:39], v116 offset:43008
    v_exp_f32 v64, v64
    v_exp_f32 v65, v65
    v_exp_f32 v66, v66
    v_mfma_f32_32x32x16_bf16 v[144:159], v[192:195], v[220:223], v[144:159]
    s_add_u32 m0, s53, 1024
    s_add_u32 s49, s49, 8192
    buffer_load_dwordx4 v122, s[16:19], s49 offen lds
    v_exp_f32 v67, v67
    v_exp_f32 v68, v68
    v_exp_f32 v69, v69
    v_mfma_f32_32x32x16_bf16 v[80:95], v[20:23], v[44:47], v[80:95]
    v_exp_f32 v70, v70
    v_exp_f32 v71, v71
    v_exp_f32 v72, v72
    v_cvt_pk_bf16_f32 v40, v64, v65
    v_cvt_pk_bf16_f32 v41, v66, v67
    v_mfma_f32_32x32x16_bf16 v[160:175], v[196:199], v[216:219], v[160:175]
    v_cvt_pk_bf16_f32 v42, v68, v69
    v_cvt_pk_bf16_f32 v43, v70, v71
    v_exp_f32 v73, v73
    s_waitcnt lgkmcnt(1)
    v_exp_f32 v74, v74
    v_mfma_f32_32x32x16_bf16 v[80:95], v[24:27], v[40:43], v[80:95]
    s_mov_b64 exec, s[4:5]
    ds_read_b128 v[16:19], v119 offset:41984
    ds_read_b128 v[20:23], v119 offset:42496
    s_mov_b64 exec, -1
    v_exp_f32 v75, v75
    v_exp_f32 v76, v76
    v_exp_f32 v77, v77
    s_lshl_b32 s49, s60, 10
    s_add_u32 s49, s49, s52
    buffer_load_dwordx4 v[208:211], v105, s[32:35], s49 offen sc1
    v_exp_f32 v78, v78
    v_exp_f32 v79, v79
    v_cvt_pk_bf16_f32 v44, v72, v73
    v_cvt_pk_bf16_f32 v45, v74, v75
    v_cvt_pk_bf16_f32 v46, v76, v77
    v_cvt_pk_bf16_f32 v47, v78, v79
    s_setprio 3
    s_waitcnt lgkmcnt(2)
    v_mfma_f32_32x32x16_bf16 v[64:79], v[36:39], v[108:111], v[0:15]
    ds_read_b128 v[32:35], v116 offset:45056
    v_exp_f32 v48, v48
    v_exp_f32 v49, v49
    v_exp_f32 v50, v50
    v_mfma_f32_32x32x16_bf16 v[176:191], v[196:199], v[220:223], v[176:191]
    s_add_u32 s49, s49, 147456
    buffer_load_dwordx4 v[212:215], v105, s[32:35], s49 offen sc1
    s_add_u32 s60, s60, 1
    s_cmp_eq_u32 s60, 14
    s_cselect_b32 s60, 0, s60
    v_exp_f32 v51, v51
    v_exp_f32 v52, v52
    v_exp_f32 v53, v53
    v_mfma_f32_32x32x16_bf16 v[80:95], v[28:31], v[44:47], v[80:95]
    v_exp_f32 v54, v54
    v_exp_f32 v55, v55
    v_exp_f32 v56, v56
    v_cvt_pk_bf16_f32 v40, v48, v49
    v_cvt_pk_bf16_f32 v41, v50, v51
    s_waitcnt vmcnt(4)
    ds_read_b64_tr_b16 v[192:193], v123 offset:2048
    ds_read_b64_tr_b16 v[194:195], v123 offset:3072
    ds_read_b64_tr_b16 v[196:197], v124 offset:2048
    ds_read_b64_tr_b16 v[198:199], v124 offset:3072
    v_cvt_pk_bf16_f32 v42, v52, v53
    v_cvt_pk_bf16_f32 v43, v54, v55
    v_exp_f32 v57, v57
    s_waitcnt lgkmcnt(5)
    v_exp_f32 v58, v58
    v_mfma_f32_32x32x16_bf16 v[80:95], v[16:19], v[40:43], v[80:95]
    s_mov_b64 exec, s[4:5]
    ds_read_b128 v[24:27], v119 offset:44032
    ds_read_b128 v[28:31], v119 offset:44544
    s_mov_b64 exec, -1
    v_exp_f32 v59, v59
    v_exp_f32 v60, v60
    v_exp_f32 v61, v61
    s_waitcnt lgkmcnt(2)
    v_mfma_f32_32x32x16_bf16 v[128:143], v[192:195], v[200:203], v[128:143]
    v_exp_f32 v62, v62
    v_exp_f32 v63, v63
    v_cvt_pk_bf16_f32 v44, v56, v57
    v_cvt_pk_bf16_f32 v45, v58, v59
    v_cvt_pk_bf16_f32 v46, v60, v61
    v_cvt_pk_bf16_f32 v47, v62, v63
    s_setprio 2
    v_mfma_f32_32x32x16_bf16 v[48:63], v[32:35], v[108:111], v[0:15]
    ds_read_b128 v[36:39], v116 offset:47104
    v_exp_f32 v64, v64
    v_exp_f32 v65, v65
    v_exp_f32 v66, v66
    s_lshl_b32 s49, s60, 14
    s_add_u32 m0, s53, 2048
    s_add_u32 s49, s49, s50
    buffer_load_dwordx4 v122, s[16:19], s49 offen lds
    v_mfma_f32_32x32x16_bf16 v[144:159], v[192:195], v[204:207], v[144:159]
    v_exp_f32 v67, v67
    v_exp_f32 v68, v68
    v_exp_f32 v69, v69
    v_mfma_f32_32x32x16_bf16 v[80:95], v[20:23], v[44:47], v[80:95]
    v_exp_f32 v70, v70
    v_exp_f32 v71, v71
    v_exp_f32 v72, v72
    v_cvt_pk_bf16_f32 v40, v64, v65
    v_cvt_pk_bf16_f32 v41, v66, v67
    s_add_u32 m0, s53, 3072
    s_add_u32 s49, s49, 8192
    buffer_load_dwordx4 v122, s[16:19], s49 offen lds
    v_mfma_f32_32x32x16_bf16 v[160:175], v[196:199], v[200:203], v[160:175]
    v_cvt_pk_bf16_f32 v42, v68, v69
    v_cvt_pk_bf16_f32 v43, v70, v71
    v_exp_f32 v73, v73
    s_waitcnt lgkmcnt(1)
    v_exp_f32 v74, v74
    v_mfma_f32_32x32x16_bf16 v[80:95], v[24:27], v[40:43], v[80:95]
    s_mov_b64 exec, s[4:5]
    ds_read_b128 v[16:19], v119 offset:46080
    ds_read_b128 v[20:23], v119 offset:46592
    s_mov_b64 exec, -1
    v_exp_f32 v75, v75
    v_exp_f32 v76, v76
    v_exp_f32 v77, v77
    s_lshl_b32 s49, s60, 10
    s_add_u32 s49, s49, s52
    buffer_load_dwordx4 v[216:219], v105, s[32:35], s49 offen sc1
    v_exp_f32 v78, v78
    v_exp_f32 v79, v79
    v_cvt_pk_bf16_f32 v44, v72, v73
    v_cvt_pk_bf16_f32 v45, v74, v75
    v_cvt_pk_bf16_f32 v46, v76, v77
    v_cvt_pk_bf16_f32 v47, v78, v79
    s_setprio 1
    s_waitcnt lgkmcnt(2)
    v_mfma_f32_32x32x16_bf16 v[64:79], v[36:39], v[108:111], v[0:15]
    ds_read_b128 v[32:35], v116 offset:49152
    v_exp_f32 v48, v48
    v_exp_f32 v49, v49
    v_exp_f32 v50, v50
    v_mfma_f32_32x32x16_bf16 v[176:191], v[196:199], v[204:207], v[176:191]
    v_exp_f32 v51, v51
    v_exp_f32 v52, v52
    v_exp_f32 v53, v53
    v_mfma_f32_32x32x16_bf16 v[80:95], v[28:31], v[44:47], v[80:95]
    v_exp_f32 v54, v54
    v_exp_f32 v55, v55
    v_exp_f32 v56, v56
    v_cvt_pk_bf16_f32 v40, v48, v49
    v_cvt_pk_bf16_f32 v41, v50, v51
    s_add_u32 s49, s49, 147456
    buffer_load_dwordx4 v[220:223], v105, s[32:35], s49 offen sc1
    s_add_u32 s60, s60, 1
    s_cmp_eq_u32 s60, 14
    s_cselect_b32 s60, 0, s60
    v_cvt_pk_bf16_f32 v42, v52, v53
    v_cvt_pk_bf16_f32 v43, v54, v55
    v_exp_f32 v57, v57
    s_waitcnt lgkmcnt(1)
    v_exp_f32 v58, v58
    v_mfma_f32_32x32x16_bf16 v[80:95], v[16:19], v[40:43], v[80:95]
    s_mov_b64 exec, s[4:5]
    ds_read_b128 v[24:27], v119 offset:48128
    ds_read_b128 v[28:31], v119 offset:48640
    s_mov_b64 exec, -1
    v_exp_f32 v59, v59
    v_exp_f32 v60, v60
    v_exp_f32 v61, v61
    s_waitcnt vmcnt(4)
    ds_read_b64_tr_b16 v[192:193], v123 offset:0
    ds_read_b64_tr_b16 v[194:195], v123 offset:1024
    ds_read_b64_tr_b16 v[196:197], v124 offset:0
    ds_read_b64_tr_b16 v[198:199], v124 offset:1024
    v_exp_f32 v62, v62
    v_exp_f32 v63, v63
    v_cvt_pk_bf16_f32 v44, v56, v57
    v_cvt_pk_bf16_f32 v45, v58, v59
    v_cvt_pk_bf16_f32 v46, v60, v61
    v_cvt_pk_bf16_f32 v47, v62, v63
    s_setprio 0
    s_waitcnt lgkmcnt(6)
    v_mfma_f32_32x32x16_bf16 v[48:63], v[32:35], v[108:111], v[0:15]
    ds_read_b128 v[36:39], v116 offset:51200
    v_exp_f32 v64, v64
    v_exp_f32 v65, v65
    v_exp_f32 v66, v66
    s_waitcnt lgkmcnt(1)
    v_mfma_f32_32x32x16_bf16 v[128:143], v[192:195], v[208:211], v[128:143]
    s_lshl_b32 s49, s60, 14
    s_add_u32 m0, s53, 0
    s_add_u32 s49, s49, s50
    buffer_load_dwordx4 v122, s[16:19], s49 offen lds
    v_exp_f32 v67, v67
    v_exp_f32 v68, v68
    v_exp_f32 v69, v69
    v_mfma_f32_32x32x16_bf16 v[80:95], v[20:23], v[44:47], v[80:95]
    v_exp_f32 v70, v70
    v_exp_f32 v71, v71
    v_exp_f32 v72, v72
    v_cvt_pk_bf16_f32 v40, v64, v65
    v_cvt_pk_bf16_f32 v41, v66, v67
    v_mfma_f32_32x32x16_bf16 v[144:159], v[192:195], v[212:215], v[144:159]
    s_add_u32 m0, s53, 1024
    s_add_u32 s49, s49, 8192
    buffer_load_dwordx4 v122, s[16:19], s49 offen lds
    v_cvt_pk_bf16_f32 v42, v68, v69
    v_cvt_pk_bf16_f32 v43, v70, v71
    v_exp_f32 v73, v73
    v_exp_f32 v74, v74
    v_mfma_f32_32x32x16_bf16 v[80:95], v[24:27], v[40:43], v[80:95]
    s_mov_b64 exec, s[4:5]
    ds_read_b128 v[16:19], v119 offset:50176
    ds_read_b128 v[20:23], v119 offset:50688
    s_mov_b64 exec, -1
    v_exp_f32 v75, v75
    v_exp_f32 v76, v76
    v_exp_f32 v77, v77
    v_mfma_f32_32x32x16_bf16 v[160:175], v[196:199], v[208:211], v[160:175]
    v_exp_f32 v78, v78
    v_exp_f32 v79, v79
    v_cvt_pk_bf16_f32 v44, v72, v73
    v_cvt_pk_bf16_f32 v45, v74, v75
    v_cvt_pk_bf16_f32 v46, v76, v77
    v_cvt_pk_bf16_f32 v47, v78, v79
    s_setprio 3
    s_waitcnt lgkmcnt(2)
    v_mfma_f32_32x32x16_bf16 v[64:79], v[36:39], v[108:111], v[0:15]
    ds_read_b128 v[32:35], v116 offset:53248
    v_exp_f32 v48, v48
    v_exp_f32 v49, v49
    v_exp_f32 v50, v50
    s_lshl_b32 s49, s60, 10
    s_add_u32 s49, s49, s52
    buffer_load_dwordx4 v[200:203], v105, s[32:35], s49 offen sc1
    v_mfma_f32_32x32x16_bf16 v[176:191], v[196:199], v[212:215], v[176:191]
    v_exp_f32 v51, v51
    v_exp_f32 v52, v52
    v_exp_f32 v53, v53
    v_mfma_f32_32x32x16_bf16 v[80:95], v[28:31], v[44:47], v[80:95]
    v_exp_f32 v54, v54
    v_exp_f32 v55, v55
    v_exp_f32 v56, v56
    v_cvt_pk_bf16_f32 v40, v48, v49
    v_cvt_pk_bf16_f32 v41, v50, v51
    s_add_u32 s49, s49, 147456
    buffer_load_dwordx4 v[204:207], v105, s[32:35], s49 offen sc1
    s_add_u32 s60, s60, 1
    s_cmp_eq_u32 s60, 14
    s_cselect_b32 s60, 0, s60
    v_cvt_pk_bf16_f32 v42, v52, v53
    v_cvt_pk_bf16_f32 v43, v54, v55
    v_exp_f32 v57, v57
    s_waitcnt lgkmcnt(1)
    v_exp_f32 v58, v58
    v_mfma_f32_32x32x16_bf16 v[80:95], v[16:19], v[40:43], v[80:95]
    s_mov_b64 exec, s[4:5]
    ds_read_b128 v[24:27], v119 offset:52224
    ds_read_b128 v[28:31], v119 offset:52736
    s_mov_b64 exec, -1
    v_exp_f32 v59, v59
    v_exp_f32 v60, v60
    v_exp_f32 v61, v61
    s_waitcnt vmcnt(4)
    ds_read_b64_tr_b16 v[192:193], v123 offset:2048
    ds_read_b64_tr_b16 v[194:195], v123 offset:3072
    ds_read_b64_tr_b16 v[196:197], v124 offset:2048
    ds_read_b64_tr_b16 v[198:199], v124 offset:3072
    v_exp_f32 v62, v62
    v_exp_f32 v63, v63
    v_cvt_pk_bf16_f32 v44, v56, v57
    v_cvt_pk_bf16_f32 v45, v58, v59
    v_cvt_pk_bf16_f32 v46, v60, v61
    v_cvt_pk_bf16_f32 v47, v62, v63
    s_setprio 2
    s_waitcnt lgkmcnt(6)
    v_mfma_f32_32x32x16_bf16 v[48:63], v[32:35], v[108:111], v[0:15]
    ds_read_b128 v[36:39], v116 offset:55296
    v_exp_f32 v64, v64
    v_exp_f32 v65, v65
    v_exp_f32 v66, v66
    s_waitcnt lgkmcnt(1)
    v_mfma_f32_32x32x16_bf16 v[128:143], v[192:195], v[216:219], v[128:143]
    s_lshl_b32 s49, s60, 14
    s_add_u32 m0, s53, 2048
    s_add_u32 s49, s49, s50
    buffer_load_dwordx4 v122, s[16:19], s49 offen lds
    v_exp_f32 v67, v67
    v_exp_f32 v68, v68
    v_exp_f32 v69, v69
    v_mfma_f32_32x32x16_bf16 v[80:95], v[20:23], v[44:47], v[80:95]
    v_exp_f32 v70, v70
    v_exp_f32 v71, v71
    v_exp_f32 v72, v72
    v_cvt_pk_bf16_f32 v40, v64, v65
    v_cvt_pk_bf16_f32 v41, v66, v67
    v_mfma_f32_32x32x16_bf16 v[144:159], v[192:195], v[220:223], v[144:159]
    v_cvt_pk_bf16_f32 v42, v68, v69
    v_cvt_pk_bf16_f32 v43, v70, v71
    v_exp_f32 v73, v73
    v_exp_f32 v74, v74
    v_mfma_f32_32x32x16_bf16 v[80:95], v[24:27], v[40:43], v[80:95]
    s_mov_b64 exec, s[4:5]
    ds_read_b128 v[16:19], v119 offset:54272
    ds_read_b128 v[20:23], v119 offset:54784
    s_mov_b64 exec, -1
    v_exp_f32 v75, v75
    v_exp_f32 v76, v76
    v_exp_f32 v77, v77
    s_add_u32 m0, s53, 3072
    s_add_u32 s49, s49, 8192
    buffer_load_dwordx4 v122, s[16:19], s49 offen lds
    v_exp_f32 v78, v78
    v_exp_f32 v79, v79
    v_cvt_pk_bf16_f32 v44, v72, v73
    v_cvt_pk_bf16_f32 v45, v74, v75
    v_cvt_pk_bf16_f32 v46, v76, v77
    v_cvt_pk_bf16_f32 v47, v78, v79
    s_setprio 1
    s_waitcnt lgkmcnt(2)
    v_mfma_f32_32x32x16_bf16 v[64:79], v[36:39], v[108:111], v[0:15]
    ds_read_b128 v[32:35], v116 offset:57344
    v_exp_f32 v48, v48
    v_exp_f32 v49, v49
    v_exp_f32 v50, v50
    v_mfma_f32_32x32x16_bf16 v[160:175], v[196:199], v[216:219], v[160:175]
    s_lshl_b32 s49, s60, 10
    s_add_u32 s49, s49, s52
    buffer_load_dwordx4 v[208:211], v105, s[32:35], s49 offen sc1
    v_exp_f32 v51, v51
    v_exp_f32 v52, v52
    v_exp_f32 v53, v53
    v_mfma_f32_32x32x16_bf16 v[80:95], v[28:31], v[44:47], v[80:95]
    v_exp_f32 v54, v54
    v_exp_f32 v55, v55
    v_exp_f32 v56, v56
    v_cvt_pk_bf16_f32 v40, v48, v49
    v_cvt_pk_bf16_f32 v41, v50, v51
    v_mfma_f32_32x32x16_bf16 v[176:191], v[196:199], v[220:223], v[176:191]
    s_add_u32 s49, s49, 147456
    buffer_load_dwordx4 v[212:215], v105, s[32:35], s49 offen sc1
    s_add_u32 s60, s60, 1
    s_cmp_eq_u32 s60, 14
    s_cselect_b32 s60, 0, s60
    v_cvt_pk_bf16_f32 v42, v52, v53
    v_cvt_pk_bf16_f32 v43, v54, v55
    v_exp_f32 v57, v57
    s_waitcnt lgkmcnt(1)
    v_exp_f32 v58, v58
    v_mfma_f32_32x32x16_bf16 v[80:95], v[16:19], v[40:43], v[80:95]
    s_mov_b64 exec, s[4:5]
    ds_read_b128 v[24:27], v119 offset:56320
    ds_read_b128 v[28:31], v119 offset:56832
    s_mov_b64 exec, -1
    v_exp_f32 v59, v59
    v_exp_f32 v60, v60
    v_exp_f32 v61, v61
    s_waitcnt vmcnt(4)
    ds_read_b64_tr_b16 v[192:193], v123 offset:0
    ds_read_b64_tr_b16 v[194:195], v123 offset:1024
    ds_read_b64_tr_b16 v[196:197], v124 offset:0
    ds_read_b64_tr_b16 v[198:199], v124 offset:1024
    v_exp_f32 v62, v62
    v_exp_f32 v63, v63
    v_cvt_pk_bf16_f32 v44, v56, v57
    v_cvt_pk_bf16_f32 v45, v58, v59
    v_cvt_pk_bf16_f32 v46, v60, v61
    v_cvt_pk_bf16_f32 v47, v62, v63
    s_setprio 0
    s_waitcnt lgkmcnt(6)
    v_mfma_f32_32x32x16_bf16 v[48:63], v[32:35], v[108:111], v[0:15]
    ds_read_b128 v[36:39], v116 offset:59392
    v_exp_f32 v64, v64
    v_exp_f32 v65, v65
    v_exp_f32 v66, v66
    s_waitcnt lgkmcnt(1)
    v_mfma_f32_32x32x16_bf16 v[128:143], v[192:195], v[200:203], v[128:143]
    s_lshl_b32 s49, s60, 14
    s_add_u32 m0, s53, 0
    s_add_u32 s49, s49, s50
    buffer_load_dwordx4 v122, s[16:19], s49 offen lds
    v_exp_f32 v67, v67
    v_exp_f32 v68, v68
    v_exp_f32 v69, v69
    v_mfma_f32_32x32x16_bf16 v[80:95], v[20:23], v[44:47], v[80:95]
    v_exp_f32 v70, v70
    v_exp_f32 v71, v71
    v_exp_f32 v72, v72
    v_cvt_pk_bf16_f32 v40, v64, v65
    v_cvt_pk_bf16_f32 v41, v66, v67
    v_mfma_f32_32x32x16_bf16 v[144:159], v[192:195], v[204:207], v[144:159]
    v_cvt_pk_bf16_f32 v42, v68, v69
    v_cvt_pk_bf16_f32 v43, v70, v71
    v_exp_f32 v73, v73
    v_exp_f32 v74, v74
    v_mfma_f32_32x32x16_bf16 v[80:95], v[24:27], v[40:43], v[80:95]
    s_mov_b64 exec, s[4:5]
    ds_read_b128 v[16:19], v119 offset:58368
    ds_read_b128 v[20:23], v119 offset:58880
    s_mov_b64 exec, -1
    v_exp_f32 v75, v75
    v_exp_f32 v76, v76
    v_exp_f32 v77, v77
    s_add_u32 m0, s53, 1024
    s_add_u32 s49, s49, 8192
    buffer_load_dwordx4 v122, s[16:19], s49 offen lds
    v_exp_f32 v78, v78
    v_exp_f32 v79, v79
    v_cvt_pk_bf16_f32 v44, v72, v73
    v_cvt_pk_bf16_f32 v45, v74, v75
    v_cvt_pk_bf16_f32 v46, v76, v77
    v_cvt_pk_bf16_f32 v47, v78, v79
    s_setprio 3
    s_waitcnt lgkmcnt(2)
    v_mfma_f32_32x32x16_bf16 v[64:79], v[36:39], v[108:111], v[0:15]
    ds_read_b128 v[32:35], v116 offset:61440
    v_exp_f32 v48, v48
    v_exp_f32 v49, v49
    v_exp_f32 v50, v50
    v_mfma_f32_32x32x16_bf16 v[160:175], v[196:199], v[200:203], v[160:175]
    s_lshl_b32 s49, s60, 10
    s_add_u32 s49, s49, s52
    buffer_load_dwordx4 v[216:219], v105, s[32:35], s49 offen sc1
    v_exp_f32 v51, v51
    v_exp_f32 v52, v52
    v_exp_f32 v53, v53
    v_mfma_f32_32x32x16_bf16 v[80:95], v[28:31], v[44:47], v[80:95]
    v_exp_f32 v54, v54
    v_exp_f32 v55, v55
    v_exp_f32 v56, v56
    v_cvt_pk_bf16_f32 v40, v48, v49
    v_cvt_pk_bf16_f32 v41, v50, v51
    v_mfma_f32_32x32x16_bf16 v[176:191], v[196:199], v[204:207], v[176:191]
    v_cvt_pk_bf16_f32 v42, v52, v53
    v_cvt_pk_bf16_f32 v43, v54, v55
    v_exp_f32 v57, v57
    s_waitcnt lgkmcnt(1)
    v_exp_f32 v58, v58
    v_mfma_f32_32x32x16_bf16 v[80:95], v[16:19], v[40:43], v[80:95]
    s_mov_b64 exec, s[4:5]
    ds_read_b128 v[24:27], v119 offset:60416
    ds_read_b128 v[28:31], v119 offset:60928
    s_mov_b64 exec, -1
    v_exp_f32 v59, v59
    v_exp_f32 v60, v60
    v_exp_f32 v61, v61
    s_add_u32 s49, s49, 147456
    buffer_load_dwordx4 v[220:223], v105, s[32:35], s49 offen sc1
    s_add_u32 s60, s60, 1
    s_cmp_eq_u32 s60, 14
    s_cselect_b32 s60, 0, s60
    v_exp_f32 v62, v62
    v_exp_f32 v63, v63
    v_cvt_pk_bf16_f32 v44, v56, v57
    v_cvt_pk_bf16_f32 v45, v58, v59
    v_cvt_pk_bf16_f32 v46, v60, v61
    v_cvt_pk_bf16_f32 v47, v62, v63
    s_setprio 2
    s_waitcnt lgkmcnt(2)
    v_mfma_f32_32x32x16_bf16 v[48:63], v[32:35], v[108:111], v[0:15]
    ds_read_b128 v[36:39], v116 offset:63488
    v_exp_f32 v64, v64
    v_exp_f32 v65, v65
    v_exp_f32 v66, v66
    s_waitcnt vmcnt(4)
    ds_read_b64_tr_b16 v[192:193], v123 offset:2048
    ds_read_b64_tr_b16 v[194:195], v123 offset:3072
    ds_read_b64_tr_b16 v[196:197], v124 offset:2048
    ds_read_b64_tr_b16 v[198:199], v124 offset:3072
    s_waitcnt lgkmcnt(0)
    v_mfma_f32_32x32x16_bf16 v[128:143], v[192:195], v[208:211], v[128:143]
    v_exp_f32 v67, v67
    v_exp_f32 v68, v68
    v_exp_f32 v69, v69
    v_mfma_f32_32x32x16_bf16 v[80:95], v[20:23], v[44:47], v[80:95]
    v_exp_f32 v70, v70
    v_exp_f32 v71, v71
    v_exp_f32 v72, v72
    v_cvt_pk_bf16_f32 v40, v64, v65
    v_cvt_pk_bf16_f32 v41, v66, v67
    s_lshl_b32 s49, s60, 14
    s_add_u32 m0, s53, 2048
    s_add_u32 s49, s49, s50
    buffer_load_dwordx4 v122, s[16:19], s49 offen lds
    v_cvt_pk_bf16_f32 v42, v68, v69
    v_cvt_pk_bf16_f32 v43, v70, v71
    v_exp_f32 v73, v73
    v_exp_f32 v74, v74
    v_mfma_f32_32x32x16_bf16 v[80:95], v[24:27], v[40:43], v[80:95]
    s_mov_b64 exec, s[4:5]
    ds_read_b128 v[16:19], v119 offset:62464
    ds_read_b128 v[20:23], v119 offset:62976
    s_mov_b64 exec, -1
    v_exp_f32 v75, v75
    v_exp_f32 v76, v76
    v_exp_f32 v77, v77
    v_mfma_f32_32x32x16_bf16 v[144:159], v[192:195], v[212:215], v[144:159]
    v_exp_f32 v78, v78
    v_exp_f32 v79, v79
    v_cvt_pk_bf16_f32 v44, v72, v73
    v_cvt_pk_bf16_f32 v45, v74, v75
    v_cvt_pk_bf16_f32 v46, v76, v77
    v_cvt_pk_bf16_f32 v47, v78, v79
    s_setprio 1
    v_mfma_f32_32x32x16_bf16 v[64:79], v[36:39], v[108:111], v[0:15]
    ds_read_b128 v[32:35], v117 offset:0
    v_exp_f32 v48, v48
    v_exp_f32 v49, v49
    v_exp_f32 v50, v50
    s_add_u32 m0, s53, 3072
    s_add_u32 s49, s49, 8192
    buffer_load_dwordx4 v122, s[16:19], s49 offen lds
    v_mfma_f32_32x32x16_bf16 v[160:175], v[196:199], v[208:211], v[160:175]
    v_exp_f32 v51, v51
    v_exp_f32 v52, v52
    v_exp_f32 v53, v53
    v_mfma_f32_32x32x16_bf16 v[80:95], v[28:31], v[44:47], v[80:95]
    v_exp_f32 v54, v54
    v_exp_f32 v55, v55
    v_exp_f32 v56, v56
    v_cvt_pk_bf16_f32 v40, v48, v49
    v_cvt_pk_bf16_f32 v41, v50, v51
    s_lshl_b32 s49, s60, 10
    s_add_u32 s49, s49, s52
    buffer_load_dwordx4 v[200:203], v105, s[32:35], s49 offen sc1
    v_mfma_f32_32x32x16_bf16 v[176:191], v[196:199], v[212:215], v[176:191]
    v_cvt_pk_bf16_f32 v42, v52, v53
    v_cvt_pk_bf16_f32 v43, v54, v55
    v_exp_f32 v57, v57
    s_waitcnt lgkmcnt(1)
    v_exp_f32 v58, v58
    v_mfma_f32_32x32x16_bf16 v[80:95], v[16:19], v[40:43], v[80:95]
    s_mov_b64 exec, s[4:5]
    ds_read_b128 v[24:27], v119 offset:64512
    ds_read_b128 v[28:31], v119 offset:65024
    s_mov_b64 exec, -1
    v_exp_f32 v59, v59
    v_exp_f32 v60, v60
    v_exp_f32 v61, v61
    s_add_u32 s49, s49, 147456
    buffer_load_dwordx4 v[204:207], v105, s[32:35], s49 offen sc1
    s_add_u32 s60, s60, 1
    s_cmp_eq_u32 s60, 14
    s_cselect_b32 s60, 0, s60
    v_exp_f32 v62, v62
    v_exp_f32 v63, v63
    v_cvt_pk_bf16_f32 v44, v56, v57
    v_cvt_pk_bf16_f32 v45, v58, v59
    v_cvt_pk_bf16_f32 v46, v60, v61
    v_cvt_pk_bf16_f32 v47, v62, v63
    s_setprio 0
    s_waitcnt lgkmcnt(2)
    v_mfma_f32_32x32x16_bf16 v[48:63], v[32:35], v[108:111], v[0:15]
    ds_read_b128 v[36:39], v117 offset:2048
    v_exp_f32 v64, v64
    v_exp_f32 v65, v65
    v_exp_f32 v66, v66
    s_waitcnt vmcnt(4)
    ds_read_b64_tr_b16 v[192:193], v123 offset:0
    ds_read_b64_tr_b16 v[194:195], v123 offset:1024
    ds_read_b64_tr_b16 v[196:197], v124 offset:0
    ds_read_b64_tr_b16 v[198:199], v124 offset:1024
    v_exp_f32 v67, v67
    v_exp_f32 v68, v68
    v_exp_f32 v69, v69
    v_mfma_f32_32x32x16_bf16 v[80:95], v[20:23], v[44:47], v[80:95]
    v_exp_f32 v70, v70
    v_exp_f32 v71, v71
    v_exp_f32 v72, v72
    v_cvt_pk_bf16_f32 v40, v64, v65
    v_cvt_pk_bf16_f32 v41, v66, v67
    s_waitcnt lgkmcnt(0)
    v_mfma_f32_32x32x16_bf16 v[128:143], v[192:195], v[216:219], v[128:143]
    v_cvt_pk_bf16_f32 v42, v68, v69
    v_cvt_pk_bf16_f32 v43, v70, v71
    v_exp_f32 v73, v73
    v_exp_f32 v74, v74
    v_mfma_f32_32x32x16_bf16 v[80:95], v[24:27], v[40:43], v[80:95]
    s_mov_b64 exec, s[4:5]
    ds_read_b128 v[16:19], v120 offset:1024
    ds_read_b128 v[20:23], v120 offset:1536
    s_mov_b64 exec, -1
    v_exp_f32 v75, v75
    v_exp_f32 v76, v76
    v_exp_f32 v77, v77
    s_lshl_b32 s49, s60, 14
    s_add_u32 m0, s53, 0
    s_add_u32 s49, s49, s50
    buffer_load_dwordx4 v122, s[16:19], s49 offen lds
    v_exp_f32 v78, v78
    v_exp_f32 v79, v79
    v_cvt_pk_bf16_f32 v44, v72, v73
    v_cvt_pk_bf16_f32 v45, v74, v75
    v_cvt_pk_bf16_f32 v46, v76, v77
    v_cvt_pk_bf16_f32 v47, v78, v79
    s_setprio 3
    v_mfma_f32_32x32x16_bf16 v[64:79], v[36:39], v[108:111], v[0:15]
    ds_read_b128 v[32:35], v117 offset:4096
    v_exp_f32 v48, v48
    v_exp_f32 v49, v49
    v_exp_f32 v50, v50
    v_mfma_f32_32x32x16_bf16 v[144:159], v[192:195], v[220:223], v[144:159]
    s_add_u32 m0, s53, 1024
    s_add_u32 s49, s49, 8192
    buffer_load_dwordx4 v122, s[16:19], s49 offen lds
    v_exp_f32 v51, v51
    v_exp_f32 v52, v52
    v_exp_f32 v53, v53
    v_mfma_f32_32x32x16_bf16 v[80:95], v[28:31], v[44:47], v[80:95]
    v_exp_f32 v54, v54
    v_exp_f32 v55, v55
    v_exp_f32 v56, v56
    v_cvt_pk_bf16_f32 v40, v48, v49
    v_cvt_pk_bf16_f32 v41, v50, v51
    v_mfma_f32_32x32x16_bf16 v[160:175], v[196:199], v[216:219], v[160:175]
    s_lshl_b32 s49, s60, 10
    s_add_u32 s49, s49, s52
    buffer_load_dwordx4 v[208:211], v105, s[32:35], s49 offen sc1
    v_cvt_pk_bf16_f32 v42, v52, v53
    v_cvt_pk_bf16_f32 v43, v54, v55
    v_exp_f32 v57, v57
    s_waitcnt lgkmcnt(1)
    v_exp_f32 v58, v58
    v_mfma_f32_32x32x16_bf16 v[80:95], v[16:19], v[40:43], v[80:95]
    s_mov_b64 exec, s[4:5]
    ds_read_b128 v[24:27], v120 offset:3072
    ds_read_b128 v[28:31], v120 offset:3584
    s_mov_b64 exec, -1
    v_exp_f32 v59, v59
    v_exp_f32 v60, v60
    v_exp_f32 v61, v61
    v_mfma_f32_32x32x16_bf16 v[176:191], v[196:199], v[220:223], v[176:191]
    v_exp_f32 v62, v62
    v_exp_f32 v63, v63
    v_cvt_pk_bf16_f32 v44, v56, v57
    v_cvt_pk_bf16_f32 v45, v58, v59
    v_cvt_pk_bf16_f32 v46, v60, v61
    v_cvt_pk_bf16_f32 v47, v62, v63
    s_setprio 2
    s_waitcnt lgkmcnt(2)
    v_mfma_f32_32x32x16_bf16 v[48:63], v[32:35], v[108:111], v[0:15]
    ds_read_b128 v[36:39], v117 offset:6144
    v_exp_f32 v64, v64
    v_exp_f32 v65, v65
    v_exp_f32 v66, v66
    s_add_u32 s49, s49, 147456
    buffer_load_dwordx4 v[212:215], v105, s[32:35], s49 offen sc1
    s_add_u32 s60, s60, 1
    s_cmp_eq_u32 s60, 14
    s_cselect_b32 s60, 0, s60
    s_waitcnt vmcnt(4)
    ds_read_b64_tr_b16 v[192:193], v123 offset:2048
    ds_read_b64_tr_b16 v[194:195], v123 offset:3072
    ds_read_b64_tr_b16 v[196:197], v124 offset:2048
    ds_read_b64_tr_b16 v[198:199], v124 offset:3072
    v_exp_f32 v67, v67
    v_exp_f32 v68, v68
    v_exp_f32 v69, v69
    v_mfma_f32_32x32x16_bf16 v[80:95], v[20:23], v[44:47], v[80:95]
    v_exp_f32 v70, v70
    v_exp_f32 v71, v71
    v_exp_f32 v72, v72
    v_cvt_pk_bf16_f32 v40, v64, v65
    v_cvt_pk_bf16_f32 v41, v66, v67
    s_waitcnt lgkmcnt(0)
    v_mfma_f32_32x32x16_bf16 v[128:143], v[192:195], v[200:203], v[128:143]
    v_cvt_pk_bf16_f32 v42, v68, v69
    v_cvt_pk_bf16_f32 v43, v70, v71
    v_exp_f32 v73, v73
    v_exp_f32 v74, v74
    v_mfma_f32_32x32x16_bf16 v[80:95], v[24:27], v[40:43], v[80:95]
    s_mov_b64 exec, s[4:5]
    ds_read_b128 v[16:19], v120 offset:5120
    ds_read_b128 v[20:23], v120 offset:5632
    s_mov_b64 exec, -1
    v_exp_f32 v75, v75
    v_exp_f32 v76, v76
    v_exp_f32 v77, v77
    s_lshl_b32 s49, s60, 14
    s_add_u32 m0, s53, 2048
    s_add_u32 s49, s49, s50
    buffer_load_dwordx4 v122, s[16:19], s49 offen lds
    v_exp_f32 v78, v78
    v_exp_f32 v79, v79
    v_cvt_pk_bf16_f32 v44, v72, v73
    v_cvt_pk_bf16_f32 v45, v74, v75
    v_cvt_pk_bf16_f32 v46, v76, v77
    v_cvt_pk_bf16_f32 v47, v78, v79
    s_barrier
    s_setprio 1
    v_mfma_f32_32x32x16_bf16 v[64:79], v[36:39], v[108:111], v[0:15]
    ds_read_b128 v[32:35], v117 offset:8192
    v_exp_f32 v48, v48
    v_exp_f32 v49, v49
    v_exp_f32 v50, v50
    v_mfma_f32_32x32x16_bf16 v[144:159], v[192:195], v[204:207], v[144:159]
    s_add_u32 m0, s53, 3072
    s_add_u32 s49, s49, 8192
    buffer_load_dwordx4 v122, s[16:19], s49 offen lds
    v_exp_f32 v51, v51
    v_exp_f32 v52, v52
    v_exp_f32 v53, v53
    v_mfma_f32_32x32x16_bf16 v[80:95], v[28:31], v[44:47], v[80:95]
    v_exp_f32 v54, v54
    v_exp_f32 v55, v55
    v_exp_f32 v56, v56
    v_cvt_pk_bf16_f32 v40, v48, v49
    v_cvt_pk_bf16_f32 v41, v50, v51
    v_mfma_f32_32x32x16_bf16 v[160:175], v[196:199], v[200:203], v[160:175]
    s_lshl_b32 s49, s60, 10
    s_add_u32 s49, s49, s52
    buffer_load_dwordx4 v[216:219], v105, s[32:35], s49 offen sc1
    v_cvt_pk_bf16_f32 v42, v52, v53
    v_cvt_pk_bf16_f32 v43, v54, v55
    v_exp_f32 v57, v57
    s_waitcnt lgkmcnt(1)
    v_exp_f32 v58, v58
    v_mfma_f32_32x32x16_bf16 v[80:95], v[16:19], v[40:43], v[80:95]
    s_mov_b64 exec, s[4:5]
    ds_read_b128 v[24:27], v120 offset:7168
    ds_read_b128 v[28:31], v120 offset:7680
    s_mov_b64 exec, -1
    v_exp_f32 v59, v59
    v_exp_f32 v60, v60
    v_exp_f32 v61, v61
    s_lshl_b32 s6, s42, 13
    s_add_u32 m0, s6, 0
    s_add_u32 s6, s59, 0
    buffer_load_dwordx4 v122, s[12:15], s6 offen lds
    s_lshl_b32 s6, s42, 13
    s_add_u32 m0, s6, 1024
    s_add_u32 s6, s59, 8192
    buffer_load_dwordx4 v122, s[12:15], s6 offen lds
    v_exp_f32 v62, v62
    v_exp_f32 v63, v63
    v_cvt_pk_bf16_f32 v44, v56, v57
    v_cvt_pk_bf16_f32 v45, v58, v59
    v_cvt_pk_bf16_f32 v46, v60, v61
    v_cvt_pk_bf16_f32 v47, v62, v63
    s_setprio 0
    s_waitcnt lgkmcnt(2)
    v_mfma_f32_32x32x16_bf16 v[48:63], v[32:35], v[108:111], v[0:15]
    ds_read_b128 v[36:39], v117 offset:10240
    v_exp_f32 v64, v64
    v_exp_f32 v65, v65
    v_exp_f32 v66, v66
    v_mfma_f32_32x32x16_bf16 v[176:191], v[196:199], v[204:207], v[176:191]
    s_add_u32 s49, s49, 147456
    buffer_load_dwordx4 v[220:223], v105, s[32:35], s49 offen sc1
    s_add_u32 s60, s60, 1
    s_cmp_eq_u32 s60, 14
    s_cselect_b32 s60, 0, s60
    v_exp_f32 v67, v67
    v_exp_f32 v68, v68
    v_exp_f32 v69, v69
    v_mfma_f32_32x32x16_bf16 v[80:95], v[20:23], v[44:47], v[80:95]
    v_exp_f32 v70, v70
    v_exp_f32 v71, v71
    v_exp_f32 v72, v72
    v_cvt_pk_bf16_f32 v40, v64, v65
    v_cvt_pk_bf16_f32 v41, v66, v67
    s_waitcnt vmcnt(6)
    ds_read_b64_tr_b16 v[192:193], v123 offset:0
    ds_read_b64_tr_b16 v[194:195], v123 offset:1024
    ds_read_b64_tr_b16 v[196:197], v124 offset:0
    ds_read_b64_tr_b16 v[198:199], v124 offset:1024
    s_waitcnt lgkmcnt(0)
    v_mfma_f32_32x32x16_bf16 v[128:143], v[192:195], v[208:211], v[128:143]
    v_cvt_pk_bf16_f32 v42, v68, v69
    v_cvt_pk_bf16_f32 v43, v70, v71
    v_exp_f32 v73, v73
    v_exp_f32 v74, v74
    v_mfma_f32_32x32x16_bf16 v[80:95], v[24:27], v[40:43], v[80:95]
    s_mov_b64 exec, s[4:5]
    ds_read_b128 v[16:19], v120 offset:9216
    ds_read_b128 v[20:23], v120 offset:9728
    s_mov_b64 exec, -1
    v_exp_f32 v75, v75
    v_exp_f32 v76, v76
    v_exp_f32 v77, v77
    s_lshl_b32 s6, s42, 13
    s_add_u32 m0, s6, 2048
    s_add_u32 s6, s59, 16384
    buffer_load_dwordx4 v122, s[12:15], s6 offen lds
    s_lshl_b32 s6, s42, 13
    s_add_u32 m0, s6, 3072
    s_add_u32 s6, s59, 24576
    buffer_load_dwordx4 v122, s[12:15], s6 offen lds
    v_exp_f32 v78, v78
    v_exp_f32 v79, v79
    v_cvt_pk_bf16_f32 v44, v72, v73
    v_cvt_pk_bf16_f32 v45, v74, v75
    v_cvt_pk_bf16_f32 v46, v76, v77
    v_cvt_pk_bf16_f32 v47, v78, v79
    s_setprio 3
    v_mfma_f32_32x32x16_bf16 v[64:79], v[36:39], v[108:111], v[0:15]
    ds_read_b128 v[32:35], v117 offset:12288
    v_exp_f32 v48, v48
    v_exp_f32 v49, v49
    v_exp_f32 v50, v50
    s_lshl_b32 s49, s60, 14
    s_add_u32 m0, s53, 0
    s_add_u32 s49, s49, s50
    buffer_load_dwordx4 v122, s[16:19], s49 offen lds
    v_mfma_f32_32x32x16_bf16 v[144:159], v[192:195], v[212:215], v[144:159]
    s_add_u32 m0, s53, 1024
    s_add_u32 s49, s49, 8192
    buffer_load_dwordx4 v122, s[16:19], s49 offen lds
    v_exp_f32 v51, v51
    v_exp_f32 v52, v52
    v_exp_f32 v53, v53
    v_mfma_f32_32x32x16_bf16 v[80:95], v[28:31], v[44:47], v[80:95]
    v_exp_f32 v54, v54
    v_exp_f32 v55, v55
    v_exp_f32 v56, v56
    v_cvt_pk_bf16_f32 v40, v48, v49
    v_cvt_pk_bf16_f32 v41, v50, v51
    v_mfma_f32_32x32x16_bf16 v[160:175], v[196:199], v[208:211], v[160:175]
    s_lshl_b32 s49, s60, 10
    s_add_u32 s49, s49, s52
    buffer_load_dwordx4 v[200:203], v105, s[32:35], s49 offen sc1
    v_cvt_pk_bf16_f32 v42, v52, v53
    v_cvt_pk_bf16_f32 v43, v54, v55
    v_exp_f32 v57, v57
    s_waitcnt lgkmcnt(1)
    v_exp_f32 v58, v58
    v_mfma_f32_32x32x16_bf16 v[80:95], v[16:19], v[40:43], v[80:95]
    s_mov_b64 exec, s[4:5]
    ds_read_b128 v[24:27], v120 offset:11264
    ds_read_b128 v[28:31], v120 offset:11776
    s_mov_b64 exec, -1
    v_exp_f32 v59, v59
    v_exp_f32 v60, v60
    v_exp_f32 v61, v61
    s_lshl_b32 s6, s42, 13
    s_add_u32 m0, s6, 4096
    s_add_u32 s6, s59, 32768
    buffer_load_dwordx4 v122, s[12:15], s6 offen lds
    s_lshl_b32 s6, s42, 13
    s_add_u32 m0, s6, 5120
    s_add_u32 s6, s59, 40960
    buffer_load_dwordx4 v122, s[12:15], s6 offen lds
    v_exp_f32 v62, v62
    v_exp_f32 v63, v63
    v_cvt_pk_bf16_f32 v44, v56, v57
    v_cvt_pk_bf16_f32 v45, v58, v59
    v_cvt_pk_bf16_f32 v46, v60, v61
    v_cvt_pk_bf16_f32 v47, v62, v63
    s_setprio 2
    s_waitcnt lgkmcnt(2)
    v_mfma_f32_32x32x16_bf16 v[48:63], v[32:35], v[108:111], v[0:15]
    ds_read_b128 v[36:39], v117 offset:14336
    v_exp_f32 v64, v64
    v_exp_f32 v65, v65
    v_exp_f32 v66, v66
    v_mfma_f32_32x32x16_bf16 v[176:191], v[196:199], v[212:215], v[176:191]
    s_add_u32 s49, s49, 147456
    buffer_load_dwordx4 v[204:207], v105, s[32:35], s49 offen sc1
    s_add_u32 s60, s60, 1
    s_cmp_eq_u32 s60, 14
    s_cselect_b32 s60, 0, s60
    v_exp_f32 v67, v67
    v_exp_f32 v68, v68
    v_exp_f32 v69, v69
    v_mfma_f32_32x32x16_bf16 v[80:95], v[20:23], v[44:47], v[80:95]
    v_exp_f32 v70, v70
    v_exp_f32 v71, v71
    v_exp_f32 v72, v72
    v_cvt_pk_bf16_f32 v40, v64, v65
    v_cvt_pk_bf16_f32 v41, v66, v67
    s_waitcnt vmcnt(8)
    ds_read_b64_tr_b16 v[192:193], v123 offset:2048
    ds_read_b64_tr_b16 v[194:195], v123 offset:3072
    ds_read_b64_tr_b16 v[196:197], v124 offset:2048
    ds_read_b64_tr_b16 v[198:199], v124 offset:3072
    s_lshl_b32 s6, s42, 13
    s_add_u32 m0, s6, 6144
    s_add_u32 s6, s59, 49152
    buffer_load_dwordx4 v122, s[12:15], s6 offen lds
    v_cvt_pk_bf16_f32 v42, v68, v69
    v_cvt_pk_bf16_f32 v43, v70, v71
    v_exp_f32 v73, v73
    s_waitcnt lgkmcnt(5)
    v_exp_f32 v74, v74
    v_mfma_f32_32x32x16_bf16 v[80:95], v[24:27], v[40:43], v[80:95]
    s_mov_b64 exec, s[4:5]
    ds_read_b128 v[16:19], v120 offset:13312
    ds_read_b128 v[20:23], v120 offset:13824
    s_mov_b64 exec, -1
    v_exp_f32 v75, v75
    v_exp_f32 v76, v76
    v_exp_f32 v77, v77
    s_lshl_b32 s6, s42, 13
    s_add_u32 m0, s6, 7168
    s_add_u32 s6, s59, 57344
    buffer_load_dwordx4 v122, s[12:15], s6 offen lds
    v_exp_f32 v78, v78
    v_exp_f32 v79, v79
    v_cvt_pk_bf16_f32 v44, v72, v73
    v_cvt_pk_bf16_f32 v45, v74, v75
    v_cvt_pk_bf16_f32 v46, v76, v77
    v_cvt_pk_bf16_f32 v47, v78, v79
    s_setprio 1
    s_waitcnt lgkmcnt(6)
    v_mfma_f32_32x32x16_bf16 v[64:79], v[36:39], v[108:111], v[0:15]
    ds_read_b128 v[32:35], v117 offset:16384
    v_exp_f32 v48, v48
    v_exp_f32 v49, v49
    v_exp_f32 v50, v50
    s_waitcnt lgkmcnt(3)
    v_mfma_f32_32x32x16_bf16 v[128:143], v[192:195], v[216:219], v[128:143]
    s_lshl_b32 s49, s60, 14
    s_add_u32 m0, s53, 2048
    s_add_u32 s49, s49, s50
    buffer_load_dwordx4 v122, s[16:19], s49 offen lds
    v_exp_f32 v51, v51
    v_exp_f32 v52, v52
    v_exp_f32 v53, v53
    v_mfma_f32_32x32x16_bf16 v[80:95], v[28:31], v[44:47], v[80:95]
    v_exp_f32 v54, v54
    v_exp_f32 v55, v55
    v_exp_f32 v56, v56
    v_cvt_pk_bf16_f32 v40, v48, v49
    v_cvt_pk_bf16_f32 v41, v50, v51
    v_mfma_f32_32x32x16_bf16 v[144:159], v[192:195], v[220:223], v[144:159]
    s_add_u32 m0, s53, 3072
    s_add_u32 s49, s49, 8192
    buffer_load_dwordx4 v122, s[16:19], s49 offen lds
    v_cvt_pk_bf16_f32 v42, v52, v53
    v_cvt_pk_bf16_f32 v43, v54, v55
    v_exp_f32 v57, v57
    s_waitcnt lgkmcnt(1)
    v_exp_f32 v58, v58
    v_mfma_f32_32x32x16_bf16 v[80:95], v[16:19], v[40:43], v[80:95]
    s_mov_b64 exec, s[4:5]
    ds_read_b128 v[24:27], v120 offset:15360
    ds_read_b128 v[28:31], v120 offset:15872
    s_mov_b64 exec, -1
    v_exp_f32 v59, v59
    v_exp_f32 v60, v60
    v_exp_f32 v61, v61
    v_mfma_f32_32x32x16_bf16 v[160:175], v[196:199], v[216:219], v[160:175]
    v_exp_f32 v62, v62
    v_exp_f32 v63, v63
    v_cvt_pk_bf16_f32 v44, v56, v57
    v_cvt_pk_bf16_f32 v45, v58, v59
    v_cvt_pk_bf16_f32 v46, v60, v61
    v_cvt_pk_bf16_f32 v47, v62, v63
    s_setprio 0
    s_waitcnt lgkmcnt(2)
    v_mfma_f32_32x32x16_bf16 v[48:63], v[32:35], v[108:111], v[0:15]
    ds_read_b128 v[36:39], v117 offset:18432
    v_exp_f32 v64, v64
    v_exp_f32 v65, v65
    v_exp_f32 v66, v66
    s_lshl_b32 s49, s60, 10
    s_add_u32 s49, s49, s52
    buffer_load_dwordx4 v[208:211], v105, s[32:35], s49 offen sc1
    v_mfma_f32_32x32x16_bf16 v[176:191], v[196:199], v[220:223], v[176:191]
    v_exp_f32 v67, v67
    v_exp_f32 v68, v68
    v_exp_f32 v69, v69
    v_mfma_f32_32x32x16_bf16 v[80:95], v[20:23], v[44:47], v[80:95]
    v_exp_f32 v70, v70
    v_exp_f32 v71, v71
    v_exp_f32 v72, v72
    v_cvt_pk_bf16_f32 v40, v64, v65
    v_cvt_pk_bf16_f32 v41, v66, v67
    s_add_u32 s49, s49, 147456
    buffer_load_dwordx4 v[212:215], v105, s[32:35], s49 offen sc1
    s_add_u32 s60, s60, 1
    s_cmp_eq_u32 s60, 14
    s_cselect_b32 s60, 0, s60
    v_cvt_pk_bf16_f32 v42, v68, v69
    v_cvt_pk_bf16_f32 v43, v70, v71
    v_exp_f32 v73, v73
    s_waitcnt lgkmcnt(1)
    v_exp_f32 v74, v74
    v_mfma_f32_32x32x16_bf16 v[80:95], v[24:27], v[40:43], v[80:95]
    s_mov_b64 exec, s[4:5]
    ds_read_b128 v[16:19], v120 offset:17408
    ds_read_b128 v[20:23], v120 offset:17920
    s_mov_b64 exec, -1
    v_exp_f32 v75, v75
    v_exp_f32 v76, v76
    v_exp_f32 v77, v77
    s_waitcnt vmcnt(6)
    ds_read_b64_tr_b16 v[192:193], v123 offset:0
    ds_read_b64_tr_b16 v[194:195], v123 offset:1024
    ds_read_b64_tr_b16 v[196:197], v124 offset:0
    ds_read_b64_tr_b16 v[198:199], v124 offset:1024
    v_exp_f32 v78, v78
    v_exp_f32 v79, v79
    v_cvt_pk_bf16_f32 v44, v72, v73
    v_cvt_pk_bf16_f32 v45, v74, v75
    v_cvt_pk_bf16_f32 v46, v76, v77
    v_cvt_pk_bf16_f32 v47, v78, v79
    s_setprio 3
    s_waitcnt lgkmcnt(6)
    v_mfma_f32_32x32x16_bf16 v[64:79], v[36:39], v[108:111], v[0:15]
    ds_read_b128 v[32:35], v117 offset:20480
    v_exp_f32 v48, v48
    v_exp_f32 v49, v49
    v_exp_f32 v50, v50
    s_waitcnt lgkmcnt(1)
    v_mfma_f32_32x32x16_bf16 v[128:143], v[192:195], v[200:203], v[128:143]
    v_exp_f32 v51, v51
    v_exp_f32 v52, v52
    v_exp_f32 v53, v53
    v_mfma_f32_32x32x16_bf16 v[80:95], v[28:31], v[44:47], v[80:95]
    v_exp_f32 v54, v54
    v_exp_f32 v55, v55
    v_exp_f32 v56, v56
    v_cvt_pk_bf16_f32 v40, v48, v49
    v_cvt_pk_bf16_f32 v41, v50, v51
    v_mfma_f32_32x32x16_bf16 v[144:159], v[192:195], v[204:207], v[144:159]
    v_cvt_pk_bf16_f32 v42, v52, v53
    v_cvt_pk_bf16_f32 v43, v54, v55
    v_exp_f32 v57, v57
    v_exp_f32 v58, v58
    v_mfma_f32_32x32x16_bf16 v[80:95], v[16:19], v[40:43], v[80:95]
    s_mov_b64 exec, s[4:5]
    ds_read_b128 v[24:27], v120 offset:19456
    ds_read_b128 v[28:31], v120 offset:19968
    s_mov_b64 exec, -1
    v_exp_f32 v59, v59
    v_exp_f32 v60, v60
    v_exp_f32 v61, v61
    v_exp_f32 v62, v62
    v_exp_f32 v63, v63
    v_cvt_pk_bf16_f32 v44, v56, v57
    v_cvt_pk_bf16_f32 v45, v58, v59
    v_cvt_pk_bf16_f32 v46, v60, v61
    v_cvt_pk_bf16_f32 v47, v62, v63
    s_setprio 2
    s_waitcnt lgkmcnt(2)
    v_mfma_f32_32x32x16_bf16 v[48:63], v[32:35], v[108:111], v[0:15]
    ds_read_b128 v[36:39], v117 offset:22528
    v_exp_f32 v64, v64
    v_exp_f32 v65, v65
    v_exp_f32 v66, v66
    v_mfma_f32_32x32x16_bf16 v[160:175], v[196:199], v[200:203], v[160:175]
    v_exp_f32 v67, v67
    v_exp_f32 v68, v68
    v_exp_f32 v69, v69
    v_mfma_f32_32x32x16_bf16 v[80:95], v[20:23], v[44:47], v[80:95]
    v_exp_f32 v70, v70
    v_exp_f32 v71, v71
    v_exp_f32 v72, v72
    v_cvt_pk_bf16_f32 v40, v64, v65
    v_cvt_pk_bf16_f32 v41, v66, v67
    v_mfma_f32_32x32x16_bf16 v[176:191], v[196:199], v[204:207], v[176:191]
    v_cvt_pk_bf16_f32 v42, v68, v69
    v_cvt_pk_bf16_f32 v43, v70, v71
    v_exp_f32 v73, v73
    s_waitcnt lgkmcnt(1)
    v_exp_f32 v74, v74
    v_mfma_f32_32x32x16_bf16 v[80:95], v[24:27], v[40:43], v[80:95]
    s_mov_b64 exec, s[4:5]
    ds_read_b128 v[16:19], v120 offset:21504
    ds_read_b128 v[20:23], v120 offset:22016
    s_mov_b64 exec, -1
    v_exp_f32 v75, v75
    v_exp_f32 v76, v76
    v_exp_f32 v77, v77
    s_waitcnt vmcnt(0)
    ds_read_b64_tr_b16 v[192:193], v123 offset:2048
    ds_read_b64_tr_b16 v[194:195], v123 offset:3072
    ds_read_b64_tr_b16 v[196:197], v124 offset:2048
    ds_read_b64_tr_b16 v[198:199], v124 offset:3072
    v_exp_f32 v78, v78
    v_exp_f32 v79, v79
    v_cvt_pk_bf16_f32 v44, v72, v73
    v_cvt_pk_bf16_f32 v45, v74, v75
    v_cvt_pk_bf16_f32 v46, v76, v77
    v_cvt_pk_bf16_f32 v47, v78, v79
    s_waitcnt vmcnt(0)
    s_barrier
    s_setprio 1
    s_waitcnt lgkmcnt(6)
    v_mfma_f32_32x32x16_bf16 v[64:79], v[36:39], v[108:111], v[0:15]
    ds_read_b128 v[32:35], v117 offset:24576
    v_exp_f32 v48, v48
    v_exp_f32 v49, v49
    v_exp_f32 v50, v50
    s_waitcnt lgkmcnt(1)
    v_mfma_f32_32x32x16_bf16 v[128:143], v[192:195], v[208:211], v[128:143]
    v_exp_f32 v51, v51
    v_exp_f32 v52, v52
    v_exp_f32 v53, v53
    v_mfma_f32_32x32x16_bf16 v[80:95], v[28:31], v[44:47], v[80:95]
    v_exp_f32 v54, v54
    v_exp_f32 v55, v55
    v_exp_f32 v56, v56
    v_cvt_pk_bf16_f32 v40, v48, v49
    v_cvt_pk_bf16_f32 v41, v50, v51
    v_mfma_f32_32x32x16_bf16 v[144:159], v[192:195], v[212:215], v[144:159]
    v_cvt_pk_bf16_f32 v42, v52, v53
    v_cvt_pk_bf16_f32 v43, v54, v55
    v_exp_f32 v57, v57
    v_exp_f32 v58, v58
    v_mfma_f32_32x32x16_bf16 v[80:95], v[16:19], v[40:43], v[80:95]
    s_mov_b64 exec, s[4:5]
    ds_read_b128 v[24:27], v120 offset:23552
    ds_read_b128 v[28:31], v120 offset:24064
    s_mov_b64 exec, -1
    v_exp_f32 v59, v59
    v_exp_f32 v60, v60
    v_exp_f32 v61, v61
    v_exp_f32 v62, v62
    v_exp_f32 v63, v63
    v_cvt_pk_bf16_f32 v44, v56, v57
    v_cvt_pk_bf16_f32 v45, v58, v59
    v_cvt_pk_bf16_f32 v46, v60, v61
    v_cvt_pk_bf16_f32 v47, v62, v63
    s_setprio 0
    s_waitcnt lgkmcnt(2)
    v_mfma_f32_32x32x16_bf16 v[48:63], v[32:35], v[108:111], v[0:15]
    ds_read_b128 v[36:39], v117 offset:26624
    v_exp_f32 v64, v64
    v_exp_f32 v65, v65
    v_exp_f32 v66, v66
    v_mfma_f32_32x32x16_bf16 v[160:175], v[196:199], v[208:211], v[160:175]
    v_exp_f32 v67, v67
    v_exp_f32 v68, v68
    v_exp_f32 v69, v69
    v_mfma_f32_32x32x16_bf16 v[80:95], v[20:23], v[44:47], v[80:95]
    v_exp_f32 v70, v70
    v_exp_f32 v71, v71
    v_exp_f32 v72, v72
    v_cvt_pk_bf16_f32 v40, v64, v65
    v_cvt_pk_bf16_f32 v41, v66, v67
    v_mfma_f32_32x32x16_bf16 v[176:191], v[196:199], v[212:215], v[176:191]
    v_cvt_pk_bf16_f32 v42, v68, v69
    v_cvt_pk_bf16_f32 v43, v70, v71
    v_exp_f32 v73, v73
    s_waitcnt lgkmcnt(1)
    v_exp_f32 v74, v74
    v_mfma_f32_32x32x16_bf16 v[80:95], v[24:27], v[40:43], v[80:95]
    s_mov_b64 exec, s[4:5]
    ds_read_b128 v[16:19], v120 offset:25600
    ds_read_b128 v[20:23], v120 offset:26112
    s_mov_b64 exec, -1
    v_exp_f32 v75, v75
    v_exp_f32 v76, v76
    v_exp_f32 v77, v77
    v_exp_f32 v78, v78
    v_exp_f32 v79, v79
    v_cvt_pk_bf16_f32 v44, v72, v73
    v_cvt_pk_bf16_f32 v45, v74, v75
    v_cvt_pk_bf16_f32 v46, v76, v77
    v_cvt_pk_bf16_f32 v47, v78, v79
    s_setprio 3
    s_waitcnt lgkmcnt(2)
    v_mfma_f32_32x32x16_bf16 v[64:79], v[36:39], v[108:111], v[0:15]
    ds_read_b128 v[32:35], v117 offset:28672
    v_exp_f32 v48, v48
    v_exp_f32 v49, v49
    v_exp_f32 v50, v50
    ds_read_b64_tr_b16 v[192:193], v102 offset:0
    ds_read_b64_tr_b16 v[194:195], v102 offset:1024
    ds_read_b64_tr_b16 v[196:197], v103 offset:0
    ds_read_b64_tr_b16 v[198:199], v103 offset:1024
    ds_read_b64_tr_b16 v[200:201], v102 offset:2048
    ds_read_b64_tr_b16 v[202:203], v102 offset:3072
    ds_read_b64_tr_b16 v[204:205], v103 offset:2048
    ds_read_b64_tr_b16 v[206:207], v103 offset:3072
    v_exp_f32 v51, v51
    v_exp_f32 v52, v52
    v_exp_f32 v53, v53
    v_mfma_f32_32x32x16_bf16 v[80:95], v[28:31], v[44:47], v[80:95]
    v_exp_f32 v54, v54
    v_exp_f32 v55, v55
    v_exp_f32 v56, v56
    v_cvt_pk_bf16_f32 v40, v48, v49
    v_cvt_pk_bf16_f32 v41, v50, v51
    ds_read_b64_tr_b16 v[208:209], v102 offset:4096
    ds_read_b64_tr_b16 v[210:211], v102 offset:5120
    ds_read_b64_tr_b16 v[212:213], v103 offset:4096
    ds_read_b64_tr_b16 v[214:215], v103 offset:5120
    ds_read_b64_tr_b16 v[216:217], v102 offset:6144
    ds_read_b64_tr_b16 v[218:219], v102 offset:7168
    ds_read_b64_tr_b16 v[220:221], v103 offset:6144
    ds_read_b64_tr_b16 v[222:223], v103 offset:7168
    v_cvt_pk_bf16_f32 v42, v52, v53
    v_cvt_pk_bf16_f32 v43, v54, v55
    v_exp_f32 v57, v57
    s_waitcnt lgkmcnt(15)
    v_exp_f32 v58, v58
    v_mfma_f32_32x32x16_bf16 v[80:95], v[16:19], v[40:43], v[80:95]
    s_mov_b64 exec, s[4:5]
    ds_read_b128 v[24:27], v120 offset:27648
    ds_read_b128 v[28:31], v120 offset:28160
    s_mov_b64 exec, -1
    v_exp_f32 v59, v59
    v_exp_f32 v60, v60
    v_exp_f32 v61, v61
    s_lshl_b32 s6, s42, 14
    s_add_u32 s7, s6, 24576
    s_cmp_ge_u32 s42, 5
    s_cselect_b32 s6, s7, s6
    v_add_u32 v98, s6, v105
    v_exp_f32 v62, v62
    v_exp_f32 v63, v63
    v_cvt_pk_bf16_f32 v44, v56, v57
    v_cvt_pk_bf16_f32 v45, v58, v59
    v_cvt_pk_bf16_f32 v46, v60, v61
    v_cvt_pk_bf16_f32 v47, v62, v63
    s_setprio 2
    v_mfma_f32_32x32x16_bf16 v[48:63], v[32:35], v[108:111], v[0:15]
    ds_read_b128 v[36:39], v117 offset:30720
    v_exp_f32 v64, v64
    v_exp_f32 v65, v65
    v_exp_f32 v66, v66
    ds_read_b64_tr_b16 v[224:225], v102 offset:8192
    ds_read_b64_tr_b16 v[226:227], v102 offset:9216
    ds_read_b64_tr_b16 v[228:229], v103 offset:8192
    ds_read_b64_tr_b16 v[230:231], v103 offset:9216
    ds_read_b64_tr_b16 v[232:233], v102 offset:10240
    ds_read_b64_tr_b16 v[234:235], v102 offset:11264
    ds_read_b64_tr_b16 v[236:237], v103 offset:10240
    ds_read_b64_tr_b16 v[238:239], v103 offset:11264
    v_exp_f32 v67, v67
    v_exp_f32 v68, v68
    v_exp_f32 v69, v69
    v_mfma_f32_32x32x16_bf16 v[80:95], v[20:23], v[44:47], v[80:95]
    v_exp_f32 v70, v70
    v_exp_f32 v71, v71
    v_exp_f32 v72, v72
    v_cvt_pk_bf16_f32 v40, v64, v65
    v_cvt_pk_bf16_f32 v41, v66, v67
    ds_read_b64_tr_b16 v[240:241], v102 offset:12288
    ds_read_b64_tr_b16 v[242:243], v102 offset:13312
    ds_read_b64_tr_b16 v[244:245], v103 offset:12288
    ds_read_b64_tr_b16 v[246:247], v103 offset:13312
    v_cvt_pk_bf16_f32 v42, v68, v69
    v_cvt_pk_bf16_f32 v43, v70, v71
    v_exp_f32 v73, v73
    s_waitcnt lgkmcnt(13)
    v_exp_f32 v74, v74
    v_mfma_f32_32x32x16_bf16 v[80:95], v[24:27], v[40:43], v[80:95]
    s_mov_b64 exec, s[4:5]
    ds_read_b128 v[16:19], v120 offset:29696
    ds_read_b128 v[20:23], v120 offset:30208
    s_mov_b64 exec, -1
    v_exp_f32 v75, v75
    v_exp_f32 v76, v76
    v_exp_f32 v77, v77
    ds_read_b64_tr_b16 v[248:249], v102 offset:14336
    ds_read_b64_tr_b16 v[250:251], v102 offset:15360
    ds_read_b64_tr_b16 v[252:253], v103 offset:14336
    ds_read_b64_tr_b16 v[254:255], v103 offset:15360
    v_exp_f32 v78, v78
    v_exp_f32 v79, v79
    v_cvt_pk_bf16_f32 v44, v72, v73
    v_cvt_pk_bf16_f32 v45, v74, v75
    v_cvt_pk_bf16_f32 v46, v76, v77
    v_cvt_pk_bf16_f32 v47, v78, v79
    s_waitcnt lgkmcnt(0)
    s_barrier
    s_setprio 1
    v_mfma_f32_32x32x16_bf16 v[64:79], v[36:39], v[108:111], v[0:15]
    ds_read_b128 v[32:35], v117 offset:32768
    v_exp_f32 v48, v48
    v_exp_f32 v49, v49
    v_exp_f32 v50, v50
    ds_write_b128 v98, v[128:131] offset:0
    v_exp_f32 v51, v51
    v_exp_f32 v52, v52
    v_exp_f32 v53, v53
    v_mfma_f32_32x32x16_bf16 v[80:95], v[28:31], v[44:47], v[80:95]
    v_exp_f32 v54, v54
    v_exp_f32 v55, v55
    v_exp_f32 v56, v56
    v_cvt_pk_bf16_f32 v40, v48, v49
    v_cvt_pk_bf16_f32 v41, v50, v51
    ds_write_b128 v98, v[132:135] offset:1024
    v_cvt_pk_bf16_f32 v42, v52, v53
    v_cvt_pk_bf16_f32 v43, v54, v55
    v_exp_f32 v57, v57
    v_exp_f32 v58, v58
    v_mfma_f32_32x32x16_bf16 v[80:95], v[16:19], v[40:43], v[80:95]
    s_mov_b64 exec, s[4:5]
    ds_read_b128 v[24:27], v120 offset:31744
    ds_read_b128 v[28:31], v120 offset:32256
    s_mov_b64 exec, -1
    v_exp_f32 v59, v59
    v_exp_f32 v60, v60
    v_exp_f32 v61, v61
    ds_write_b128 v98, v[136:139] offset:2048
    v_exp_f32 v62, v62
    v_exp_f32 v63, v63
    v_cvt_pk_bf16_f32 v44, v56, v57
    v_cvt_pk_bf16_f32 v45, v58, v59
    v_cvt_pk_bf16_f32 v46, v60, v61
    v_cvt_pk_bf16_f32 v47, v62, v63
    s_setprio 0
    s_waitcnt lgkmcnt(5)
    v_mfma_f32_32x32x16_bf16 v[48:63], v[32:35], v[108:111], v[0:15]
    ds_read_b128 v[36:39], v117 offset:34816
    v_exp_f32 v64, v64
    v_exp_f32 v65, v65
    v_exp_f32 v66, v66
    ds_write_b128 v98, v[140:143] offset:3072
    v_exp_f32 v67, v67
    v_exp_f32 v68, v68
    v_exp_f32 v69, v69
    v_mfma_f32_32x32x16_bf16 v[80:95], v[20:23], v[44:47], v[80:95]
    v_exp_f32 v70, v70
    v_exp_f32 v71, v71
    v_exp_f32 v72, v72
    v_cvt_pk_bf16_f32 v40, v64, v65
    v_cvt_pk_bf16_f32 v41, v66, v67
    ds_write_b128 v98, v[144:147] offset:4096
    v_cvt_pk_bf16_f32 v42, v68, v69
    v_cvt_pk_bf16_f32 v43, v70, v71
    v_exp_f32 v73, v73
    s_waitcnt lgkmcnt(4)
    v_exp_f32 v74, v74
    v_mfma_f32_32x32x16_bf16 v[80:95], v[24:27], v[40:43], v[80:95]
    s_mov_b64 exec, s[4:5]
    ds_read_b128 v[16:19], v120 offset:33792
    ds_read_b128 v[20:23], v120 offset:34304
    s_mov_b64 exec, -1
    v_exp_f32 v75, v75
    v_exp_f32 v76, v76
    v_exp_f32 v77, v77
    ds_write_b128 v98, v[148:151] offset:5120
    v_exp_f32 v78, v78
    v_exp_f32 v79, v79
    v_cvt_pk_bf16_f32 v44, v72, v73
    v_cvt_pk_bf16_f32 v45, v74, v75
    v_cvt_pk_bf16_f32 v46, v76, v77
    v_cvt_pk_bf16_f32 v47, v78, v79
    s_setprio 3
    s_waitcnt lgkmcnt(5)
    v_mfma_f32_32x32x16_bf16 v[64:79], v[36:39], v[108:111], v[0:15]
    ds_read_b128 v[32:35], v117 offset:36864
    v_exp_f32 v48, v48
    v_exp_f32 v49, v49
    v_exp_f32 v50, v50
    ds_write_b128 v98, v[152:155] offset:6144
    v_exp_f32 v51, v51
    v_exp_f32 v52, v52
    v_exp_f32 v53, v53
    v_mfma_f32_32x32x16_bf16 v[80:95], v[28:31], v[44:47], v[80:95]
    v_exp_f32 v54, v54
    v_exp_f32 v55, v55
    v_exp_f32 v56, v56
    v_cvt_pk_bf16_f32 v40, v48, v49
    v_cvt_pk_bf16_f32 v41, v50, v51
    ds_write_b128 v98, v[156:159] offset:7168
    v_cvt_pk_bf16_f32 v42, v52, v53
    v_cvt_pk_bf16_f32 v43, v54, v55
    v_exp_f32 v57, v57
    s_waitcnt lgkmcnt(4)
    v_exp_f32 v58, v58
    v_mfma_f32_32x32x16_bf16 v[80:95], v[16:19], v[40:43], v[80:95]
    s_mov_b64 exec, s[4:5]
    ds_read_b128 v[24:27], v120 offset:35840
    ds_read_b128 v[28:31], v120 offset:36352
    s_mov_b64 exec, -1
    v_exp_f32 v59, v59
    v_exp_f32 v60, v60
    v_exp_f32 v61, v61
    v_exp_f32 v62, v62
    v_exp_f32 v63, v63
    v_cvt_pk_bf16_f32 v44, v56, v57
    v_cvt_pk_bf16_f32 v45, v58, v59
    v_cvt_pk_bf16_f32 v46, v60, v61
    v_cvt_pk_bf16_f32 v47, v62, v63
    s_setprio 2
    s_waitcnt lgkmcnt(4)
    v_mfma_f32_32x32x16_bf16 v[48:63], v[32:35], v[108:111], v[0:15]
    ds_read_b128 v[36:39], v117 offset:38912
    v_exp_f32 v64, v64
    v_exp_f32 v65, v65
    v_exp_f32 v66, v66
    ds_write_b128 v98, v[160:163] offset:8192
    v_exp_f32 v67, v67
    v_exp_f32 v68, v68
    v_exp_f32 v69, v69
    v_mfma_f32_32x32x16_bf16 v[80:95], v[20:23], v[44:47], v[80:95]
    v_exp_f32 v70, v70
    v_exp_f32 v71, v71
    v_exp_f32 v72, v72
    v_cvt_pk_bf16_f32 v40, v64, v65
    v_cvt_pk_bf16_f32 v41, v66, v67
    ds_write_b128 v98, v[164:167] offset:9216
    v_cvt_pk_bf16_f32 v42, v68, v69
    v_cvt_pk_bf16_f32 v43, v70, v71
    v_exp_f32 v73, v73
    s_waitcnt lgkmcnt(3)
    v_exp_f32 v74, v74
    v_mfma_f32_32x32x16_bf16 v[80:95], v[24:27], v[40:43], v[80:95]
    s_mov_b64 exec, s[4:5]
    ds_read_b128 v[16:19], v120 offset:37888
    ds_read_b128 v[20:23], v120 offset:38400
    s_mov_b64 exec, -1
    v_exp_f32 v75, v75
    v_exp_f32 v76, v76
    v_exp_f32 v77, v77
    ds_write_b128 v98, v[168:171] offset:10240
    v_exp_f32 v78, v78
    v_exp_f32 v79, v79
    v_cvt_pk_bf16_f32 v44, v72, v73
    v_cvt_pk_bf16_f32 v45, v74, v75
    v_cvt_pk_bf16_f32 v46, v76, v77
    v_cvt_pk_bf16_f32 v47, v78, v79
    s_setprio 1
    s_waitcnt lgkmcnt(5)
    v_mfma_f32_32x32x16_bf16 v[64:79], v[36:39], v[108:111], v[0:15]
    v_exp_f32 v48, v48
    v_exp_f32 v49, v49
    v_exp_f32 v50, v50
    ds_write_b128 v98, v[172:175] offset:11264
    v_exp_f32 v51, v51
    v_exp_f32 v52, v52
    v_exp_f32 v53, v53
    v_mfma_f32_32x32x16_bf16 v[80:95], v[28:31], v[44:47], v[80:95]
    v_exp_f32 v54, v54
    v_exp_f32 v55, v55
    v_exp_f32 v56, v56
    v_cvt_pk_bf16_f32 v40, v48, v49
    v_cvt_pk_bf16_f32 v41, v50, v51
    ds_write_b128 v98, v[176:179] offset:12288
    v_cvt_pk_bf16_f32 v42, v52, v53
    v_cvt_pk_bf16_f32 v43, v54, v55
    v_exp_f32 v57, v57
    s_waitcnt lgkmcnt(3)
    v_exp_f32 v58, v58
    v_mfma_f32_32x32x16_bf16 v[80:95], v[16:19], v[40:43], v[80:95]
    s_mov_b64 exec, s[4:5]
    ds_read_b128 v[24:27], v120 offset:39936
    ds_read_b128 v[28:31], v120 offset:40448
    s_mov_b64 exec, -1
    v_exp_f32 v59, v59
    v_exp_f32 v60, v60
    v_exp_f32 v61, v61
    ds_write_b128 v98, v[180:183] offset:13312
    v_exp_f32 v62, v62
    v_exp_f32 v63, v63
    v_cvt_pk_bf16_f32 v44, v56, v57
    v_cvt_pk_bf16_f32 v45, v58, v59
    v_cvt_pk_bf16_f32 v46, v60, v61
    v_cvt_pk_bf16_f32 v47, v62, v63
    s_setprio 0
    v_exp_f32 v64, v64
    v_exp_f32 v65, v65
    v_exp_f32 v66, v66
    ds_write_b128 v98, v[184:187] offset:14336
    v_exp_f32 v67, v67
    v_exp_f32 v68, v68
    v_exp_f32 v69, v69
    v_mfma_f32_32x32x16_bf16 v[80:95], v[20:23], v[44:47], v[80:95]
    v_exp_f32 v70, v70
    v_exp_f32 v71, v71
    v_exp_f32 v72, v72
    v_cvt_pk_bf16_f32 v40, v64, v65
    v_cvt_pk_bf16_f32 v41, v66, v67
    ds_write_b128 v98, v[188:191] offset:15360
    v_cvt_pk_bf16_f32 v42, v68, v69
    v_cvt_pk_bf16_f32 v43, v70, v71
    v_exp_f32 v73, v73
    s_waitcnt lgkmcnt(3)
    v_exp_f32 v74, v74
    v_mfma_f32_32x32x16_bf16 v[80:95], v[24:27], v[40:43], v[80:95]
    v_exp_f32 v75, v75
    v_exp_f32 v76, v76
    v_exp_f32 v77, v77
    v_exp_f32 v78, v78
    v_exp_f32 v79, v79
    v_cvt_pk_bf16_f32 v44, v72, v73
    v_cvt_pk_bf16_f32 v45, v74, v75
    v_cvt_pk_bf16_f32 v46, v76, v77
    v_cvt_pk_bf16_f32 v47, v78, v79
    s_nop 1
    v_mfma_f32_32x32x16_bf16 v[80:95], v[28:31], v[44:47], v[80:95]
    s_waitcnt lgkmcnt(0)
    v_mov_b32 v97, 0x71800000
    s_lshr_b32 s6, s57, 15
    s_lshr_b32 s7, s42, 1
    s_mul_i32 s6, s6, 144
    s_lshl_b32 s7, s7, 3
    s_add_u32 s6, s6, s7
    s_lshl_b32 s6, s6, 10
    s_add_u32 s66, s6, 6291456
    s_add_u32 s67, s66, 4096
    s_nop 1
    v_cmp_nlt_f32 vcc, v88, v97
    s_nop 1
    s_cbranch_vccnz L_SLOW
L_FIN:
    v_rcp_f32 v89, v88
    s_setprio 0
    v_mul_f32 v80, v89, v80
    v_mul_f32 v81, v89, v81
    v_mul_f32 v82, v89, v82
    v_mul_f32 v83, v89, v83
    v_mul_f32 v84, v89, v84
    v_mul_f32 v85, v89, v85
    v_mul_f32 v86, v89, v86
    v_mul_f32 v87, v89, v87
    v_cvt_pk_bf16_f32 v80, v80, v81
    v_cvt_pk_bf16_f32 v81, v82, v83
    v_cvt_pk_bf16_f32 v82, v84, v85
    v_cvt_pk_bf16_f32 v83, v86, v87
    v_min_u32 v80, -2, v80
    v_min_u32 v81, -2, v81
    v_min_u32 v82, -2, v82
    v_min_u32 v83, -2, v83
    buffer_store_dwordx4 v[80:83], v105, s[32:35], s58 offen sc1
    s_lshr_b32 s3, s42, 2
    s_lshl_b32 s3, s3, 1
    s_and_b32 s4, s42, 1
    s_add_u32 s3, s3, s4
    s_lshl_b32 s3, s3, 12
    s_and_b32 s4, s42, 2
    s_lshl_b32 s4, s4, 10
    s_add_u32 s3, s3, s4
    v_add_u32 v98, s3, v105
    v_add_u32 v99, 65536, v98
    v_add_u32 v100, 131072, v98
    s_barrier
    ds_read_b128 v[128:131], v98 offset:0
    ds_read_b128 v[132:135], v98 offset:1024
    ds_read_b128 v[136:139], v98 offset:16384
    ds_read_b128 v[140:143], v98 offset:17408
    ds_read_b128 v[144:147], v98 offset:32768
    ds_read_b128 v[148:151], v98 offset:33792
    ds_read_b128 v[152:155], v98 offset:49152
    ds_read_b128 v[156:159], v98 offset:50176
    ds_read_b128 v[160:163], v99 offset:0
    ds_read_b128 v[164:167], v99 offset:1024
    ds_read_b128 v[168:171], v99 offset:40960
    ds_read_b128 v[172:175], v99 offset:41984
    ds_read_b128 v[176:179], v99 offset:57344
    ds_read_b128 v[180:183], v99 offset:58368
    ds_read_b128 v[184:187], v100 offset:8192
    ds_read_b128 v[188:191], v100 offset:9216
    buffer_load_dwordx4 v[48:51], v105, s[32:35], s66 offen offset:0 sc1
    v_pk_mov_b32 v[0:1], 0, 0
    v_pk_mov_b32 v[2:3], 0, 0
    v_pk_mov_b32 v[4:5], 0, 0
    v_pk_mov_b32 v[6:7], 0, 0
    v_pk_mov_b32 v[8:9], 0, 0
    v_pk_mov_b32 v[10:11], 0, 0
    v_pk_mov_b32 v[12:13], 0, 0
    v_pk_mov_b32 v[14:15], 0, 0
    v_pk_mov_b32 v[16:17], 0, 0
    v_pk_mov_b32 v[18:19], 0, 0
    v_pk_mov_b32 v[20:21], 0, 0
    v_pk_mov_b32 v[22:23], 0, 0
    v_pk_mov_b32 v[24:25], 0, 0
    v_pk_mov_b32 v[26:27], 0, 0
    v_pk_mov_b32 v[28:29], 0, 0
    v_pk_mov_b32 v[30:31], 0, 0
    s_lshl_b32 s3, s42, 13
    v_add_u32 v96, s3, v105
    s_and_b32 s3, s42, 1
    s_lshl_b32 s3, s3, 13
    s_lshr_b32 s4, s42, 1
    s_lshl_b32 s4, s4, 11
    s_add_u32 s3, s3, s4
    v_add_u32 v97, s3, v105
    v_lshlrev_b32 v40, 16, v112
    v_and_b32 v41, 0xffff0000, v112
    v_lshlrev_b32 v42, 16, v113
    v_and_b32 v43, 0xffff0000, v113
    v_lshlrev_b32 v44, 16, v114
    v_and_b32 v45, 0xffff0000, v114
    v_lshlrev_b32 v46, 16, v115
    v_and_b32 v47, 0xffff0000, v115
    s_waitcnt lgkmcnt(12)
    v_pk_add_f32 v[128:129], v[128:129], v[136:137]
    v_pk_add_f32 v[130:131], v[130:131], v[138:139]
    v_pk_add_f32 v[132:133], v[132:133], v[140:141]
    v_pk_add_f32 v[134:135], v[134:135], v[142:143]
    buffer_load_dwordx4 v[52:55], v105, s[32:35], s66 offen offset:1024 sc1
    s_waitcnt lgkmcnt(10)
    v_pk_add_f32 v[128:129], v[128:129], v[144:145]
    v_pk_add_f32 v[130:131], v[130:131], v[146:147]
    v_pk_add_f32 v[132:133], v[132:133], v[148:149]
    v_pk_add_f32 v[134:135], v[134:135], v[150:151]
    buffer_load_dwordx4 v[56:59], v105, s[32:35], s66 offen offset:2048 sc1
    s_waitcnt lgkmcnt(8)
    v_pk_add_f32 v[128:129], v[128:129], v[152:153]
    v_pk_add_f32 v[130:131], v[130:131], v[154:155]
    v_pk_add_f32 v[132:133], v[132:133], v[156:157]
    v_pk_add_f32 v[134:135], v[134:135], v[158:159]
    buffer_load_dwordx4 v[60:63], v105, s[32:35], s66 offen offset:3072 sc1
    s_waitcnt lgkmcnt(6)
    v_pk_add_f32 v[128:129], v[128:129], v[160:161]
    v_pk_add_f32 v[130:131], v[130:131], v[162:163]
    v_pk_add_f32 v[132:133], v[132:133], v[164:165]
    v_pk_add_f32 v[134:135], v[134:135], v[166:167]
    buffer_load_dwordx4 v[64:67], v105, s[32:35], s67 offen offset:0 sc1
    s_waitcnt lgkmcnt(4)
    v_pk_add_f32 v[128:129], v[128:129], v[168:169]
    v_pk_add_f32 v[130:131], v[130:131], v[170:171]
    v_pk_add_f32 v[132:133], v[132:133], v[172:173]
    v_pk_add_f32 v[134:135], v[134:135], v[174:175]
    buffer_load_dwordx4 v[68:71], v105, s[32:35], s67 offen offset:1024 sc1
    s_waitcnt lgkmcnt(2)
    v_pk_add_f32 v[128:129], v[128:129], v[176:177]
    v_pk_add_f32 v[130:131], v[130:131], v[178:179]
    v_pk_add_f32 v[132:133], v[132:133], v[180:181]
    v_pk_add_f32 v[134:135], v[134:135], v[182:183]
    buffer_load_dwordx4 v[72:75], v105, s[32:35], s67 offen offset:2048 sc1
    s_waitcnt lgkmcnt(0)
    v_pk_add_f32 v[128:129], v[128:129], v[184:185]
    v_pk_add_f32 v[130:131], v[130:131], v[186:187]
    v_pk_add_f32 v[132:133], v[132:133], v[188:189]
    v_pk_add_f32 v[134:135], v[134:135], v[190:191]
    buffer_load_dwordx4 v[76:79], v105, s[32:35], s67 offen offset:3072 sc1
    s_barrier
    s_movk_i32 s4, 0xff
    s_waitcnt vmcnt(7)
    v_max3_u32 v101, v48, v49, v50
    v_max_u32 v101, v101, v51
    v_cmp_eq_u32 vcc, -1, v101
    s_nop 1
    s_cbranch_vccnz L_O1_0
    v_mfma_f32_32x32x16_bf16 v[0:15], v[192:195], v[48:51], v[0:15]
    v_mfma_f32_32x32x16_bf16 v[16:31], v[196:199], v[48:51], v[16:31]
    s_bitset0_b32 s4, 0
L_O1_0:
    s_waitcnt vmcnt(6)
    v_max3_u32 v101, v52, v53, v54
    v_max_u32 v101, v101, v55
    v_cmp_eq_u32 vcc, -1, v101
    s_nop 1
    s_cbranch_vccnz L_O1_1
    v_mfma_f32_32x32x16_bf16 v[0:15], v[200:203], v[52:55], v[0:15]
    v_mfma_f32_32x32x16_bf16 v[16:31], v[204:207], v[52:55], v[16:31]
    s_bitset0_b32 s4, 1
L_O1_1:
    s_waitcnt vmcnt(5)
    v_max3_u32 v101, v56, v57, v58
    v_max_u32 v101, v101, v59
    v_cmp_eq_u32 vcc, -1, v101
    s_nop 1
    s_cbranch_vccnz L_O1_2
    v_mfma_f32_32x32x16_bf16 v[0:15], v[208:211], v[56:59], v[0:15]
    v_mfma_f32_32x32x16_bf16 v[16:31], v[212:215], v[56:59], v[16:31]
    s_bitset0_b32 s4, 2
L_O1_2:
    s_waitcnt vmcnt(4)
    v_max3_u32 v101, v60, v61, v62
    v_max_u32 v101, v101, v63
    v_cmp_eq_u32 vcc, -1, v101
    s_nop 1
    s_cbranch_vccnz L_O1_3
    v_mfma_f32_32x32x16_bf16 v[0:15], v[216:219], v[60:63], v[0:15]
    v_mfma_f32_32x32x16_bf16 v[16:31], v[220:223], v[60:63], v[16:31]
    s_bitset0_b32 s4, 3
L_O1_3:
    s_waitcnt vmcnt(3)
    v_max3_u32 v101, v64, v65, v66
    v_max_u32 v101, v101, v67
    v_cmp_eq_u32 vcc, -1, v101
    s_nop 1
    s_cbranch_vccnz L_O1_4
    v_mfma_f32_32x32x16_bf16 v[0:15], v[224:227], v[64:67], v[0:15]
    v_mfma_f32_32x32x16_bf16 v[16:31], v[228:231], v[64:67], v[16:31]
    s_bitset0_b32 s4, 4
L_O1_4:
    s_waitcnt vmcnt(2)
    v_max3_u32 v101, v68, v69, v70
    v_max_u32 v101, v101, v71
    v_cmp_eq_u32 vcc, -1, v101
    s_nop 1
    s_cbranch_vccnz L_O1_5
    v_mfma_f32_32x32x16_bf16 v[0:15], v[232:235], v[68:71], v[0:15]
    v_mfma_f32_32x32x16_bf16 v[16:31], v[236:239], v[68:71], v[16:31]
    s_bitset0_b32 s4, 5
L_O1_5:
    s_waitcnt vmcnt(1)
    v_max3_u32 v101, v72, v73, v74
    v_max_u32 v101, v101, v75
    v_cmp_eq_u32 vcc, -1, v101
    s_nop 1
    s_cbranch_vccnz L_O1_6
    v_mfma_f32_32x32x16_bf16 v[0:15], v[240:243], v[72:75], v[0:15]
    v_mfma_f32_32x32x16_bf16 v[16:31], v[244:247], v[72:75], v[16:31]
    s_bitset0_b32 s4, 6
L_O1_6:
    s_waitcnt vmcnt(0)
    v_max3_u32 v101, v76, v77, v78
    v_max_u32 v101, v101, v79
    v_cmp_eq_u32 vcc, -1, v101
    s_nop 1
    s_cbranch_vccnz L_O1_7
    v_mfma_f32_32x32x16_bf16 v[0:15], v[248:251], v[76:79], v[0:15]
    v_mfma_f32_32x32x16_bf16 v[16:31], v[252:255], v[76:79], v[16:31]
    s_bitset0_b32 s4, 7
L_O1_7:
    s_cmp_eq_u32 s4, 0
    s_cbranch_scc1 L_ODONE
    s_mov_b32 s3, 20000
L_ORETRY:
    s_sleep 1
    s_bitcmp0_b32 s4, 0
    s_cbranch_scc1 L_O2_0
    buffer_load_dwordx4 v[48:51], v105, s[32:35], s66 offen offset:0 sc1
L_O2_0:
    s_bitcmp0_b32 s4, 1
    s_cbranch_scc1 L_O2_1
    buffer_load_dwordx4 v[52:55], v105, s[32:35], s66 offen offset:1024 sc1
L_O2_1:
    s_bitcmp0_b32 s4, 2
    s_cbranch_scc1 L_O2_2
    buffer_load_dwordx4 v[56:59], v105, s[32:35], s66 offen offset:2048 sc1
L_O2_2:
    s_bitcmp0_b32 s4, 3
    s_cbranch_scc1 L_O2_3
    buffer_load_dwordx4 v[60:63], v105, s[32:35], s66 offen offset:3072 sc1
L_O2_3:
    s_bitcmp0_b32 s4, 4
    s_cbranch_scc1 L_O2_4
    buffer_load_dwordx4 v[64:67], v105, s[32:35], s67 offen offset:0 sc1
L_O2_4:
    s_bitcmp0_b32 s4, 5
    s_cbranch_scc1 L_O2_5
    buffer_load_dwordx4 v[68:71], v105, s[32:35], s67 offen offset:1024 sc1
L_O2_5:
    s_bitcmp0_b32 s4, 6
    s_cbranch_scc1 L_O2_6
    buffer_load_dwordx4 v[72:75], v105, s[32:35], s67 offen offset:2048 sc1
L_O2_6:
    s_bitcmp0_b32 s4, 7
    s_cbranch_scc1 L_O2_7
    buffer_load_dwordx4 v[76:79], v105, s[32:35], s67 offen offset:3072 sc1
L_O2_7:
    s_waitcnt vmcnt(0)
    s_sub_u32 s3, s3, 1
    s_cmp_eq_u32 s3, 0
    s_cselect_b64 s[6:7], 0, -1
    s_bitcmp0_b32 s4, 0
    s_cbranch_scc1 L_O3_0
    v_max3_u32 v101, v48, v49, v50
    v_max_u32 v101, v101, v51
    v_cmp_eq_u32 vcc, -1, v101
    s_nop 1
    s_nop 0
    s_and_b64 vcc, vcc, s[6:7]
    s_cbranch_vccnz L_O3_0
    v_mfma_f32_32x32x16_bf16 v[0:15], v[192:195], v[48:51], v[0:15]
    v_mfma_f32_32x32x16_bf16 v[16:31], v[196:199], v[48:51], v[16:31]
    s_bitset0_b32 s4, 0
L_O3_0:
    s_bitcmp0_b32 s4, 1
    s_cbranch_scc1 L_O3_1
    v_max3_u32 v101, v52, v53, v54
    v_max_u32 v101, v101, v55
    v_cmp_eq_u32 vcc, -1, v101
    s_nop 1
    s_nop 0
    s_and_b64 vcc, vcc, s[6:7]
    s_cbranch_vccnz L_O3_1
    v_mfma_f32_32x32x16_bf16 v[0:15], v[200:203], v[52:55], v[0:15]
    v_mfma_f32_32x32x16_bf16 v[16:31], v[204:207], v[52:55], v[16:31]
    s_bitset0_b32 s4, 1
L_O3_1:
    s_bitcmp0_b32 s4, 2
    s_cbranch_scc1 L_O3_2
    v_max3_u32 v101, v56, v57, v58
    v_max_u32 v101, v101, v59
    v_cmp_eq_u32 vcc, -1, v101
    s_nop 1
    s_nop 0
    s_and_b64 vcc, vcc, s[6:7]
    s_cbranch_vccnz L_O3_2
    v_mfma_f32_32x32x16_bf16 v[0:15], v[208:211], v[56:59], v[0:15]
    v_mfma_f32_32x32x16_bf16 v[16:31], v[212:215], v[56:59], v[16:31]
    s_bitset0_b32 s4, 2
L_O3_2:
    s_bitcmp0_b32 s4, 3
    s_cbranch_scc1 L_O3_3
    v_max3_u32 v101, v60, v61, v62
    v_max_u32 v101, v101, v63
    v_cmp_eq_u32 vcc, -1, v101
    s_nop 1
    s_nop 0
    s_and_b64 vcc, vcc, s[6:7]
    s_cbranch_vccnz L_O3_3
    v_mfma_f32_32x32x16_bf16 v[0:15], v[216:219], v[60:63], v[0:15]
    v_mfma_f32_32x32x16_bf16 v[16:31], v[220:223], v[60:63], v[16:31]
    s_bitset0_b32 s4, 3
L_O3_3:
    s_bitcmp0_b32 s4, 4
    s_cbranch_scc1 L_O3_4
    v_max3_u32 v101, v64, v65, v66
    v_max_u32 v101, v101, v67
    v_cmp_eq_u32 vcc, -1, v101
    s_nop 1
    s_nop 0
    s_and_b64 vcc, vcc, s[6:7]
    s_cbranch_vccnz L_O3_4
    v_mfma_f32_32x32x16_bf16 v[0:15], v[224:227], v[64:67], v[0:15]
    v_mfma_f32_32x32x16_bf16 v[16:31], v[228:231], v[64:67], v[16:31]
    s_bitset0_b32 s4, 4
L_O3_4:
    s_bitcmp0_b32 s4, 5
    s_cbranch_scc1 L_O3_5
    v_max3_u32 v101, v68, v69, v70
    v_max_u32 v101, v101, v71
    v_cmp_eq_u32 vcc, -1, v101
    s_nop 1
    s_nop 0
    s_and_b64 vcc, vcc, s[6:7]
    s_cbranch_vccnz L_O3_5
    v_mfma_f32_32x32x16_bf16 v[0:15], v[232:235], v[68:71], v[0:15]
    v_mfma_f32_32x32x16_bf16 v[16:31], v[236:239], v[68:71], v[16:31]
    s_bitset0_b32 s4, 5
L_O3_5:
    s_bitcmp0_b32 s4, 6
    s_cbranch_scc1 L_O3_6
    v_max3_u32 v101, v72, v73, v74
    v_max_u32 v101, v101, v75
    v_cmp_eq_u32 vcc, -1, v101
    s_nop 1
    s_nop 0
    s_and_b64 vcc, vcc, s[6:7]
    s_cbranch_vccnz L_O3_6
    v_mfma_f32_32x32x16_bf16 v[0:15], v[240:243], v[72:75], v[0:15]
    v_mfma_f32_32x32x16_bf16 v[16:31], v[244:247], v[72:75], v[16:31]
    s_bitset0_b32 s4, 6
L_O3_6:
    s_bitcmp0_b32 s4, 7
    s_cbranch_scc1 L_O3_7
    v_max3_u32 v101, v76, v77, v78
    v_max_u32 v101, v101, v79
    v_cmp_eq_u32 vcc, -1, v101
    s_nop 1
    s_nop 0
    s_and_b64 vcc, vcc, s[6:7]
    s_cbranch_vccnz L_O3_7
    v_mfma_f32_32x32x16_bf16 v[0:15], v[248:251], v[76:79], v[0:15]
    v_mfma_f32_32x32x16_bf16 v[16:31], v[252:255], v[76:79], v[16:31]
    s_bitset0_b32 s4, 7
L_O3_7:
    s_cmp_lg_u32 s4, 0
    s_cbranch_scc1 L_ORETRY
    s_nop 15
L_ODONE:
    s_nop 11
    ds_write_b128 v96, v[0:3] offset:0
    ds_write_b128 v96, v[4:7] offset:1024
    ds_write_b128 v96, v[8:11] offset:2048
    ds_write_b128 v96, v[12:15] offset:3072
    ds_write_b128 v96, v[16:19] offset:4096
    ds_write_b128 v96, v[20:23] offset:5120
    ds_write_b128 v96, v[24:27] offset:6144
    ds_write_b128 v96, v[28:31] offset:7168
    s_waitcnt lgkmcnt(0)
    s_barrier
    ds_read_b128 v[48:51], v97 offset:0
    ds_read_b128 v[52:55], v97 offset:1024
    ds_read_b128 v[56:59], v97 offset:16384
    ds_read_b128 v[60:63], v97 offset:17408
    ds_read_b128 v[64:67], v97 offset:32768
    ds_read_b128 v[68:71], v97 offset:33792
    ds_read_b128 v[72:75], v97 offset:49152
    ds_read_b128 v[76:79], v97 offset:50176
    s_waitcnt lgkmcnt(6)
    v_pk_add_f32 v[128:129], v[128:129], v[48:49]
    v_pk_add_f32 v[130:131], v[130:131], v[50:51]
    v_pk_add_f32 v[132:133], v[132:133], v[52:53]
    v_pk_add_f32 v[134:135], v[134:135], v[54:55]
    s_waitcnt lgkmcnt(4)
    v_pk_add_f32 v[128:129], v[128:129], v[56:57]
    v_pk_add_f32 v[130:131], v[130:131], v[58:59]
    v_pk_add_f32 v[132:133], v[132:133], v[60:61]
    v_pk_add_f32 v[134:135], v[134:135], v[62:63]
    s_waitcnt lgkmcnt(2)
    v_pk_add_f32 v[128:129], v[128:129], v[64:65]
    v_pk_add_f32 v[130:131], v[130:131], v[66:67]
    v_pk_add_f32 v[132:133], v[132:133], v[68:69]
    v_pk_add_f32 v[134:135], v[134:135], v[70:71]
    s_waitcnt lgkmcnt(0)
    v_pk_add_f32 v[128:129], v[128:129], v[72:73]
    v_pk_add_f32 v[130:131], v[130:131], v[74:75]
    v_pk_add_f32 v[132:133], v[132:133], v[76:77]
    v_pk_add_f32 v[134:135], v[134:135], v[78:79]
    s_nop 0
    v_permlane32_swap_b32 v128, v132
    v_permlane32_swap_b32 v129, v133
    v_permlane32_swap_b32 v130, v134
    v_permlane32_swap_b32 v131, v135
    v_pk_add_f32 v[128:129], v[128:129], v[40:41]
    v_pk_add_f32 v[130:131], v[130:131], v[42:43]
    v_pk_add_f32 v[132:133], v[132:133], v[44:45]
    v_pk_add_f32 v[134:135], v[134:135], v[46:47]
    v_cvt_pk_bf16_f32 v128, v128, v129
    v_cvt_pk_bf16_f32 v129, v130, v131
    v_cvt_pk_bf16_f32 v130, v132, v133
    v_cvt_pk_bf16_f32 v131, v134, v135
    buffer_store_dwordx4 v[128:131], v125, s[20:23], s57 offen
L_END:
    s_endpgm
L_SLOW:
    v_mov_b32 v96, 0xff800000
    s_mov_b32 s3, 0
    s_sub_u32 s6, s48, s56
L_SLOW1:
    buffer_load_dwordx4 v[32:35], v105, s[32:35], s6 offen sc1
    s_waitcnt vmcnt(0)
    v_mfma_f32_32x32x16_bf16 v[48:63], v[32:35], v[108:111], 0
    s_nop 15
    v_max3_f32 v96, v96, v48, v49
    v_max3_f32 v96, v96, v50, v51
    v_max3_f32 v96, v96, v52, v53
    v_max3_f32 v96, v96, v54, v55
    v_max3_f32 v96, v96, v56, v57
    v_max3_f32 v96, v96, v58, v59
    v_max3_f32 v96, v96, v60, v61
    v_max3_f32 v96, v96, v62, v63
    s_add_u32 s6, s6, 2048
    s_add_u32 s3, s3, 1
    s_cmp_lt_u32 s3, 64
    s_cbranch_scc1 L_SLOW1
    v_mov_b32 v97, v96
    s_nop 1
    v_permlane32_swap_b32 v96, v97
    s_nop 1
    v_max_f32 v96, v96, v97
    v_sub_f32 v0, 0, v96
    v_sub_f32 v1, 0, v96
    v_sub_f32 v2, 0, v96
    v_sub_f32 v3, 0, v96
    v_sub_f32 v4, 0, v96
    v_sub_f32 v5, 0, v96
    v_sub_f32 v6, 0, v96
    v_sub_f32 v7, 0, v96
    v_sub_f32 v8, 0, v96
    v_sub_f32 v9, 0, v96
    v_sub_f32 v10, 0, v96
    v_sub_f32 v11, 0, v96
    v_sub_f32 v12, 0, v96
    v_sub_f32 v13, 0, v96
    v_sub_f32 v14, 0, v96
    v_sub_f32 v15, 0, v96
    v_mov_b32 v80, 0
    v_mov_b32 v81, 0
    v_mov_b32 v82, 0
    v_mov_b32 v83, 0
    v_mov_b32 v84, 0
    v_mov_b32 v85, 0
    v_mov_b32 v86, 0
    v_mov_b32 v87, 0
    v_mov_b32 v88, 0
    v_mov_b32 v89, 0
    v_mov_b32 v90, 0
    v_mov_b32 v91, 0
    v_mov_b32 v92, 0
    v_mov_b32 v93, 0
    v_mov_b32 v94, 0
    v_mov_b32 v95, 0
    s_mov_b32 s3, 0
    s_sub_u32 s6, s48, s56
L_SLOW2:
    buffer_load_dwordx4 v[32:35], v105, s[32:35], s6 offen sc1
    s_mov_b64 exec, s[4:5]
    buffer_load_dwordx4 v[16:19], v119, s[32:35], s6 offen offset:1024 sc1
    buffer_load_dwordx4 v[20:23], v119, s[32:35], s6 offen offset:1536 sc1
    s_mov_b64 exec, -1
    s_waitcnt vmcnt(0)
    v_mfma_f32_32x32x16_bf16 v[48:63], v[32:35], v[108:111], v[0:15]
    s_nop 15
    v_exp_f32 v48, v48
    v_exp_f32 v49, v49
    v_exp_f32 v50, v50
    v_exp_f32 v51, v51
    v_exp_f32 v52, v52
    v_exp_f32 v53, v53
    v_exp_f32 v54, v54
    v_exp_f32 v55, v55
    v_exp_f32 v56, v56
    v_exp_f32 v57, v57
    v_exp_f32 v58, v58
    v_exp_f32 v59, v59
    v_exp_f32 v60, v60
    v_exp_f32 v61, v61
    v_exp_f32 v62, v62
    v_exp_f32 v63, v63
    s_nop 1
    v_cvt_pk_bf16_f32 v40, v48, v49
    v_cvt_pk_bf16_f32 v41, v50, v51
    v_cvt_pk_bf16_f32 v42, v52, v53
    v_cvt_pk_bf16_f32 v43, v54, v55
    v_cvt_pk_bf16_f32 v44, v56, v57
    v_cvt_pk_bf16_f32 v45, v58, v59
    v_cvt_pk_bf16_f32 v46, v60, v61
    v_cvt_pk_bf16_f32 v47, v62, v63
    s_nop 1
    v_mfma_f32_32x32x16_bf16 v[80:95], v[16:19], v[40:43], v[80:95]
    v_mfma_f32_32x32x16_bf16 v[80:95], v[20:23], v[44:47], v[80:95]
    s_add_u32 s6, s6, 2048
    s_add_u32 s3, s3, 1
    s_cmp_lt_u32 s3, 64
    s_cbranch_scc1 L_SLOW2
    s_nop 15
    s_branch L_FIN
L_QK1:
    v_add_u32 v72, 98304, v1
    v_xor_b32 v76, 32, v72
    v_add_u32 v73, 98304, v2
    v_xor_b32 v77, 32, v73
    v_add_u32 v74, 98304, v3
    v_xor_b32 v78, 32, v74
    v_add_u32 v75, 98304, v4
    v_xor_b32 v79, 32, v75
    s_lshr_b32 s0, s57, 7
    s_and_b32 s1, s0, 7
    s_lshl_b32 s1, s1, 1
    s_add_u32 s1, s1, s44
    s_lshl_b32 s1, s1, 7
    s_add_u32 s1, s1, s61
    s_lshl_b32 s66, s1, 10
    s_lshl_b32 s67, s1, 11
    s_add_u32 s67, s67, 2097152
    s_cmp_ge_u32 s0, 8
    s_cselect_b32 s66, s67, s66
    s_cselect_b32 s67, 2, 1
    s_lshl_b32 s67, s67, 16
    s_add_u32 s67, s67, s66
    s_lshr_b32 s40, s58, 5
    s_lshl_b32 s71, s44, 1
    s_add_u32 s40, s40, s71
    s_mul_i32 s71, s61, 144
    s_add_u32 s40, s40, s71
    s_lshl_b32 s40, s40, 10
    s_add_u32 s40, s40, 6324224
    s_lshr_b32 s41, s60, 5
    s_lshl_b32 s71, s44, 1
    s_add_u32 s41, s41, s71
    s_mul_i32 s71, s61, 144
    s_add_u32 s41, s41, s71
    s_lshl_b32 s41, s41, 10
    s_add_u32 s41, s41, 6324224
    s_waitcnt vmcnt(8)
    s_barrier
    ds_read_b128 v[128:131], v64 offset:0
    ds_read_b64_tr_b16 v[24:25], v68 offset:0
    ds_read_b64_tr_b16 v[26:27], v68 offset:512
    ds_read_b64_tr_b16 v[28:29], v72 offset:0
    ds_read_b64_tr_b16 v[30:31], v72 offset:512
    ds_read_b64_tr_b16 v[32:33], v76 offset:0
    ds_read_b64_tr_b16 v[34:35], v76 offset:512
    s_waitcnt lgkmcnt(4)
    v_mfma_f32_32x32x16_bf16 v[80:95], v[24:27], v[128:131], 0
    ds_read_b128 v[132:135], v65 offset:0
    ds_read_b64_tr_b16 v[36:37], v69 offset:0
    ds_read_b64_tr_b16 v[38:39], v69 offset:512
    s_waitcnt lgkmcnt(5)
    v_mfma_f32_32x32x16_bf16 v[96:111], v[28:31], v[128:131], 0
    ds_read_b64_tr_b16 v[40:41], v73 offset:0
    ds_read_b64_tr_b16 v[42:43], v73 offset:512
    s_lshl_b32 s51, s50, 7
    s_add_u32 m0, s52, 16384
    s_add_u32 s51, s51, s48
    buffer_load_dwordx4 v5, s[8:11], s51 offen lds
    s_waitcnt lgkmcnt(5)
    v_mfma_f32_32x32x16_bf16 v[112:127], v[32:35], v[128:131], 0
    ds_read_b64_tr_b16 v[44:45], v77 offset:0
    ds_read_b64_tr_b16 v[46:47], v77 offset:512
    s_add_u32 m0, s52, 17408
    s_mul_i32 s49, s50, 196608
    buffer_load_dwordx4 v6, s[8:11], s51 offen lds
    v_smfmac_f32_16x16x64_bf16 v[12:15], v[16:19], v[24:31], v52
    s_waitcnt lgkmcnt(4)
    v_mfma_f32_32x32x16_bf16 v[80:95], v[36:39], v[132:135], v[80:95]
    ds_read_b128 v[136:139], v66 offset:0
    ds_read_b64_tr_b16 v[24:25], v70 offset:0
    ds_read_b64_tr_b16 v[26:27], v70 offset:512
    s_waitcnt vmcnt(9)
    v_lshlrev_b32 v60, 16, v56
    v_and_b32 v61, 0xffff0000, v56
    v_add_f32 v62, v60, v61
    v_mul_f32 v63, v60, v60
    s_waitcnt lgkmcnt(5)
    v_mfma_f32_32x32x16_bf16 v[96:111], v[40:43], v[132:135], v[96:111]
    ds_read_b64_tr_b16 v[28:29], v74 offset:0
    ds_read_b64_tr_b16 v[30:31], v74 offset:512
    s_add_u32 m0, s56, 81920
    s_add_u32 s49, s49, s57
    buffer_load_dwordx4 v7, s[12:15], s49 offen lds
    s_mul_i32 s51, s50, s53
    v_fmac_f32 v63, v61, v61
    v_lshlrev_b32 v60, 16, v57
    v_and_b32 v61, 0xffff0000, v57
    v_add_f32 v62, v62, v60
    s_waitcnt lgkmcnt(5)
    v_mfma_f32_32x32x16_bf16 v[112:127], v[44:47], v[132:135], v[112:127]
    ds_read_b64_tr_b16 v[32:33], v78 offset:0
    ds_read_b64_tr_b16 v[34:35], v78 offset:512
    s_add_u32 m0, s56, 114688
    s_add_u32 s49, s51, s58
    buffer_load_dwordx4 v8, s[16:19], s49 offen lds
    v_smfmac_f32_16x16x64_bf16 v[12:15], v[48:51], v[44:51], v52
    v_fmac_f32 v63, v60, v60
    v_add_f32 v62, v62, v61
    v_fmac_f32 v63, v61, v61
    v_lshlrev_b32 v60, 16, v58
    s_waitcnt lgkmcnt(4)
    v_mfma_f32_32x32x16_bf16 v[80:95], v[24:27], v[136:139], v[80:95]
    ds_read_b128 v[140:143], v67 offset:0
    ds_read_b64_tr_b16 v[36:37], v71 offset:0
    ds_read_b64_tr_b16 v[38:39], v71 offset:512
    v_and_b32 v61, 0xffff0000, v58
    v_add_f32 v62, v62, v60
    v_fmac_f32 v63, v60, v60
    v_add_f32 v62, v62, v61
    s_waitcnt lgkmcnt(5)
    v_mfma_f32_32x32x16_bf16 v[96:111], v[28:31], v[136:139], v[96:111]
    ds_read_b64_tr_b16 v[40:41], v75 offset:0
    ds_read_b64_tr_b16 v[42:43], v75 offset:512
    s_add_u32 m0, s56, 147456
    s_add_u32 s49, s51, s59
    buffer_load_dwordx4 v9, s[20:23], s49 offen lds
    s_add_u32 s50, s50, 1
    s_and_b32 s50, s50, 7
    v_fmac_f32 v63, v61, v61
    v_lshlrev_b32 v60, 16, v59
    v_and_b32 v61, 0xffff0000, v59
    v_add_f32 v62, v62, v60
    s_waitcnt lgkmcnt(5)
    v_mfma_f32_32x32x16_bf16 v[112:127], v[32:35], v[136:139], v[112:127]
    ds_read_b64_tr_b16 v[44:45], v79 offset:0
    ds_read_b64_tr_b16 v[46:47], v79 offset:512
    v_fmac_f32 v63, v60, v60
    v_add_f32 v62, v62, v61
    v_fmac_f32 v63, v61, v61
    s_nop 0
    v_add_f32_dpp v62, v62, v62 row_shr:1 bound_ctrl:0
    s_waitcnt vmcnt(7)
    s_waitcnt lgkmcnt(4)
    v_mfma_f32_32x32x16_bf16 v[80:95], v[36:39], v[140:143], v[80:95]
    s_barrier
    ds_read_b128 v[144:147], v64 offset:8192
    ds_read_b64_tr_b16 v[24:25], v68 offset:8192
    ds_read_b64_tr_b16 v[26:27], v68 offset:8704
    v_add_f32_dpp v63, v63, v63 row_shr:1 bound_ctrl:0
    v_add_f32_dpp v62, v62, v62 row_shr:2 bound_ctrl:0
    s_nop 0
    v_add_f32_dpp v63, v63, v63 row_shr:2 bound_ctrl:0
    v_add_f32_dpp v62, v62, v62 row_shr:4 bound_ctrl:0
    s_waitcnt lgkmcnt(5)
    v_mfma_f32_32x32x16_bf16 v[96:111], v[40:43], v[140:143], v[96:111]
    ds_read_b64_tr_b16 v[28:29], v72 offset:8192
    ds_read_b64_tr_b16 v[30:31], v72 offset:8704
    s_lshl_b32 s51, s50, 7
    s_add_u32 m0, s52, 24576
    s_add_u32 s51, s51, s48
    buffer_load_dwordx4 v5, s[8:11], s51 offen lds
    v_add_f32_dpp v63, v63, v63 row_shr:4 bound_ctrl:0
    v_add_f32_dpp v62, v62, v62 row_shr:8 bound_ctrl:0
    s_nop 0
    v_add_f32_dpp v63, v63, v63 row_shr:8 bound_ctrl:0
    v_add_f32_dpp v62, v62, v62 row_bcast:15 row_mask:0xa
    s_waitcnt lgkmcnt(5)
    v_mfma_f32_32x32x16_bf16 v[112:127], v[44:47], v[140:143], v[112:127]
    ds_read_b64_tr_b16 v[32:33], v76 offset:8192
    ds_read_b64_tr_b16 v[34:35], v76 offset:8704
    s_add_u32 m0, s52, 25600
    s_mul_i32 s49, s50, 196608
    buffer_load_dwordx4 v6, s[8:11], s51 offen lds
    v_add_f32_dpp v63, v63, v63 row_bcast:15 row_mask:0xa
    v_add_f32_dpp v62, v62, v62 row_bcast:31 row_mask:0xc
    s_nop 0
    v_add_f32_dpp v63, v63, v63 row_bcast:31 row_mask:0xc
    v_mul_f32 v62, 0x3b000000, v62
    s_waitcnt lgkmcnt(4)
    v_mfma_f32_32x32x16_bf16 v[80:95], v[24:27], v[144:147], v[80:95]
    ds_read_b128 v[148:151], v65 offset:8192
    ds_read_b64_tr_b16 v[36:37], v69 offset:8192
    ds_read_b64_tr_b16 v[38:39], v69 offset:8704
    v_mul_f32 v63, 0x3b000000, v63
    v_cvt_pk_bf16_f32 v56, -v62, -v62
    v_fma_f32 v63, -v62, v62, v63
    v_max_f32 v63, 0, v63
    s_waitcnt lgkmcnt(5)
    v_mfma_f32_32x32x16_bf16 v[96:111], v[28:31], v[144:147], v[96:111]
    ds_read_b64_tr_b16 v[40:41], v73 offset:8192
    ds_read_b64_tr_b16 v[42:43], v73 offset:8704
    s_add_u32 m0, s56, 90112
    s_add_u32 s49, s49, s57
    buffer_load_dwordx4 v7, s[12:15], s49 offen lds
    s_mul_i32 s51, s50, s53
    v_cvt_pk_bf16_f32 v60, v63, v63
    v_and_b32 v60, 0xffff0000, v60
    v_add_f32 v60, 0x3727c5ac, v60
    v_cvt_pk_bf16_f32 v60, v60, v60
    s_waitcnt lgkmcnt(5)
    v_mfma_f32_32x32x16_bf16 v[112:127], v[32:35], v[144:147], v[112:127]
    ds_read_b64_tr_b16 v[44:45], v77 offset:8192
    ds_read_b64_tr_b16 v[46:47], v77 offset:8704
    v_smfmac_f32_16x16x64_bf16 v[12:15], v[16:19], v[24:31], v52
    v_and_b32 v60, 0xffff0000, v60
    v_sqrt_f32 v60, v60
    s_nop 0
    v_cvt_pk_bf16_f32 v60, v60, v60
    v_and_b32 v60, 0xffff0000, v60
    s_waitcnt lgkmcnt(4)
    v_mfma_f32_32x32x16_bf16 v[80:95], v[36:39], v[148:151], v[80:95]
    ds_read_b128 v[152:155], v66 offset:8192
    ds_read_b64_tr_b16 v[24:25], v70 offset:8192
    ds_read_b64_tr_b16 v[26:27], v70 offset:8704
    v_rcp_f32 v57, v60
    v_mul_f32 v58, v60, v60
    s_waitcnt lgkmcnt(5)
    v_mfma_f32_32x32x16_bf16 v[96:111], v[40:43], v[148:151], v[96:111]
    ds_read_b64_tr_b16 v[28:29], v74 offset:8192
    ds_read_b64_tr_b16 v[30:31], v74 offset:8704
    s_add_u32 m0, s56, 122880
    s_add_u32 s49, s51, s58
    buffer_load_dwordx4 v8, s[16:19], s49 offen lds
    s_waitcnt lgkmcnt(5)
    v_mfma_f32_32x32x16_bf16 v[112:127], v[44:47], v[148:151], v[112:127]
    ds_read_b64_tr_b16 v[32:33], v78 offset:8192
    ds_read_b64_tr_b16 v[34:35], v78 offset:8704
    v_smfmac_f32_16x16x64_bf16 v[12:15], v[48:51], v[44:51], v52
    s_waitcnt lgkmcnt(4)
    v_mfma_f32_32x32x16_bf16 v[80:95], v[24:27], v[152:155], v[80:95]
    ds_read_b128 v[156:159], v67 offset:8192
    ds_read_b64_tr_b16 v[36:37], v71 offset:8192
    ds_read_b64_tr_b16 v[38:39], v71 offset:8704
    s_waitcnt lgkmcnt(5)
    v_mfma_f32_32x32x16_bf16 v[96:111], v[28:31], v[152:155], v[96:111]
    ds_read_b64_tr_b16 v[40:41], v75 offset:8192
    ds_read_b64_tr_b16 v[42:43], v75 offset:8704
    s_add_u32 m0, s56, 155648
    s_add_u32 s49, s51, s59
    buffer_load_dwordx4 v9, s[20:23], s49 offen lds
    s_add_u32 s50, s50, 1
    s_and_b32 s50, s50, 7
    s_waitcnt lgkmcnt(5)
    v_mfma_f32_32x32x16_bf16 v[112:127], v[32:35], v[152:155], v[112:127]
    ds_read_b64_tr_b16 v[44:45], v79 offset:8192
    ds_read_b64_tr_b16 v[46:47], v79 offset:8704
    buffer_load_dword v23, v22, s[36:39], 0 offen sc1
    s_waitcnt vmcnt(6)
    s_waitcnt lgkmcnt(4)
    v_mfma_f32_32x32x16_bf16 v[80:95], v[36:39], v[156:159], v[80:95]
    s_barrier
    ds_read_b128 v[160:163], v64 offset:16384
    ds_read_b64_tr_b16 v[24:25], v68 offset:16384
    ds_read_b64_tr_b16 v[26:27], v68 offset:16896
    s_waitcnt lgkmcnt(5)
    v_mfma_f32_32x32x16_bf16 v[96:111], v[40:43], v[156:159], v[96:111]
    ds_read_b64_tr_b16 v[28:29], v72 offset:16384
    ds_read_b64_tr_b16 v[30:31], v72 offset:16896
    s_lshl_b32 s51, s50, 7
    s_add_u32 m0, s52, 0
    s_add_u32 s51, s51, s48
    buffer_load_dwordx4 v5, s[8:11], s51 offen lds
    s_waitcnt lgkmcnt(5)
    v_mfma_f32_32x32x16_bf16 v[112:127], v[44:47], v[156:159], v[112:127]
    ds_read_b64_tr_b16 v[32:33], v76 offset:16384
    ds_read_b64_tr_b16 v[34:35], v76 offset:16896
    s_add_u32 m0, s52, 1024
    s_mul_i32 s49, s50, 196608
    buffer_load_dwordx4 v6, s[8:11], s51 offen lds
    s_waitcnt lgkmcnt(4)
    v_mfma_f32_32x32x16_bf16 v[80:95], v[24:27], v[160:163], v[80:95]
    ds_read_b128 v[164:167], v65 offset:16384
    ds_read_b64_tr_b16 v[36:37], v69 offset:16384
    ds_read_b64_tr_b16 v[38:39], v69 offset:16896
    s_waitcnt lgkmcnt(5)
    v_mfma_f32_32x32x16_bf16 v[96:111], v[28:31], v[160:163], v[96:111]
    ds_read_b64_tr_b16 v[40:41], v73 offset:16384
    ds_read_b64_tr_b16 v[42:43], v73 offset:16896
    s_add_u32 m0, s56, 65536
    s_add_u32 s49, s49, s57
    buffer_load_dwordx4 v7, s[12:15], s49 offen lds
    s_mul_i32 s51, s50, s53
    s_waitcnt lgkmcnt(5)
    v_mfma_f32_32x32x16_bf16 v[112:127], v[32:35], v[160:163], v[112:127]
    ds_read_b64_tr_b16 v[44:45], v77 offset:16384
    ds_read_b64_tr_b16 v[46:47], v77 offset:16896
    v_smfmac_f32_16x16x64_bf16 v[12:15], v[16:19], v[24:31], v52
    s_waitcnt lgkmcnt(4)
    v_mfma_f32_32x32x16_bf16 v[80:95], v[36:39], v[164:167], v[80:95]
    ds_read_b128 v[168:171], v66 offset:16384
    ds_read_b64_tr_b16 v[24:25], v70 offset:16384
    ds_read_b64_tr_b16 v[26:27], v70 offset:16896
    s_waitcnt lgkmcnt(5)
    v_mfma_f32_32x32x16_bf16 v[96:111], v[40:43], v[164:167], v[96:111]
    ds_read_b64_tr_b16 v[28:29], v74 offset:16384
    ds_read_b64_tr_b16 v[30:31], v74 offset:16896
    s_add_u32 m0, s56, 98304
    s_add_u32 s49, s51, s58
    buffer_load_dwordx4 v8, s[16:19], s49 offen lds
    s_waitcnt lgkmcnt(5)
    v_mfma_f32_32x32x16_bf16 v[112:127], v[44:47], v[164:167], v[112:127]
    ds_read_b64_tr_b16 v[32:33], v78 offset:16384
    ds_read_b64_tr_b16 v[34:35], v78 offset:16896
    v_smfmac_f32_16x16x64_bf16 v[12:15], v[48:51], v[44:51], v52
    s_waitcnt lgkmcnt(4)
    v_mfma_f32_32x32x16_bf16 v[80:95], v[24:27], v[168:171], v[80:95]
    ds_read_b128 v[172:175], v67 offset:16384
    ds_read_b64_tr_b16 v[36:37], v71 offset:16384
    ds_read_b64_tr_b16 v[38:39], v71 offset:16896
    s_waitcnt lgkmcnt(5)
    v_mfma_f32_32x32x16_bf16 v[96:111], v[28:31], v[168:171], v[96:111]
    ds_read_b64_tr_b16 v[40:41], v75 offset:16384
    ds_read_b64_tr_b16 v[42:43], v75 offset:16896
    s_add_u32 m0, s56, 131072
    s_add_u32 s49, s51, s59
    buffer_load_dwordx4 v9, s[20:23], s49 offen lds
    s_add_u32 s50, s50, 1
    s_and_b32 s50, s50, 7
    s_waitcnt lgkmcnt(5)
    v_mfma_f32_32x32x16_bf16 v[112:127], v[32:35], v[168:171], v[112:127]
    ds_read_b64_tr_b16 v[44:45], v79 offset:16384
    ds_read_b64_tr_b16 v[46:47], v79 offset:16896
    s_waitcnt vmcnt(5)
    v_cmp_eq_u32 vcc, 0, v23
    s_nop 1
    s_cbranch_vccz L_BACK_tag_QK11
    s_mov_b32 s3, 20000
L_SPIN_tag_QK11:
    s_sleep 1
    buffer_load_dword v23, v22, s[36:39], 0 offen sc1
    s_waitcnt vmcnt(0)
    v_cmp_eq_u32 vcc, 0, v23
    s_nop 0
    s_sub_u32 s3, s3, 1
    s_cbranch_vccz L_BACK_tag_QK11
    s_cmp_lg_u32 s3, 0
    s_cbranch_scc1 L_SPIN_tag_QK11
L_BACK_tag_QK11:
    v_readfirstlane_b32 s64, v23
    v_mov_b32 v59, v23
    v_readlane_b32 s3, v56, 63
    v_readlane_b32 s4, v57, 63
    v_readlane_b32 s5, v58, 63
    v_lshlrev_b32 v61, 4, v0
    v_mov_b32 v56, s3
    v_mov_b32 v57, s4
    v_mov_b32 v58, s5
    s_lshl_b32 s3, s2, 10
    s_lshl_b32 s4, s42, 7
    s_add_u32 s3, s3, s4
    s_add_u32 s3, s3, 23134208
    s_mov_b64 exec, 0xff
    buffer_store_dwordx4 v[56:59], v61, s[32:35], s3 offen sc1
    s_mov_b64 exec, -1
    s_waitcnt vmcnt(6)
    s_waitcnt lgkmcnt(4)
    v_mfma_f32_32x32x16_bf16 v[80:95], v[36:39], v[172:175], v[80:95]
    s_barrier
    ds_read_b128 v[176:179], v64 offset:24576
    ds_read_b64_tr_b16 v[24:25], v68 offset:24576
    ds_read_b64_tr_b16 v[26:27], v68 offset:25088
    s_waitcnt lgkmcnt(5)
    v_mfma_f32_32x32x16_bf16 v[96:111], v[40:43], v[172:175], v[96:111]
    ds_read_b64_tr_b16 v[28:29], v72 offset:24576
    ds_read_b64_tr_b16 v[30:31], v72 offset:25088
    s_lshl_b32 s51, s50, 7
    s_add_u32 m0, s52, 8192
    s_add_u32 s51, s51, s48
    buffer_load_dwordx4 v5, s[8:11], s51 offen lds
    s_waitcnt lgkmcnt(5)
    v_mfma_f32_32x32x16_bf16 v[112:127], v[44:47], v[172:175], v[112:127]
    ds_read_b64_tr_b16 v[32:33], v76 offset:24576
    ds_read_b64_tr_b16 v[34:35], v76 offset:25088
    s_add_u32 m0, s52, 9216
    s_mul_i32 s49, s50, 196608
    buffer_load_dwordx4 v6, s[8:11], s51 offen lds
    s_waitcnt lgkmcnt(4)
    v_mfma_f32_32x32x16_bf16 v[80:95], v[24:27], v[176:179], v[80:95]
    ds_read_b128 v[180:183], v65 offset:24576
    ds_read_b64_tr_b16 v[36:37], v69 offset:24576
    ds_read_b64_tr_b16 v[38:39], v69 offset:25088
    s_waitcnt lgkmcnt(5)
    v_mfma_f32_32x32x16_bf16 v[96:111], v[28:31], v[176:179], v[96:111]
    ds_read_b64_tr_b16 v[40:41], v73 offset:24576
    ds_read_b64_tr_b16 v[42:43], v73 offset:25088
    s_add_u32 m0, s56, 73728
    s_add_u32 s49, s49, s57
    buffer_load_dwordx4 v7, s[12:15], s49 offen lds
    s_mul_i32 s51, s50, s53
    s_waitcnt lgkmcnt(5)
    v_mfma_f32_32x32x16_bf16 v[112:127], v[32:35], v[176:179], v[112:127]
    ds_read_b64_tr_b16 v[44:45], v77 offset:24576
    ds_read_b64_tr_b16 v[46:47], v77 offset:25088
    v_smfmac_f32_16x16x64_bf16 v[12:15], v[16:19], v[24:31], v52
    s_waitcnt lgkmcnt(4)
    v_mfma_f32_32x32x16_bf16 v[80:95], v[36:39], v[180:183], v[80:95]
    ds_read_b128 v[184:187], v66 offset:24576
    ds_read_b64_tr_b16 v[24:25], v70 offset:24576
    ds_read_b64_tr_b16 v[26:27], v70 offset:25088
    s_waitcnt lgkmcnt(5)
    v_mfma_f32_32x32x16_bf16 v[96:111], v[40:43], v[180:183], v[96:111]
    ds_read_b64_tr_b16 v[28:29], v74 offset:24576
    ds_read_b64_tr_b16 v[30:31], v74 offset:25088
    s_add_u32 m0, s56, 106496
    s_add_u32 s49, s51, s58
    buffer_load_dwordx4 v8, s[16:19], s49 offen lds
    s_waitcnt lgkmcnt(5)
    v_mfma_f32_32x32x16_bf16 v[112:127], v[44:47], v[180:183], v[112:127]
    ds_read_b64_tr_b16 v[32:33], v78 offset:24576
    ds_read_b64_tr_b16 v[34:35], v78 offset:25088
    v_smfmac_f32_16x16x64_bf16 v[12:15], v[48:51], v[44:51], v52
    s_waitcnt lgkmcnt(4)
    v_mfma_f32_32x32x16_bf16 v[80:95], v[24:27], v[184:187], v[80:95]
    ds_read_b128 v[188:191], v67 offset:24576
    ds_read_b64_tr_b16 v[36:37], v71 offset:24576
    ds_read_b64_tr_b16 v[38:39], v71 offset:25088
    s_waitcnt lgkmcnt(5)
    v_mfma_f32_32x32x16_bf16 v[96:111], v[28:31], v[184:187], v[96:111]
    ds_read_b64_tr_b16 v[40:41], v75 offset:24576
    ds_read_b64_tr_b16 v[42:43], v75 offset:25088
    s_add_u32 m0, s56, 139264
    s_add_u32 s49, s51, s59
    buffer_load_dwordx4 v9, s[20:23], s49 offen lds
    s_add_u32 s50, s50, 1
    s_and_b32 s50, s50, 7
    s_waitcnt lgkmcnt(5)
    v_mfma_f32_32x32x16_bf16 v[112:127], v[32:35], v[184:187], v[112:127]
    ds_read_b64_tr_b16 v[44:45], v79 offset:24576
    ds_read_b64_tr_b16 v[46:47], v79 offset:25088
    s_and_b32 s3, s45, 7
    s_lshl_b32 s3, s3, 3
    s_add_u32 s3, s3, s42
    s_lshl_b32 s3, s3, 3
    v_add_u32 v20, s3, v0
    v_mul_u32_u24 v20, 3584, v20
    s_mov_b64 exec, 0xff
    buffer_load_dword v252, v20, s[24:27], s60 offen
    buffer_load_dword v253, v20, s[28:31], s60 offen
    s_mov_b64 exec, -1
    s_waitcnt vmcnt(8)
    s_waitcnt lgkmcnt(4)
    v_mfma_f32_32x32x16_bf16 v[80:95], v[36:39], v[188:191], v[80:95]
    s_barrier
    ds_read_b128 v[192:195], v64 offset:0
    ds_read_b64_tr_b16 v[24:25], v68 offset:0
    ds_read_b64_tr_b16 v[26:27], v68 offset:512
    s_waitcnt lgkmcnt(5)
    v_mfma_f32_32x32x16_bf16 v[96:111], v[40:43], v[188:191], v[96:111]
    ds_read_b64_tr_b16 v[28:29], v72 offset:0
    ds_read_b64_tr_b16 v[30:31], v72 offset:512
    s_lshl_b32 s51, s50, 7
    s_add_u32 m0, s52, 16384
    s_add_u32 s51, s51, s48
    buffer_load_dwordx4 v5, s[8:11], s51 offen lds
    s_waitcnt lgkmcnt(5)
    v_mfma_f32_32x32x16_bf16 v[112:127], v[44:47], v[188:191], v[112:127]
    ds_read_b64_tr_b16 v[32:33], v76 offset:0
    ds_read_b64_tr_b16 v[34:35], v76 offset:512
    s_add_u32 m0, s52, 17408
    s_mul_i32 s49, s50, 196608
    buffer_load_dwordx4 v6, s[8:11], s51 offen lds
    s_waitcnt lgkmcnt(4)
    v_mfma_f32_32x32x16_bf16 v[80:95], v[24:27], v[192:195], v[80:95]
    ds_read_b128 v[196:199], v65 offset:0
    ds_read_b64_tr_b16 v[36:37], v69 offset:0
    ds_read_b64_tr_b16 v[38:39], v69 offset:512
    s_waitcnt lgkmcnt(5)
    v_mfma_f32_32x32x16_bf16 v[96:111], v[28:31], v[192:195], v[96:111]
    ds_read_b64_tr_b16 v[40:41], v73 offset:0
    ds_read_b64_tr_b16 v[42:43], v73 offset:512
    s_add_u32 m0, s56, 81920
    s_add_u32 s49, s49, s57
    buffer_load_dwordx4 v7, s[12:15], s49 offen lds
    s_mul_i32 s51, s50, s53
    s_waitcnt lgkmcnt(5)
    v_mfma_f32_32x32x16_bf16 v[112:127], v[32:35], v[192:195], v[112:127]
    ds_read_b64_tr_b16 v[44:45], v77 offset:0
    ds_read_b64_tr_b16 v[46:47], v77 offset:512
    v_smfmac_f32_16x16x64_bf16 v[12:15], v[16:19], v[24:31], v52
    s_waitcnt lgkmcnt(4)
    v_mfma_f32_32x32x16_bf16 v[80:95], v[36:39], v[196:199], v[80:95]
    ds_read_b128 v[200:203], v66 offset:0
    ds_read_b64_tr_b16 v[24:25], v70 offset:0
    ds_read_b64_tr_b16 v[26:27], v70 offset:512
    s_waitcnt lgkmcnt(5)
    v_mfma_f32_32x32x16_bf16 v[96:111], v[40:43], v[196:199], v[96:111]
    ds_read_b64_tr_b16 v[28:29], v74 offset:0
    ds_read_b64_tr_b16 v[30:31], v74 offset:512
    s_add_u32 m0, s56, 114688
    s_add_u32 s49, s51, s58
    buffer_load_dwordx4 v8, s[16:19], s49 offen lds
    s_waitcnt lgkmcnt(5)
    v_mfma_f32_32x32x16_bf16 v[112:127], v[44:47], v[196:199], v[112:127]
    ds_read_b64_tr_b16 v[32:33], v78 offset:0
    ds_read_b64_tr_b16 v[34:35], v78 offset:512
    v_smfmac_f32_16x16x64_bf16 v[12:15], v[48:51], v[44:51], v52
    s_waitcnt lgkmcnt(4)
    v_mfma_f32_32x32x16_bf16 v[80:95], v[24:27], v[200:203], v[80:95]
    ds_read_b128 v[204:207], v67 offset:0
    ds_read_b64_tr_b16 v[36:37], v71 offset:0
    ds_read_b64_tr_b16 v[38:39], v71 offset:512
    s_waitcnt lgkmcnt(5)
    v_mfma_f32_32x32x16_bf16 v[96:111], v[28:31], v[200:203], v[96:111]
    ds_read_b64_tr_b16 v[40:41], v75 offset:0
    ds_read_b64_tr_b16 v[42:43], v75 offset:512
    s_add_u32 m0, s56, 147456
    s_add_u32 s49, s51, s59
    buffer_load_dwordx4 v9, s[20:23], s49 offen lds
    s_add_u32 s50, s50, 1
    s_and_b32 s50, s50, 7
    s_waitcnt lgkmcnt(5)
    v_mfma_f32_32x32x16_bf16 v[112:127], v[32:35], v[200:203], v[112:127]
    ds_read_b64_tr_b16 v[44:45], v79 offset:0
    ds_read_b64_tr_b16 v[46:47], v79 offset:512
    s_waitcnt vmcnt(7)
    s_waitcnt lgkmcnt(4)
    v_mfma_f32_32x32x16_bf16 v[80:95], v[36:39], v[204:207], v[80:95]
    s_barrier
    ds_read_b128 v[208:211], v64 offset:8192
    ds_read_b64_tr_b16 v[24:25], v68 offset:8192
    ds_read_b64_tr_b16 v[26:27], v68 offset:8704
    s_waitcnt lgkmcnt(5)
    v_mfma_f32_32x32x16_bf16 v[96:111], v[40:43], v[204:207], v[96:111]
    ds_read_b64_tr_b16 v[28:29], v72 offset:8192
    ds_read_b64_tr_b16 v[30:31], v72 offset:8704
    s_lshl_b32 s51, s50, 7
    s_add_u32 m0, s52, 24576
    s_add_u32 s51, s51, s48
    buffer_load_dwordx4 v5, s[8:11], s51 offen lds
    s_waitcnt lgkmcnt(5)
    v_mfma_f32_32x32x16_bf16 v[112:127], v[44:47], v[204:207], v[112:127]
    ds_read_b64_tr_b16 v[32:33], v76 offset:8192
    ds_read_b64_tr_b16 v[34:35], v76 offset:8704
    s_add_u32 m0, s52, 25600
    s_mul_i32 s49, s50, 196608
    buffer_load_dwordx4 v6, s[8:11], s51 offen lds
    s_waitcnt lgkmcnt(4)
    v_mfma_f32_32x32x16_bf16 v[80:95], v[24:27], v[208:211], v[80:95]
    ds_read_b128 v[212:215], v65 offset:8192
    ds_read_b64_tr_b16 v[36:37], v69 offset:8192
    ds_read_b64_tr_b16 v[38:39], v69 offset:8704
    s_waitcnt lgkmcnt(5)
    v_mfma_f32_32x32x16_bf16 v[96:111], v[28:31], v[208:211], v[96:111]
    ds_read_b64_tr_b16 v[40:41], v73 offset:8192
    ds_read_b64_tr_b16 v[42:43], v73 offset:8704
    s_add_u32 m0, s56, 90112
    s_add_u32 s49, s49, s57
    buffer_load_dwordx4 v7, s[12:15], s49 offen lds
    s_mul_i32 s51, s50, s53
    s_waitcnt lgkmcnt(5)
    v_mfma_f32_32x32x16_bf16 v[112:127], v[32:35], v[208:211], v[112:127]
    ds_read_b64_tr_b16 v[44:45], v77 offset:8192
    ds_read_b64_tr_b16 v[46:47], v77 offset:8704
    v_smfmac_f32_16x16x64_bf16 v[12:15], v[16:19], v[24:31], v52
    s_waitcnt lgkmcnt(4)
    v_mfma_f32_32x32x16_bf16 v[80:95], v[36:39], v[212:215], v[80:95]
    ds_read_b128 v[216:219], v66 offset:8192
    ds_read_b64_tr_b16 v[24:25], v70 offset:8192
    ds_read_b64_tr_b16 v[26:27], v70 offset:8704
    s_waitcnt lgkmcnt(5)
    v_mfma_f32_32x32x16_bf16 v[96:111], v[40:43], v[212:215], v[96:111]
    ds_read_b64_tr_b16 v[28:29], v74 offset:8192
    ds_read_b64_tr_b16 v[30:31], v74 offset:8704
    s_add_u32 m0, s56, 122880
    s_add_u32 s49, s51, s58
    buffer_load_dwordx4 v8, s[16:19], s49 offen lds
    s_waitcnt lgkmcnt(5)
    v_mfma_f32_32x32x16_bf16 v[112:127], v[44:47], v[212:215], v[112:127]
    ds_read_b64_tr_b16 v[32:33], v78 offset:8192
    ds_read_b64_tr_b16 v[34:35], v78 offset:8704
    v_smfmac_f32_16x16x64_bf16 v[12:15], v[48:51], v[44:51], v52
    v_and_b32 v61, 15, v0
    v_lshlrev_b32 v61, 4, v61
    v_lshrrev_b32 v62, 4, v0
    v_lshl_add_u32 v61, v62, 9, v61
    s_mul_i32 s71, s44, 1536
    s_lshl_b32 s0, s43, 2
    s_add_u32 s71, s71, s0
    s_add_u32 s71, s71, 133120
    v_add_u32 v61, s71, v61
    s_waitcnt lgkmcnt(4)
    v_mfma_f32_32x32x16_bf16 v[80:95], v[24:27], v[216:219], v[80:95]
    ds_read_b128 v[220:223], v67 offset:8192
    ds_read_b64_tr_b16 v[36:37], v71 offset:8192
    ds_read_b64_tr_b16 v[38:39], v71 offset:8704
    s_waitcnt lgkmcnt(5)
    v_mfma_f32_32x32x16_bf16 v[96:111], v[28:31], v[216:219], v[96:111]
    ds_read_b64_tr_b16 v[40:41], v75 offset:8192
    ds_read_b64_tr_b16 v[42:43], v75 offset:8704
    s_add_u32 m0, s56, 155648
    s_add_u32 s49, s51, s59
    buffer_load_dwordx4 v9, s[20:23], s49 offen lds
    s_add_u32 s50, s50, 1
    s_and_b32 s50, s50, 7
    s_waitcnt lgkmcnt(5)
    v_mfma_f32_32x32x16_bf16 v[112:127], v[32:35], v[216:219], v[112:127]
    ds_read_b64_tr_b16 v[44:45], v79 offset:8192
    ds_read_b64_tr_b16 v[46:47], v79 offset:8704
    s_waitcnt vmcnt(5)
    s_waitcnt lgkmcnt(4)
    v_mfma_f32_32x32x16_bf16 v[80:95], v[36:39], v[220:223], v[80:95]
    s_barrier
    ds_read_b128 v[224:227], v64 offset:16384
    ds_read_b64_tr_b16 v[24:25], v68 offset:16384
    ds_read_b64_tr_b16 v[26:27], v68 offset:16896
    s_waitcnt lgkmcnt(5)
    v_mfma_f32_32x32x16_bf16 v[96:111], v[40:43], v[220:223], v[96:111]
    ds_read_b64_tr_b16 v[28:29], v72 offset:16384
    ds_read_b64_tr_b16 v[30:31], v72 offset:16896
    s_mul_i32 s49, s50, 229376
    s_add_u32 m0, s56, 0
    s_add_u32 s49, s49, s60
    buffer_load_dwordx4 v10, s[24:27], s49 offen lds
    s_waitcnt lgkmcnt(5)
    v_mfma_f32_32x32x16_bf16 v[112:127], v[44:47], v[220:223], v[112:127]
    ds_read_b64_tr_b16 v[32:33], v76 offset:16384
    ds_read_b64_tr_b16 v[34:35], v76 offset:16896
    v_and_b32 v62, 31, v0
    s_mul_i32 s3, s44, 1536
    s_add_u32 s3, s3, 133120
    v_lshl_add_u32 v9, v62, 4, s3
    s_lshl_b32 s3, s61, 12
    s_add_u32 s3, s3, 23134208
    v_lshl_add_u32 v60, v62, 7, s3
    buffer_load_dwordx4 v[56:59], v60, s[32:35], 0 offen sc1
    s_waitcnt lgkmcnt(4)
    v_mfma_f32_32x32x16_bf16 v[80:95], v[24:27], v[224:227], v[80:95]
    ds_read_b128 v[228:231], v65 offset:16384
    ds_read_b64_tr_b16 v[36:37], v69 offset:16384
    ds_read_b64_tr_b16 v[38:39], v69 offset:16896
    s_waitcnt lgkmcnt(5)
    v_mfma_f32_32x32x16_bf16 v[96:111], v[28:31], v[224:227], v[96:111]
    ds_read_b64_tr_b16 v[40:41], v73 offset:16384
    ds_read_b64_tr_b16 v[42:43], v73 offset:16896
    s_add_u32 m0, s56, 32768
    s_add_u32 s50, s50, 1
    buffer_load_dwordx4 v11, s[28:31], s49 offen lds
    s_and_b32 s50, s50, 7
    s_waitcnt lgkmcnt(5)
    v_mfma_f32_32x32x16_bf16 v[112:127], v[32:35], v[224:227], v[112:127]
    ds_read_b64_tr_b16 v[44:45], v77 offset:16384
    ds_read_b64_tr_b16 v[46:47], v77 offset:16896
    v_smfmac_f32_16x16x64_bf16 v[12:15], v[16:19], v[24:31], v52
    s_waitcnt lgkmcnt(4)
    v_mfma_f32_32x32x16_bf16 v[80:95], v[36:39], v[228:231], v[80:95]
    ds_read_b128 v[232:235], v66 offset:16384
    ds_read_b64_tr_b16 v[24:25], v70 offset:16384
    ds_read_b64_tr_b16 v[26:27], v70 offset:16896
    s_waitcnt lgkmcnt(5)
    v_mfma_f32_32x32x16_bf16 v[96:111], v[40:43], v[228:231], v[96:111]
    ds_read_b64_tr_b16 v[28:29], v74 offset:16384
    ds_read_b64_tr_b16 v[30:31], v74 offset:16896
    s_mul_i32 s49, s50, 229376
    s_add_u32 m0, s56, 65536
    s_add_u32 s49, s49, s60
    buffer_load_dwordx4 v10, s[24:27], s49 offen lds
    s_waitcnt lgkmcnt(5)
    v_mfma_f32_32x32x16_bf16 v[112:127], v[44:47], v[228:231], v[112:127]
    ds_read_b64_tr_b16 v[32:33], v78 offset:16384
    ds_read_b64_tr_b16 v[34:35], v78 offset:16896
    v_smfmac_f32_16x16x64_bf16 v[12:15], v[48:51], v[44:51], v52
    s_waitcnt lgkmcnt(4)
    v_mfma_f32_32x32x16_bf16 v[80:95], v[24:27], v[232:235], v[80:95]
    ds_read_b128 v[236:239], v67 offset:16384
    ds_read_b64_tr_b16 v[36:37], v71 offset:16384
    ds_read_b64_tr_b16 v[38:39], v71 offset:16896
    s_waitcnt lgkmcnt(5)
    v_mfma_f32_32x32x16_bf16 v[96:111], v[28:31], v[232:235], v[96:111]
    ds_read_b64_tr_b16 v[40:41], v75 offset:16384
    ds_read_b64_tr_b16 v[42:43], v75 offset:16896
    s_add_u32 m0, s56, 98304
    s_add_u32 s50, s50, 1
    buffer_load_dwordx4 v11, s[28:31], s49 offen lds
    s_and_b32 s50, s50, 7
    s_waitcnt lgkmcnt(5)
    v_mfma_f32_32x32x16_bf16 v[112:127], v[32:35], v[232:235], v[112:127]
    ds_read_b64_tr_b16 v[44:45], v79 offset:16384
    ds_read_b64_tr_b16 v[46:47], v79 offset:16896
    s_waitcnt vmcnt(5)
    s_waitcnt lgkmcnt(4)
    v_mfma_f32_32x32x16_bf16 v[80:95], v[36:39], v[236:239], v[80:95]
    s_barrier
    ds_read_b128 v[240:243], v64 offset:24576
    ds_read_b64_tr_b16 v[24:25], v68 offset:24576
    ds_read_b64_tr_b16 v[26:27], v68 offset:25088
    s_waitcnt lgkmcnt(5)
    v_mfma_f32_32x32x16_bf16 v[96:111], v[40:43], v[236:239], v[96:111]
    ds_read_b64_tr_b16 v[28:29], v72 offset:24576
    ds_read_b64_tr_b16 v[30:31], v72 offset:25088
    s_mul_i32 s49, s50, 229376
    s_add_u32 m0, s56, 8192
    s_add_u32 s49, s49, s60
    buffer_load_dwordx4 v10, s[24:27], s49 offen lds
    s_waitcnt lgkmcnt(5)
    v_mfma_f32_32x32x16_bf16 v[112:127], v[44:47], v[236:239], v[112:127]
    ds_read_b64_tr_b16 v[32:33], v76 offset:24576
    ds_read_b64_tr_b16 v[34:35], v76 offset:25088
    s_waitcnt vmcnt(4)
    v_cmp_ne_u32 vcc, s64, v59
    s_nop 1
    s_cbranch_vccz L_BACK_rec_QK1
    s_mov_b32 s3, 20000
L_SPIN_rec_QK1:
    s_sleep 1
    buffer_load_dwordx4 v[56:59], v60, s[32:35], 0 offen sc1
    s_waitcnt vmcnt(0)
    v_cmp_ne_u32 vcc, s64, v59
    s_nop 0
    s_sub_u32 s3, s3, 1
    s_cbranch_vccz L_BACK_rec_QK1
    s_cmp_lg_u32 s3, 0
    s_cbranch_scc1 L_SPIN_rec_QK1
L_BACK_rec_QK1:
    s_waitcnt lgkmcnt(4)
    v_mfma_f32_32x32x16_bf16 v[80:95], v[24:27], v[240:243], v[80:95]
    ds_read_b128 v[244:247], v65 offset:24576
    ds_read_b64_tr_b16 v[36:37], v69 offset:24576
    ds_read_b64_tr_b16 v[38:39], v69 offset:25088
    v_cmp_gt_u32 vcc, 32, v0
    v_mov_b32 v5, v57
    v_mov_b32 v8, v58
    v_cndmask_b32 v20, 0, v56, vcc
    v_cndmask_b32 v21, 0, v56, vcc
    v_cndmask_b32 v22, 0, v56, vcc
    v_cndmask_b32 v23, 0, v56, vcc
    s_waitcnt lgkmcnt(5)
    v_mfma_f32_32x32x16_bf16 v[96:111], v[28:31], v[240:243], v[96:111]
    ds_read_b64_tr_b16 v[40:41], v73 offset:24576
    ds_read_b64_tr_b16 v[42:43], v73 offset:25088
    s_add_u32 m0, s56, 40960
    s_add_u32 s50, s50, 1
    buffer_load_dwordx4 v11, s[28:31], s49 offen lds
    s_and_b32 s50, s50, 7
    v_mul_f32 v6, 0xc0135761, v5
    v_mul_f32 v7, v5, v5
    v_mul_f32 v7, v7, v6
    v_mul_f32 v7, 0x3d372713, v7
    s_waitcnt lgkmcnt(5)
    v_mfma_f32_32x32x16_bf16 v[112:127], v[32:35], v[240:243], v[112:127]
    ds_read_b64_tr_b16 v[44:45], v77 offset:24576
    ds_read_b64_tr_b16 v[46:47], v77 offset:25088
    v_smfmac_f32_16x16x64_bf16 v[12:15], v[16:19], v[24:31], v52
    s_waitcnt lgkmcnt(4)
    v_mfma_f32_32x32x16_bf16 v[80:95], v[36:39], v[244:247], v[80:95]
    ds_read_b128 v[248:251], v66 offset:24576
    ds_read_b64_tr_b16 v[24:25], v70 offset:24576
    ds_read_b64_tr_b16 v[26:27], v70 offset:25088
    s_waitcnt lgkmcnt(5)
    v_mfma_f32_32x32x16_bf16 v[96:111], v[40:43], v[244:247], v[96:111]
    ds_read_b64_tr_b16 v[28:29], v74 offset:24576
    ds_read_b64_tr_b16 v[30:31], v74 offset:25088
    s_mul_i32 s49, s50, 229376
    s_add_u32 m0, s56, 73728
    s_add_u32 s49, s49, s60
    buffer_load_dwordx4 v10, s[24:27], s49 offen lds
    s_waitcnt lgkmcnt(5)
    v_mfma_f32_32x32x16_bf16 v[112:127], v[44:47], v[244:247], v[112:127]
    ds_read_b64_tr_b16 v[32:33], v78 offset:24576
    ds_read_b64_tr_b16 v[34:35], v78 offset:25088
    v_smfmac_f32_16x16x64_bf16 v[12:15], v[48:51], v[44:51], v52
    s_waitcnt lgkmcnt(4)
    v_mfma_f32_32x32x16_bf16 v[80:95], v[24:27], v[248:251], v[80:95]
    ds_read_b128 v[252:255], v67 offset:24576
    ds_read_b64_tr_b16 v[36:37], v71 offset:24576
    ds_read_b64_tr_b16 v[38:39], v71 offset:25088
    s_nop 2
    v_add_f32 v12, v12, v13
    v_and_b32 v62, 0xffff0000, v12
    v_sub_f32 v63, v12, v62
    v_cvt_pk_bf16_f32 v12, v62, v63
    v_add_f32 v14, v14, v15
    v_and_b32 v62, 0xffff0000, v14
    v_sub_f32 v63, v14, v62
    v_cvt_pk_bf16_f32 v14, v62, v63
    s_waitcnt lgkmcnt(5)
    v_mfma_f32_32x32x16_bf16 v[96:111], v[28:31], v[248:251], v[96:111]
    ds_read_b64_tr_b16 v[40:41], v75 offset:24576
    ds_read_b64_tr_b16 v[42:43], v75 offset:25088
    s_add_u32 m0, s56, 106496
    s_add_u32 s50, s50, 1
    buffer_load_dwordx4 v11, s[28:31], s49 offen lds
    s_and_b32 s50, s50, 7
    s_mov_b32 exec_hi, 65535
    ds_write_b32 v61, v12 offset:0
    ds_write_b32 v61, v14 offset:256
    s_mov_b64 exec, -1
    s_waitcnt lgkmcnt(7)
    v_mfma_f32_32x32x16_bf16 v[112:127], v[32:35], v[248:251], v[112:127]
    ds_read_b64_tr_b16 v[44:45], v79 offset:24576
    ds_read_b64_tr_b16 v[46:47], v79 offset:25088
    v_add_u32 v28, 65536, v1
    v_add_u32 v29, 65536, v2
    v_add_u32 v30, 65536, v3
    v_add_u32 v31, 65536, v4
    s_waitcnt vmcnt(4)
    s_waitcnt lgkmcnt(2)
    v_mfma_f32_32x32x16_bf16 v[80:95], v[36:39], v[252:255], v[80:95]
    s_barrier
    ds_read_b128 v[68:71], v9 offset:0
    ds_read_b128 v[72:75], v9 offset:512
    ds_read_b128 v[76:79], v9 offset:1024
    v_mfma_f32_32x32x16_bf16 v[96:111], v[40:43], v[252:255], v[96:111]
    ds_read_b64_tr_b16 v[32:33], v1 offset:0
    ds_read_b64_tr_b16 v[34:35], v1 offset:512
    s_mul_i32 s49, s50, 229376
    s_add_u32 m0, s56, 16384
    s_add_u32 s49, s49, s60
    buffer_load_dwordx4 v10, s[24:27], s49 offen lds
    s_waitcnt lgkmcnt(5)
    v_mfma_f32_32x32x16_bf16 v[112:127], v[44:47], v[252:255], v[112:127]
    v_xor_b32 v24, 32, v1
    ds_read_b64_tr_b16 v[36:37], v24 offset:0
    ds_read_b64_tr_b16 v[38:39], v24 offset:512
    s_add_u32 m0, s56, 49152
    s_add_u32 s50, s50, 1
    buffer_load_dwordx4 v11, s[28:31], s49 offen lds
    s_and_b32 s50, s50, 7
    s_waitcnt lgkmcnt(4)
    v_mfma_f32_32x32x16_bf16 v[80:95], v[68:71], v[20:23], v[80:95]
    s_mul_i32 s49, s50, 229376
    s_add_u32 m0, s56, 81920
    s_add_u32 s49, s49, s60
    buffer_load_dwordx4 v10, s[24:27], s49 offen lds
    v_mfma_f32_32x32x16_bf16 v[96:111], v[72:75], v[20:23], v[96:111]
    s_add_u32 m0, s56, 114688
    s_add_u32 s50, s50, 1
    buffer_load_dwordx4 v11, s[28:31], s49 offen lds
    s_and_b32 s50, s50, 7
    v_mfma_f32_32x32x16_bf16 v[112:127], v[76:79], v[20:23], v[112:127]
    v_lshlrev_b32 v9, 4, v0
    s_waitcnt lgkmcnt(2)
    v_mfma_f32_32x32x16_bf16 v[48:63], v[32:35], v[128:131], 0
    ds_read_b64_tr_b16 v[40:41], v2 offset:0
    ds_read_b64_tr_b16 v[42:43], v2 offset:512
    s_cmp_ge_u32 s57, 1024
    s_cselect_b32 s71, 1.0, 0x3eb8aa3b
    v_mul_f32 v25, s71, v5
    v_mul_f32 v80, v25, v80
    v_mul_f32 v81, v25, v81
    v_cvt_pk_bf16_f32 v80, v80, v81
    v_mul_f32 v82, v25, v82
    v_mul_f32 v83, v25, v83
    v_cvt_pk_bf16_f32 v81, v82, v83
    s_waitcnt lgkmcnt(2)
    v_mfma_f32_32x32x16_bf16 v[64:79], v[36:39], v[128:131], 0
    v_xor_b32 v24, 32, v2
    ds_read_b64_tr_b16 v[44:45], v24 offset:0
    ds_read_b64_tr_b16 v[46:47], v24 offset:512
    v_and_b32 v26, 1, v0
    v_mul_u32_u24 v26, 0xaaaa, v26
    v_add_u32 v26, 0x4444, v26
    v_lshl_or_b32 v128, v26, 16, v26
    v_mov_b32 v12, 0
    v_mov_b32 v13, 0
    v_mov_b32 v14, 0
    v_mov_b32 v15, 0
    s_waitcnt lgkmcnt(2)
    v_mfma_f32_32x32x16_bf16 v[48:63], v[40:43], v[132:135], v[48:63]
    ds_read_b64_tr_b16 v[32:33], v3 offset:0
    ds_read_b64_tr_b16 v[34:35], v3 offset:512
    v_mul_f32 v84, v25, v84
    v_mul_f32 v85, v25, v85
    v_cvt_pk_bf16_f32 v82, v84, v85
    s_waitcnt lgkmcnt(2)
    v_mfma_f32_32x32x16_bf16 v[64:79], v[44:47], v[132:135], v[64:79]
    v_smfmac_f32_16x16x64_bf16 v[12:15], v[16:19], v[40:47], v128
    v_xor_b32 v24, 32, v3
    ds_read_b64_tr_b16 v[36:37], v24 offset:0
    ds_read_b64_tr_b16 v[38:39], v24 offset:512
    v_mul_f32 v86, v25, v86
    v_mul_f32 v87, v25, v87
    v_cvt_pk_bf16_f32 v83, v86, v87
    buffer_store_dwordx4 v[80:83], v9, s[32:35], s66 offen sc1
    v_mul_f32 v88, v25, v88
    v_mul_f32 v89, v25, v89
    v_cvt_pk_bf16_f32 v84, v88, v89
    s_waitcnt lgkmcnt(2)
    v_mfma_f32_32x32x16_bf16 v[48:63], v[32:35], v[136:139], v[48:63]
    ds_read_b64_tr_b16 v[40:41], v4 offset:0
    ds_read_b64_tr_b16 v[42:43], v4 offset:512
    v_mul_f32 v90, v25, v90
    v_mul_f32 v91, v25, v91
    v_cvt_pk_bf16_f32 v85, v90, v91
    v_mul_f32 v92, v25, v92
    v_mul_f32 v93, v25, v93
    v_cvt_pk_bf16_f32 v86, v92, v93
    s_waitcnt lgkmcnt(2)
    v_mfma_f32_32x32x16_bf16 v[64:79], v[36:39], v[136:139], v[64:79]
    v_xor_b32 v24, 32, v4
    ds_read_b64_tr_b16 v[44:45], v24 offset:0
    ds_read_b64_tr_b16 v[46:47], v24 offset:512
    v_mul_f32 v94, v25, v94
    v_mul_f32 v95, v25, v95
    v_cvt_pk_bf16_f32 v87, v94, v95
    s_waitcnt lgkmcnt(2)
    v_mfma_f32_32x32x16_bf16 v[48:63], v[40:43], v[140:143], v[48:63]
    ds_read_b64_tr_b16 v[32:33], v28 offset:0
    ds_read_b64_tr_b16 v[34:35], v28 offset:512
    buffer_store_dwordx4 v[84:87], v9, s[32:35], s67 offen sc1
    s_mov_b32 s12, s68
    s_and_b32 s13, s69, 0xffff
    s_mov_b32 s14, 524288
    s_mov_b32 s15, 0x20000
    s_mov_b32 s16, s76
    s_and_b32 s17, s77, 0xffff
    s_mov_b32 s18, 1835008
    s_mov_b32 s19, 0x20000
    s_mov_b32 s20, s78
    s_and_b32 s21, s79, 0xffff
    s_mov_b32 s22, 2097152
    s_mov_b32 s23, 0x20000
    s_waitcnt lgkmcnt(2)
    v_mfma_f32_32x32x16_bf16 v[64:79], v[44:47], v[140:143], v[64:79]
    v_xor_b32 v24, 32, v28
    ds_read_b64_tr_b16 v[36:37], v24 offset:0
    ds_read_b64_tr_b16 v[38:39], v24 offset:512
    s_lshl_b32 s48, s62, 17
    s_add_u32 s48, s48, 2097152
    s_add_u32 s48, s48, s56
    s_lshl_b32 s51, s63, 14
    s_waitcnt lgkmcnt(2)
    v_mfma_f32_32x32x16_bf16 v[48:63], v[32:35], v[144:147], v[48:63]
    ds_read_b64_tr_b16 v[40:41], v29 offset:0
    ds_read_b64_tr_b16 v[42:43], v29 offset:512
    s_waitcnt lgkmcnt(2)
    v_mfma_f32_32x32x16_bf16 v[64:79], v[36:39], v[144:147], v[64:79]
    v_xor_b32 v24, 32, v29
    ds_read_b64_tr_b16 v[44:45], v24 offset:0
    ds_read_b64_tr_b16 v[46:47], v24 offset:512
    s_waitcnt lgkmcnt(2)
    v_mfma_f32_32x32x16_bf16 v[48:63], v[40:43], v[148:151], v[48:63]
    ds_read_b64_tr_b16 v[32:33], v30 offset:0
    ds_read_b64_tr_b16 v[34:35], v30 offset:512
    s_waitcnt lgkmcnt(2)
    v_mfma_f32_32x32x16_bf16 v[64:79], v[44:47], v[148:151], v[64:79]
    v_smfmac_f32_16x16x64_bf16 v[12:15], v[16:19], v[40:47], v128
    v_xor_b32 v24, 32, v30
    ds_read_b64_tr_b16 v[36:37], v24 offset:0
    ds_read_b64_tr_b16 v[38:39], v24 offset:512
    s_waitcnt lgkmcnt(2)
    v_mfma_f32_32x32x16_bf16 v[48:63], v[32:35], v[152:155], v[48:63]
    ds_read_b64_tr_b16 v[40:41], v31 offset:0
    ds_read_b64_tr_b16 v[42:43], v31 offset:512
    s_waitcnt lgkmcnt(2)
    v_mfma_f32_32x32x16_bf16 v[64:79], v[36:39], v[152:155], v[64:79]
    v_xor_b32 v24, 32, v31
    ds_read_b64_tr_b16 v[44:45], v24 offset:0
    ds_read_b64_tr_b16 v[46:47], v24 offset:512
    s_waitcnt vmcnt(6)
    s_waitcnt lgkmcnt(2)
    v_mfma_f32_32x32x16_bf16 v[48:63], v[40:43], v[156:159], v[48:63]
    s_barrier
    ds_read_b64_tr_b16 v[32:33], v1 offset:8192
    ds_read_b64_tr_b16 v[34:35], v1 offset:8704
    s_waitcnt lgkmcnt(2)
    v_mfma_f32_32x32x16_bf16 v[64:79], v[44:47], v[156:159], v[64:79]
    v_xor_b32 v24, 32, v1
    ds_read_b64_tr_b16 v[36:37], v24 offset:8192
    ds_read_b64_tr_b16 v[38:39], v24 offset:8704
    s_mul_i32 s49, s50, 229376
    s_add_u32 m0, s56, 24576
    s_add_u32 s49, s49, s60
    buffer_load_dwordx4 v10, s[24:27], s49 offen lds
    s_add_u32 m0, s56, 57344
    s_add_u32 s50, s50, 1
    buffer_load_dwordx4 v11, s[28:31], s49 offen lds
    s_and_b32 s50, s50, 7
    s_mul_i32 s49, s50, 229376
    s_add_u32 m0, s56, 90112
    s_add_u32 s49, s49, s60
    buffer_load_dwordx4 v10, s[24:27], s49 offen lds
    s_add_u32 m0, s56, 122880
    s_add_u32 s50, s50, 1
    buffer_load_dwordx4 v11, s[28:31], s49 offen lds
    s_and_b32 s50, s50, 7
    s_waitcnt lgkmcnt(2)
    v_mfma_f32_32x32x16_bf16 v[48:63], v[32:35], v[160:163], v[48:63]
    ds_read_b64_tr_b16 v[40:41], v2 offset:8192
    ds_read_b64_tr_b16 v[42:43], v2 offset:8704
    s_waitcnt lgkmcnt(2)
    v_mfma_f32_32x32x16_bf16 v[64:79], v[36:39], v[160:163], v[64:79]
    v_xor_b32 v24, 32, v2
    ds_read_b64_tr_b16 v[44:45], v24 offset:8192
    ds_read_b64_tr_b16 v[46:47], v24 offset:8704
    s_lshr_b32 s0, s62, 2
    s_add_u32 s1, s0, 4
    s_mul_i32 s1, s1, 43
    s_lshr_b32 s1, s1, 7
    s_add_u32 s1, s1, 12
    s_sub_u32 s6, s0, 4
    s_mul_i32 s6, s6, 43
    s_lshr_b32 s6, s6, 7
    s_add_u32 s6, s6, 12
    s_add_u32 s7, s0, 8
    s_cmp_lt_u32 s0, 4
    s_cselect_b32 s6, s7, s6
    s_waitcnt lgkmcnt(2)
    v_mfma_f32_32x32x16_bf16 v[48:63], v[40:43], v[164:167], v[48:63]
    ds_read_b64_tr_b16 v[32:33], v3 offset:8192
    ds_read_b64_tr_b16 v[34:35], v3 offset:8704
    s_lshl_b32 s1, s1, 4
    s_lshl_b32 s0, s0, 4
    s_sub_u32 s0, s0, 16
    s_lshl_b32 s6, s6, 4
    s_lshl_b32 s7, s63, 1
    s_add_u32 s6, s6, s7
    s_sub_u32 s6, s6, 32
    v_mov_b32 v154, s1
    v_cmp_le_u32 vcc, 16, v0
    v_mov_b32 v27, s0
    s_nop 0
    v_cndmask_b32 v154, v154, v27, vcc
    v_cmp_le_u32 vcc, 32, v0
    v_mov_b32 v27, s6
    s_nop 0
    v_cndmask_b32 v154, v154, v27, vcc
    s_waitcnt lgkmcnt(2)
    v_mfma_f32_32x32x16_bf16 v[64:79], v[44:47], v[164:167], v[64:79]
    v_smfmac_f32_16x16x64_bf16 v[12:15], v[16:19], v[40:47], v128
    v_xor_b32 v24, 32, v3
    ds_read_b64_tr_b16 v[36:37], v24 offset:8192
    ds_read_b64_tr_b16 v[38:39], v24 offset:8704
    v_min_u32 v27, 33, v0
    v_add_u32 v154, v154, v27
    v_lshlrev_b32 v154, 7, v154
    v_add_u32 v154, 23068672, v154
    v_and_b32 v150, 15, v0
    v_lshlrev_b32 v150, 4, v150
    v_lshrrev_b32 v151, 4, v0
    s_waitcnt lgkmcnt(2)
    v_mfma_f32_32x32x16_bf16 v[48:63], v[32:35], v[168:171], v[48:63]
    ds_read_b64_tr_b16 v[40:41], v4 offset:8192
    ds_read_b64_tr_b16 v[42:43], v4 offset:8704
    v_lshl_add_u32 v150, v151, 9, v150
    s_mul_i32 s71, s44, 1024
    s_lshl_b32 s0, s43, 2
    s_add_u32 s71, s71, s0
    s_add_u32 s71, s71, 136192
    v_add_u32 v150, s71, v150
    v_and_b32 v151, 31, v0
    s_lshl_b32 s71, s44, 10
    s_add_u32 s71, s71, 136192
    v_lshl_add_u32 v151, v151, 4, s71
    s_waitcnt lgkmcnt(2)
    v_mfma_f32_32x32x16_bf16 v[64:79], v[36:39], v[168:171], v[64:79]
    v_xor_b32 v24, 32, v4
    ds_read_b64_tr_b16 v[44:45], v24 offset:8192
    ds_read_b64_tr_b16 v[46:47], v24 offset:8704
    v_mul_f32 v84, v96, v96
    v_mul_f32 v85, v97, v97
    v_mul_f32 v86, v98, v98
    v_mul_f32 v87, v99, v99
    v_fma_f32 v84, v84, v7, v6
    s_waitcnt lgkmcnt(2)
    v_mfma_f32_32x32x16_bf16 v[48:63], v[40:43], v[172:175], v[48:63]
    ds_read_b64_tr_b16 v[32:33], v28 offset:8192
    ds_read_b64_tr_b16 v[34:35], v28 offset:8704
    v_fma_f32 v85, v85, v7, v6
    v_fma_f32 v86, v86, v7, v6
    v_fma_f32 v87, v87, v7, v6
    v_mul_f32 v84, v84, v96
    v_mul_f32 v85, v85, v97
    v_mul_f32 v86, v86, v98
    s_waitcnt lgkmcnt(2)
    v_mfma_f32_32x32x16_bf16 v[64:79], v[44:47], v[172:175], v[64:79]
    v_xor_b32 v24, 32, v28
    ds_read_b64_tr_b16 v[36:37], v24 offset:8192
    ds_read_b64_tr_b16 v[38:39], v24 offset:8704
    v_mul_f32 v87, v87, v99
    v_exp_f32 v84, v84
    v_exp_f32 v85, v85
    s_waitcnt lgkmcnt(2)
    v_mfma_f32_32x32x16_bf16 v[48:63], v[32:35], v[176:179], v[48:63]
    ds_read_b64_tr_b16 v[40:41], v29 offset:8192
    ds_read_b64_tr_b16 v[42:43], v29 offset:8704
    v_exp_f32 v86, v86
    v_exp_f32 v87, v87
    v_mul_f32 v96, v96, v104
    v_mul_f32 v97, v97, v105
    s_waitcnt lgkmcnt(2)
    v_mfma_f32_32x32x16_bf16 v[64:79], v[36:39], v[176:179], v[64:79]
    v_xor_b32 v24, 32, v29
    ds_read_b64_tr_b16 v[44:45], v24 offset:8192
    ds_read_b64_tr_b16 v[46:47], v24 offset:8704
    v_mul_f32 v98, v98, v106
    v_mul_f32 v99, v99, v107
    v_fma_f32 v84, v84, v8, v8
    v_fma_f32 v85, v85, v8, v8
    v_fma_f32 v86, v86, v8, v8
    s_waitcnt lgkmcnt(2)
    v_mfma_f32_32x32x16_bf16 v[48:63], v[40:43], v[180:183], v[48:63]
    ds_read_b64_tr_b16 v[32:33], v30 offset:8192
    ds_read_b64_tr_b16 v[34:35], v30 offset:8704
    v_fma_f32 v87, v87, v8, v8
    v_rcp_f32 v84, v84
    v_rcp_f32 v85, v85
    v_rcp_f32 v86, v86
    s_waitcnt lgkmcnt(2)
    v_mfma_f32_32x32x16_bf16 v[64:79], v[44:47], v[180:183], v[64:79]
    v_smfmac_f32_16x16x64_bf16 v[12:15], v[16:19], v[40:47], v128
    v_xor_b32 v24, 32, v30
    ds_read_b64_tr_b16 v[36:37], v24 offset:8192
    ds_read_b64_tr_b16 v[38:39], v24 offset:8704
    s_waitcnt vmcnt(4)
    s_barrier
    s_lshl_b32 s3, s46, 4
    s_add_u32 s3, s3, s45
    s_lshl_b32 s3, s3, 7
    s_add_u32 s3, s3, 23068672
    s_cmp_eq_u32 s42, 0
    s_cselect_b32 s3, s3, 0x7fffff00
    v_mov_b32 v152, s64
    v_lshlrev_b32 v153, 2, v0
    s_mov_b32 exec_hi, 0
    buffer_store_dword v152, v153, s[32:35], s3 offen sc1
    s_mov_b64 exec, -1
    s_waitcnt lgkmcnt(2)
    v_mfma_f32_32x32x16_bf16 v[48:63], v[32:35], v[184:187], v[48:63]
    ds_read_b64_tr_b16 v[40:41], v31 offset:8192
    ds_read_b64_tr_b16 v[42:43], v31 offset:8704
    v_rcp_f32 v87, v87
    v_mul_f32 v96, v96, v84
    v_mul_f32 v97, v97, v85
    v_mul_f32 v98, v98, v86
    v_mul_f32 v99, v99, v87
    v_mul_f32 v88, v100, v100
    s_waitcnt lgkmcnt(2)
    v_mfma_f32_32x32x16_bf16 v[64:79], v[36:39], v[184:187], v[64:79]
    v_xor_b32 v24, 32, v31
    ds_read_b64_tr_b16 v[44:45], v24 offset:8192
    ds_read_b64_tr_b16 v[46:47], v24 offset:8704
    v_mul_f32 v89, v101, v101
    v_mul_f32 v90, v102, v102
    v_mul_f32 v91, v103, v103
    v_fma_f32 v88, v88, v7, v6
    v_fma_f32 v89, v89, v7, v6
    s_waitcnt vmcnt(5)
    s_waitcnt lgkmcnt(2)
    v_mfma_f32_32x32x16_bf16 v[48:63], v[40:43], v[188:191], v[48:63]
    s_barrier
    ds_read_b64_tr_b16 v[32:33], v1 offset:16384
    ds_read_b64_tr_b16 v[34:35], v1 offset:16896
    v_fma_f32 v90, v90, v7, v6
    v_fma_f32 v91, v91, v7, v6
    v_mul_f32 v88, v88, v100
    v_mul_f32 v89, v89, v101
    v_mul_f32 v90, v90, v102
    v_mul_f32 v91, v91, v103
    s_waitcnt lgkmcnt(2)
    v_mfma_f32_32x32x16_bf16 v[64:79], v[44:47], v[188:191], v[64:79]
    v_xor_b32 v24, 32, v1
    ds_read_b64_tr_b16 v[36:37], v24 offset:16384
    ds_read_b64_tr_b16 v[38:39], v24 offset:16896
    v_exp_f32 v88, v88
    v_exp_f32 v89, v89
    v_exp_f32 v90, v90
    s_waitcnt lgkmcnt(2)
    v_mfma_f32_32x32x16_bf16 v[48:63], v[32:35], v[192:195], v[48:63]
    ds_read_b64_tr_b16 v[40:41], v2 offset:16384
    ds_read_b64_tr_b16 v[42:43], v2 offset:16896
    v_exp_f32 v91, v91
    v_mul_f32 v100, v100, v108
    v_mul_f32 v101, v101, v109
    v_mul_f32 v102, v102, v110
    s_waitcnt lgkmcnt(2)
    v_mfma_f32_32x32x16_bf16 v[64:79], v[36:39], v[192:195], v[64:79]
    v_xor_b32 v24, 32, v2
    ds_read_b64_tr_b16 v[44:45], v24 offset:16384
    ds_read_b64_tr_b16 v[46:47], v24 offset:16896
    v_mul_f32 v103, v103, v111
    v_fma_f32 v88, v88, v8, v8
    v_fma_f32 v89, v89, v8, v8
    v_fma_f32 v90, v90, v8, v8
    v_fma_f32 v91, v91, v8, v8
    s_waitcnt lgkmcnt(2)
    v_mfma_f32_32x32x16_bf16 v[48:63], v[40:43], v[196:199], v[48:63]
    ds_read_b64_tr_b16 v[32:33], v3 offset:16384
    ds_read_b64_tr_b16 v[34:35], v3 offset:16896
    v_rcp_f32 v88, v88
    v_rcp_f32 v89, v89
    v_rcp_f32 v90, v90
    s_waitcnt lgkmcnt(2)
    v_mfma_f32_32x32x16_bf16 v[64:79], v[44:47], v[196:199], v[64:79]
    v_smfmac_f32_16x16x64_bf16 v[12:15], v[16:19], v[40:47], v128
    v_xor_b32 v24, 32, v3
    ds_read_b64_tr_b16 v[36:37], v24 offset:16384
    ds_read_b64_tr_b16 v[38:39], v24 offset:16896
    v_rcp_f32 v91, v91
    v_cvt_pk_bf16_f32 v132, v96, v97
    v_cvt_pk_bf16_f32 v133, v98, v99
    v_mul_f32 v100, v100, v88
    s_waitcnt lgkmcnt(2)
    v_mfma_f32_32x32x16_bf16 v[48:63], v[32:35], v[200:203], v[48:63]
    ds_read_b64_tr_b16 v[40:41], v4 offset:16384
    ds_read_b64_tr_b16 v[42:43], v4 offset:16896
    v_mul_f32 v101, v101, v89
    v_mul_f32 v102, v102, v90
    v_mul_f32 v103, v103, v91
    v_cvt_pk_bf16_f32 v134, v100, v101
    v_cvt_pk_bf16_f32 v135, v102, v103
    v_mul_f32 v84, v112, v112
    s_waitcnt lgkmcnt(2)
    v_mfma_f32_32x32x16_bf16 v[64:79], v[36:39], v[200:203], v[64:79]
    v_xor_b32 v24, 32, v4
    ds_read_b64_tr_b16 v[44:45], v24 offset:16384
    ds_read_b64_tr_b16 v[46:47], v24 offset:16896
    v_mul_f32 v85, v113, v113
    v_mul_f32 v86, v114, v114
    v_mul_f32 v87, v115, v115
    v_fma_f32 v84, v84, v7, v6
    v_fma_f32 v85, v85, v7, v6
    s_waitcnt lgkmcnt(2)
    v_mfma_f32_32x32x16_bf16 v[48:63], v[40:43], v[204:207], v[48:63]
    ds_read_b64_tr_b16 v[32:33], v28 offset:16384
    ds_read_b64_tr_b16 v[34:35], v28 offset:16896
    v_fma_f32 v86, v86, v7, v6
    v_fma_f32 v87, v87, v7, v6
    v_mul_f32 v84, v84, v112
    v_mul_f32 v85, v85, v113
    v_mul_f32 v86, v86, v114
    v_mul_f32 v87, v87, v115
    s_waitcnt lgkmcnt(2)
    v_mfma_f32_32x32x16_bf16 v[64:79], v[44:47], v[204:207], v[64:79]
    v_xor_b32 v24, 32, v28
    ds_read_b64_tr_b16 v[36:37], v24 offset:16384
    ds_read_b64_tr_b16 v[38:39], v24 offset:16896
    v_exp_f32 v84, v84
    v_exp_f32 v85, v85
    v_exp_f32 v86, v86
    s_waitcnt lgkmcnt(2)
    v_mfma_f32_32x32x16_bf16 v[48:63], v[32:35], v[208:211], v[48:63]
    ds_read_b64_tr_b16 v[40:41], v29 offset:16384
    ds_read_b64_tr_b16 v[42:43], v29 offset:16896
    v_exp_f32 v87, v87
    v_mul_f32 v112, v112, v120
    v_mul_f32 v113, v113, v121
    v_mul_f32 v114, v114, v122
    s_waitcnt lgkmcnt(2)
    v_mfma_f32_32x32x16_bf16 v[64:79], v[36:39], v[208:211], v[64:79]
    v_xor_b32 v24, 32, v29
    ds_read_b64_tr_b16 v[44:45], v24 offset:16384
    ds_read_b64_tr_b16 v[46:47], v24 offset:16896
    v_mul_f32 v115, v115, v123
    v_fma_f32 v84, v84, v8, v8
    v_fma_f32 v85, v85, v8, v8
    v_fma_f32 v86, v86, v8, v8
    v_fma_f32 v87, v87, v8, v8
    s_waitcnt lgkmcnt(2)
    v_mfma_f32_32x32x16_bf16 v[48:63], v[40:43], v[212:215], v[48:63]
    ds_read_b64_tr_b16 v[32:33], v30 offset:16384
    ds_read_b64_tr_b16 v[34:35], v30 offset:16896
    v_rcp_f32 v84, v84
    v_rcp_f32 v85, v85
    v_rcp_f32 v86, v86
    s_waitcnt lgkmcnt(2)
    v_mfma_f32_32x32x16_bf16 v[64:79], v[44:47], v[212:215], v[64:79]
    v_smfmac_f32_16x16x64_bf16 v[12:15], v[16:19], v[40:47], v128
    v_xor_b32 v24, 32, v30
    ds_read_b64_tr_b16 v[36:37], v24 offset:16384
    ds_read_b64_tr_b16 v[38:39], v24 offset:16896
    v_rcp_f32 v87, v87
    v_mul_f32 v112, v112, v84
    v_mul_f32 v113, v113, v85
    v_mul_f32 v114, v114, v86
    s_waitcnt lgkmcnt(2)
    v_mfma_f32_32x32x16_bf16 v[48:63], v[32:35], v[216:219], v[48:63]
    ds_read_b64_tr_b16 v[40:41], v31 offset:16384
    ds_read_b64_tr_b16 v[42:43], v31 offset:16896
    v_mul_f32 v115, v115, v87
    v_mul_f32 v88, v116, v116
    v_mul_f32 v89, v117, v117
    v_mul_f32 v90, v118, v118
    v_mul_f32 v91, v119, v119
    v_fma_f32 v88, v88, v7, v6
    s_waitcnt lgkmcnt(2)
    v_mfma_f32_32x32x16_bf16 v[64:79], v[36:39], v[216:219], v[64:79]
    v_xor_b32 v24, 32, v31
    ds_read_b64_tr_b16 v[44:45], v24 offset:16384
    ds_read_b64_tr_b16 v[46:47], v24 offset:16896
    v_fma_f32 v89, v89, v7, v6
    v_fma_f32 v90, v90, v7, v6
    v_fma_f32 v91, v91, v7, v6
    v_mul_f32 v88, v88, v116
    v_mul_f32 v89, v89, v117
    s_waitcnt vmcnt(1)
    s_waitcnt lgkmcnt(2)
    v_mfma_f32_32x32x16_bf16 v[48:63], v[40:43], v[220:223], v[48:63]
    s_barrier
    ds_read_b64_tr_b16 v[32:33], v1 offset:24576
    ds_read_b64_tr_b16 v[34:35], v1 offset:25088
    v_mul_f32 v90, v90, v118
    v_mul_f32 v91, v91, v119
    v_exp_f32 v88, v88
    v_exp_f32 v89, v89
    s_waitcnt lgkmcnt(2)
    v_mfma_f32_32x32x16_bf16 v[64:79], v[44:47], v[220:223], v[64:79]
    v_xor_b32 v24, 32, v1
    ds_read_b64_tr_b16 v[36:37], v24 offset:24576
    ds_read_b64_tr_b16 v[38:39], v24 offset:25088
    buffer_load_dword v155, v154, s[32:35], s70 offen sc1
    v_exp_f32 v90, v90
    v_exp_f32 v91, v91
    v_mul_f32 v116, v116, v124
    s_waitcnt lgkmcnt(2)
    v_mfma_f32_32x32x16_bf16 v[48:63], v[32:35], v[224:227], v[48:63]
    ds_read_b64_tr_b16 v[40:41], v2 offset:24576
    ds_read_b64_tr_b16 v[42:43], v2 offset:25088
    v_mul_f32 v117, v117, v125
    v_mul_f32 v118, v118, v126
    v_mul_f32 v119, v119, v127
    v_fma_f32 v88, v88, v8, v8
    v_fma_f32 v89, v89, v8, v8
    v_fma_f32 v90, v90, v8, v8
    s_waitcnt lgkmcnt(2)
    v_mfma_f32_32x32x16_bf16 v[64:79], v[36:39], v[224:227], v[64:79]
    v_xor_b32 v24, 32, v2
    ds_read_b64_tr_b16 v[44:45], v24 offset:24576
    ds_read_b64_tr_b16 v[46:47], v24 offset:25088
    v_fma_f32 v91, v91, v8, v8
    v_rcp_f32 v88, v88
    v_rcp_f32 v89, v89
    s_waitcnt lgkmcnt(2)
    v_mfma_f32_32x32x16_bf16 v[48:63], v[40:43], v[228:231], v[48:63]
    ds_read_b64_tr_b16 v[32:33], v3 offset:24576
    ds_read_b64_tr_b16 v[34:35], v3 offset:25088
    v_rcp_f32 v90, v90
    v_rcp_f32 v91, v91
    v_cvt_pk_bf16_f32 v136, v112, v113
    v_cvt_pk_bf16_f32 v137, v114, v115
    s_waitcnt lgkmcnt(2)
    v_mfma_f32_32x32x16_bf16 v[64:79], v[44:47], v[228:231], v[64:79]
    v_smfmac_f32_16x16x64_bf16 v[12:15], v[16:19], v[40:47], v128
    v_xor_b32 v24, 32, v3
    ds_read_b64_tr_b16 v[36:37], v24 offset:24576
    ds_read_b64_tr_b16 v[38:39], v24 offset:25088
    v_mul_f32 v116, v116, v88
    v_mul_f32 v117, v117, v89
    v_mul_f32 v118, v118, v90
    v_mul_f32 v119, v119, v91
    v_cvt_pk_bf16_f32 v138, v116, v117
    s_waitcnt lgkmcnt(2)
    v_mfma_f32_32x32x16_bf16 v[48:63], v[32:35], v[232:235], v[48:63]
    ds_read_b64_tr_b16 v[40:41], v4 offset:24576
    ds_read_b64_tr_b16 v[42:43], v4 offset:25088
    v_cvt_pk_bf16_f32 v139, v118, v119
    s_mul_i32 s71, s47, 144
    s_add_u32 s71, s71, s62
    s_lshl_b32 s71, s71, 10
    s_add_u32 s58, s71, 6291456
    s_lshl_b32 s57, s54, 1
    s_and_b32 s71, s42, 1
    s_add_u32 s57, s57, s71
    s_lshl_b32 s57, s57, 15
    s_lshl_b32 s71, s55, 7
    s_add_u32 s57, s57, s71
    s_lshr_b32 s71, s42, 1
    s_lshl_b32 s71, s71, 5
    s_waitcnt lgkmcnt(2)
    v_mfma_f32_32x32x16_bf16 v[64:79], v[36:39], v[232:235], v[64:79]
    v_xor_b32 v24, 32, v4
    ds_read_b64_tr_b16 v[44:45], v24 offset:24576
    ds_read_b64_tr_b16 v[46:47], v24 offset:25088
    s_add_u32 s57, s57, s71
    v_mov_b32 v104, v0
    v_mov_b32 v105, v9
    v_mov_b32 v116, v9
    v_add_u32 v117, 65536, v9
    v_add_u32 v118, 131072, v9
    v_lshrrev_b32 v96, 5, v0
    v_and_b32 v97, 15, v0
    v_lshlrev_b32 v97, 4, v97
    v_lshl_add_u32 v119, v96, 8, v97
    s_waitcnt lgkmcnt(2)
    v_mfma_f32_32x32x16_bf16 v[48:63], v[40:43], v[236:239], v[48:63]
    ds_read_b64_tr_b16 v[32:33], v28 offset:24576
    ds_read_b64_tr_b16 v[34:35], v28 offset:25088
    v_add_u32 v120, 65536, v119
    v_add_u32 v121, 131072, v119
    v_and_b32 v97, 31, v0
    s_waitcnt lgkmcnt(2)
    v_mfma_f32_32x32x16_bf16 v[64:79], v[44:47], v[236:239], v[64:79]
    v_xor_b32 v24, 32, v28
    ds_read_b64_tr_b16 v[36:37], v24 offset:24576
    ds_read_b64_tr_b16 v[38:39], v24 offset:25088
    v_lshlrev_b32 v97, 10, v97
    v_lshl_add_u32 v125, v96, 4, v97
    v_lshrrev_b32 v97, 3, v0
    v_bfe_u32 v98, v0, 4, 1
    v_lshlrev_b32 v98, 2, v98
    v_and_b32 v122, 7, v0
    s_waitcnt lgkmcnt(2)
    v_mfma_f32_32x32x16_bf16 v[48:63], v[32:35], v[240:243], v[48:63]
    ds_read_b64_tr_b16 v[40:41], v29 offset:24576
    ds_read_b64_tr_b16 v[42:43], v29 offset:25088
    v_xor_b32 v98, v98, v122
    v_lshlrev_b32 v98, 4, v98
    v_lshl_add_u32 v122, v97, 10, v98
    v_bfe_u32 v97, v0, 2, 2
    v_lshl_add_u32 v96, v96, 2, v97
    v_lshlrev_b32 v96, 7, v96
    s_waitcnt lgkmcnt(2)
    v_mfma_f32_32x32x16_bf16 v[64:79], v[36:39], v[240:243], v[64:79]
    v_smfmac_f32_16x16x64_bf16 v[12:15], v[16:19], v[32:39], v128
    v_xor_b32 v24, 32, v29
    ds_read_b64_tr_b16 v[44:45], v24 offset:24576
    ds_read_b64_tr_b16 v[46:47], v24 offset:25088
    buffer_load_dword v164, v154, s[32:35], s70 offen sc1
    v_and_b32 v97, 3, v0
    v_lshl_add_u32 v96, v97, 3, v96
    v_bfe_u32 v97, v0, 3, 1
    v_lshlrev_b32 v97, 1, v97
    v_bfe_u32 v98, v0, 4, 1
    v_xor_b32 v97, v97, v98
    s_waitcnt lgkmcnt(2)
    v_mfma_f32_32x32x16_bf16 v[48:63], v[40:43], v[244:247], v[48:63]
    ds_read_b64_tr_b16 v[32:33], v30 offset:24576
    ds_read_b64_tr_b16 v[34:35], v30 offset:25088
    v_lshl_add_u32 v96, v97, 5, v96
    s_lshl_b32 s53, s42, 12
    s_add_u32 s53, s53, 106496
    v_add_u32 v123, s53, v96
    v_xor_b32 v124, 64, v123
    v_add_u32 v96, 16, v0
    s_waitcnt lgkmcnt(2)
    v_mfma_f32_32x32x16_bf16 v[64:79], v[44:47], v[244:247], v[64:79]
    v_xor_b32 v24, 32, v30
    ds_read_b64_tr_b16 v[36:37], v24 offset:24576
    ds_read_b64_tr_b16 v[38:39], v24 offset:25088
    v_add_f32 v12, v12, v13
    v_and_b32 v26, 0xffff0000, v12
    v_sub_f32 v27, v12, v26
    v_cvt_pk_bf16_f32 v12, v26, v27
    v_add_f32 v14, v14, v15
    v_and_b32 v26, 0xffff0000, v14
    v_sub_f32 v27, v14, v26
    v_cvt_pk_bf16_f32 v14, v26, v27
    s_mov_b32 exec_hi, 0
    ds_write_b32 v150, v12 offset:0
    ds_write_b32 v150, v14 offset:256
    s_mov_b64 exec, -1
    s_waitcnt lgkmcnt(4)
    v_mfma_f32_32x32x16_bf16 v[48:63], v[32:35], v[248:251], v[48:63]
    ds_read_b64_tr_b16 v[40:41], v31 offset:24576
    ds_read_b64_tr_b16 v[42:43], v31 offset:25088
    v_and_b32 v96, 31, v96
    v_lshrrev_b32 v97, 2, v96
    v_and_b32 v96, 3, v96
    s_waitcnt lgkmcnt(4)
    v_mfma_f32_32x32x16_bf16 v[64:79], v[36:39], v[248:251], v[64:79]
    v_xor_b32 v24, 32, v31
    ds_read_b64_tr_b16 v[44:45], v24 offset:24576
    ds_read_b64_tr_b16 v[46:47], v24 offset:25088
    s_waitcnt lgkmcnt(4)
    s_barrier
    ds_read_b128 v[156:159], v151 offset:0
    ds_read_b128 v[160:163], v151 offset:512
    s_and_b32 s71, s63, 1
    s_lshl_b32 s71, s71, 2
    v_add_u32 v96, s71, v96
    v_and_b32 v98, 1, v97
    v_lshl_add_u32 v96, v98, 3, v96
    v_lshrrev_b32 v97, 1, v97
    v_lshl_add_u32 v96, v96, 4, v97
    s_lshr_b32 s71, s63, 1
    s_lshl_b32 s71, s71, 2
    s_waitcnt lgkmcnt(4)
    v_mfma_f32_32x32x16_bf16 v[48:63], v[40:43], v[252:255], v[48:63]
    v_add_u32 v96, s71, v96
    s_lshr_b32 s71, s54, 1
    s_lshl_b32 s71, s71, 4
    v_add_u32 v97, s71, v0
    v_cmp_gt_u32 vcc, 16, v0
    s_nop 1
    v_cndmask_b32 v96, v96, v97, vcc
    v_lshlrev_b32 v96, 7, v96
    v_add_u32 v126, 23101440, v96
    s_lshr_b32 s71, s42, 1
    s_waitcnt lgkmcnt(2)
    v_mfma_f32_32x32x16_bf16 v[64:79], v[44:47], v[252:255], v[64:79]
    s_waitcnt vmcnt(1)
    v_cmp_ne_u32 vcc, s64, v155
    s_cmp_eq_u32 s70, 0
    s_cselect_b64 vcc, vcc, 0
    s_cbranch_vccz L_BACK_pfa_QK12
    s_waitcnt vmcnt(0)
    v_cmp_ne_u32 vcc, s64, v164
    s_nop 1
    s_cbranch_vccz L_BACK_pfa_QK12
    s_mov_b32 s3, 20000
L_SPIN_pfa_QK12:
    s_sleep 1
    buffer_load_dword v155, v154, s[32:35], s70 offen sc1
    s_waitcnt vmcnt(0)
    v_cmp_ne_u32 vcc, s64, v155
    s_nop 0
    s_sub_u32 s3, s3, 1
    s_cbranch_vccz L_BACK_pfa_QK12
    s_cmp_lg_u32 s3, 0
    s_cbranch_scc1 L_SPIN_pfa_QK12
L_BACK_pfa_QK12:
    s_barrier
    s_lshl_b32 s3, s62, 6
    s_add_u32 s3, s3, s47
    s_lshl_b32 s3, s3, 10
    buffer_load_dwordx4 v[108:111], v9, s[32:35], s3 offen sc1
    s_add_u32 s49, s51, 0
    s_and_b32 s49, s49, 0x1ffff
    s_add_u32 m0, s56, 139264
    s_add_u32 s49, s49, s48
    buffer_load_dwordx4 v9, s[32:35], s49 offen sc1 lds
    s_add_u32 s49, s51, 8192
    s_and_b32 s49, s49, 0x1ffff
    s_add_u32 m0, s56, 147456
    s_add_u32 s49, s49, s48
    buffer_load_dwordx4 v9, s[32:35], s49 offen sc1 lds
    s_add_u32 s49, s51, 16384
    s_and_b32 s49, s49, 0x1ffff
    s_add_u32 m0, s56, 155648
    s_add_u32 s49, s49, s48
    buffer_load_dwordx4 v9, s[32:35], s49 offen sc1 lds
    s_waitcnt lgkmcnt(0)
    v_mfma_f32_32x32x16_bf16 v[48:63], v[156:159], v[20:23], v[48:63]
    v_mfma_f32_32x32x16_bf16 v[64:79], v[160:163], v[20:23], v[64:79]
    s_lshl_b32 s71, s71, 14
    s_sub_u32 s71, s71, s53
    v_add_u32 v102, s71, v123
    v_xor_b32 v103, 64, v102
    s_lshl_b32 s71, s55, 7
    s_mul_i32 s50, s42, 229376
    s_add_u32 s50, s50, s71
    s_lshl_b32 s59, s42, 16
    s_add_u32 s59, s59, s71
    s_mul_i32 s71, s54, 288
    s_mul_i32 s52, s42, 14
    s_add_u32 s52, s52, s71
    s_lshl_b32 s52, s52, 10
    s_add_u32 s52, s52, 6324224
    v_and_b32 v96, 27, v0
    v_cmp_eq_u32 vcc, 16, v96
    v_mov_b32 v97, 0x3f803f80
    s_nop 0
    v_cndmask_b32 v16, 0, v97, vcc
    v_cndmask_b32 v17, 0, v97, vcc
    v_cndmask_b32 v18, 0, v97, vcc
    v_cndmask_b32 v19, 0, v97, vcc
    v_cndmask_b32 v20, 0, v97, vcc
    v_cndmask_b32 v21, 0, v97, vcc
    v_cndmask_b32 v22, 0, v97, vcc
    v_cndmask_b32 v23, 0, v97, vcc
    v_cndmask_b32 v24, 0, v97, vcc
    v_cndmask_b32 v25, 0, v97, vcc
    v_cndmask_b32 v26, 0, v97, vcc
    v_cndmask_b32 v27, 0, v97, vcc
    v_cndmask_b32 v28, 0, v97, vcc
    v_cndmask_b32 v29, 0, v97, vcc
    v_cndmask_b32 v30, 0, v97, vcc
    v_cndmask_b32 v31, 0, v97, vcc
    s_and_b32 s3, s62, 3
    s_mul_i32 s3, s3, 3
    s_lshl_b32 s6, s63, 1
    s_add_u32 s6, s6, s3
    s_sub_u32 s3, s6, 14
    s_cmp_ge_u32 s6, 14
    s_cselect_b32 s60, s3, s6
    v_mov_b32 v184, v6
    v_mov_b32 v186, v7
    v_mov_b32 v188, v8
    v_pk_mul_f32 v[168:169], v[48:49], v[48:49]
    v_pk_mul_f32 v[170:171], v[50:51], v[50:51]
    v_pk_mul_f32 v[172:173], v[52:53], v[52:53]
    v_pk_mul_f32 v[174:175], v[54:55], v[54:55]
    v_pk_fma_f32 v[168:169], v[168:169], v[186:187], v[184:185] op_sel_hi:[1,0,0]
    v_pk_fma_f32 v[170:171], v[170:171], v[186:187], v[184:185] op_sel_hi:[1,0,0]
    v_pk_fma_f32 v[172:173], v[172:173], v[186:187], v[184:185] op_sel_hi:[1,0,0]
    v_pk_fma_f32 v[174:175], v[174:175], v[186:187], v[184:185] op_sel_hi:[1,0,0]
    v_pk_mul_f32 v[168:169], v[168:169], v[48:49]
    v_pk_mul_f32 v[170:171], v[170:171], v[50:51]
    v_pk_mul_f32 v[172:173], v[172:173], v[52:53]
    v_pk_mul_f32 v[174:175], v[174:175], v[54:55]
    v_exp_f32 v168, v168
    v_exp_f32 v169, v169
    v_exp_f32 v170, v170
    v_exp_f32 v171, v171
    v_exp_f32 v172, v172
    v_exp_f32 v173, v173
    v_exp_f32 v174, v174
    v_exp_f32 v175, v175
    v_pk_mul_f32 v[48:49], v[48:49], v[56:57]
    v_pk_mul_f32 v[50:51], v[50:51], v[58:59]
    v_pk_mul_f32 v[52:53], v[52:53], v[60:61]
    v_pk_mul_f32 v[54:55], v[54:55], v[62:63]
    v_pk_fma_f32 v[168:169], v[168:169], v[188:189], v[188:189] op_sel_hi:[1,0,0]
    v_pk_fma_f32 v[170:171], v[170:171], v[188:189], v[188:189] op_sel_hi:[1,0,0]
    v_pk_fma_f32 v[172:173], v[172:173], v[188:189], v[188:189] op_sel_hi:[1,0,0]
    v_pk_fma_f32 v[174:175], v[174:175], v[188:189], v[188:189] op_sel_hi:[1,0,0]
    v_rcp_f32 v168, v168
    v_rcp_f32 v169, v169
    v_rcp_f32 v170, v170
    v_rcp_f32 v171, v171
    v_rcp_f32 v172, v172
    v_rcp_f32 v173, v173
    v_rcp_f32 v174, v174
    v_rcp_f32 v175, v175
    v_pk_mul_f32 v[48:49], v[48:49], v[168:169]
    v_pk_mul_f32 v[50:51], v[50:51], v[170:171]
    v_pk_mul_f32 v[52:53], v[52:53], v[172:173]
    v_pk_mul_f32 v[54:55], v[54:55], v[174:175]
    v_cvt_pk_bf16_f32 v140, v48, v49
    v_cvt_pk_bf16_f32 v141, v50, v51
    v_cvt_pk_bf16_f32 v142, v52, v53
    v_cvt_pk_bf16_f32 v143, v54, v55
    s_branch L_COMMON
L_QK3:
    v_add_u32 v72, 32768, v68
    v_xor_b32 v76, 32, v68
    v_add_u32 v76, 65536, v76
    v_add_u32 v73, 32768, v69
    v_xor_b32 v77, 32, v69
    v_add_u32 v77, 65536, v77
    v_add_u32 v74, 32768, v70
    v_xor_b32 v78, 32, v70
    v_add_u32 v78, 65536, v78
    v_add_u32 v75, 32768, v71
    v_xor_b32 v79, 32, v71
    v_add_u32 v79, 65536, v79
    s_lshr_b32 s0, s57, 7
    s_and_b32 s1, s0, 7
    s_lshl_b32 s1, s1, 1
    s_add_u32 s1, s1, s44
    s_lshl_b32 s1, s1, 7
    s_add_u32 s1, s1, s61
    s_lshl_b32 s66, s1, 10
    s_lshl_b32 s67, s1, 11
    s_add_u32 s67, s67, 2097152
    s_cmp_ge_u32 s0, 8
    s_cselect_b32 s66, s67, s66
    s_cselect_b32 s67, 2, 1
    s_lshl_b32 s67, s67, 16
    s_add_u32 s67, s67, s66
    s_lshr_b32 s0, s58, 7
    s_and_b32 s1, s0, 7
    s_lshl_b32 s1, s1, 1
    s_add_u32 s1, s1, s44
    s_lshl_b32 s1, s1, 7
    s_add_u32 s1, s1, s61
    s_lshl_b32 s80, s1, 10
    s_lshl_b32 s81, s1, 11
    s_add_u32 s81, s81, 2097152
    s_cmp_ge_u32 s0, 8
    s_cselect_b32 s80, s81, s80
    s_cselect_b32 s81, 2, 1
    s_lshl_b32 s81, s81, 16
    s_add_u32 s81, s81, s80
    s_lshr_b32 s0, s59, 7
    s_and_b32 s1, s0, 7
    s_lshl_b32 s1, s1, 1
    s_add_u32 s1, s1, s44
    s_lshl_b32 s1, s1, 7
    s_add_u32 s1, s1, s61
    s_lshl_b32 s82, s1, 10
    s_lshl_b32 s83, s1, 11
    s_add_u32 s83, s83, 2097152
    s_cmp_ge_u32 s0, 8
    s_cselect_b32 s82, s83, s82
    s_cselect_b32 s83, 2, 1
    s_lshl_b32 s83, s83, 16
    s_add_u32 s83, s83, s82
    s_lshr_b32 s40, s58, 5
    s_lshl_b32 s71, s44, 1
    s_add_u32 s40, s40, s71
    s_mul_i32 s71, s61, 144
    s_add_u32 s40, s40, s71
    s_lshl_b32 s40, s40, 10
    s_add_u32 s40, s40, 6324224
    s_lshr_b32 s41, s60, 5
    s_lshl_b32 s71, s44, 1
    s_add_u32 s41, s41, s71
    s_mul_i32 s71, s61, 144
    s_add_u32 s41, s41, s71
    s_lshl_b32 s41, s41, 10
    s_add_u32 s41, s41, 6324224
    s_mov_b32 s40, 0x7fffff00
    s_waitcnt vmcnt(8)
    s_barrier
    ds_read_b128 v[128:131], v64 offset:0
    ds_read_b64_tr_b16 v[24:25], v68 offset:0
    ds_read_b64_tr_b16 v[26:27], v68 offset:512
    ds_read_b64_tr_b16 v[28:29], v72 offset:0
    ds_read_b64_tr_b16 v[30:31], v72 offset:512
    ds_read_b64_tr_b16 v[32:33], v76 offset:0
    ds_read_b64_tr_b16 v[34:35], v76 offset:512
    s_waitcnt lgkmcnt(4)
    v_mfma_f32_32x32x16_bf16 v[80:95], v[24:27], v[128:131], 0
    ds_read_b128 v[132:135], v65 offset:0
    ds_read_b64_tr_b16 v[36:37], v69 offset:0
    ds_read_b64_tr_b16 v[38:39], v69 offset:512
    s_waitcnt lgkmcnt(5)
    v_mfma_f32_32x32x16_bf16 v[96:111], v[28:31], v[128:131], 0
    ds_read_b64_tr_b16 v[40:41], v73 offset:0
    ds_read_b64_tr_b16 v[42:43], v73 offset:512
    s_lshl_b32 s51, s50, 7
    s_add_u32 m0, s52, 16384
    s_add_u32 s51, s51, s48
    buffer_load_dwordx4 v5, s[8:11], s51 offen lds
    s_waitcnt lgkmcnt(5)
    v_mfma_f32_32x32x16_bf16 v[112:127], v[32:35], v[128:131], 0
    ds_read_b64_tr_b16 v[44:45], v77 offset:0
    ds_read_b64_tr_b16 v[46:47], v77 offset:512
    s_add_u32 m0, s52, 17408
    s_mul_i32 s49, s50, 196608
    buffer_load_dwordx4 v6, s[8:11], s51 offen lds
    v_smfmac_f32_16x16x64_bf16 v[12:15], v[16:19], v[24:31], v52
    s_waitcnt lgkmcnt(4)
    v_mfma_f32_32x32x16_bf16 v[80:95], v[36:39], v[132:135], v[80:95]
    ds_read_b128 v[136:139], v66 offset:0
    ds_read_b64_tr_b16 v[24:25], v70 offset:0
    ds_read_b64_tr_b16 v[26:27], v70 offset:512
    s_waitcnt vmcnt(9)
    v_lshlrev_b32 v60, 16, v56
    v_and_b32 v61, 0xffff0000, v56
    v_add_f32 v62, v60, v61
    v_mul_f32 v63, v60, v60
    s_waitcnt lgkmcnt(5)
    v_mfma_f32_32x32x16_bf16 v[96:111], v[40:43], v[132:135], v[96:111]
    ds_read_b64_tr_b16 v[28:29], v74 offset:0
    ds_read_b64_tr_b16 v[30:31], v74 offset:512
    s_add_u32 m0, s56, 81920
    s_add_u32 s49, s49, s57
    buffer_load_dwordx4 v7, s[12:15], s49 offen lds
    s_mul_i32 s51, s50, s53
    v_fmac_f32 v63, v61, v61
    v_lshlrev_b32 v60, 16, v57
    v_and_b32 v61, 0xffff0000, v57
    v_add_f32 v62, v62, v60
    s_waitcnt lgkmcnt(5)
    v_mfma_f32_32x32x16_bf16 v[112:127], v[44:47], v[132:135], v[112:127]
    ds_read_b64_tr_b16 v[32:33], v78 offset:0
    ds_read_b64_tr_b16 v[34:35], v78 offset:512
    s_add_u32 m0, s56, 114688
    s_add_u32 s49, s51, s58
    buffer_load_dwordx4 v8, s[16:19], s49 offen lds
    v_smfmac_f32_16x16x64_bf16 v[12:15], v[48:51], v[44:51], v52
    v_fmac_f32 v63, v60, v60
    v_add_f32 v62, v62, v61
    v_fmac_f32 v63, v61, v61
    v_lshlrev_b32 v60, 16, v58
    s_waitcnt lgkmcnt(4)
    v_mfma_f32_32x32x16_bf16 v[80:95], v[24:27], v[136:139], v[80:95]
    ds_read_b128 v[140:143], v67 offset:0
    ds_read_b64_tr_b16 v[36:37], v71 offset:0
    ds_read_b64_tr_b16 v[38:39], v71 offset:512
    v_and_b32 v61, 0xffff0000, v58
    v_add_f32 v62, v62, v60
    v_fmac_f32 v63, v60, v60
    v_add_f32 v62, v62, v61
    s_waitcnt lgkmcnt(5)
    v_mfma_f32_32x32x16_bf16 v[96:111], v[28:31], v[136:139], v[96:111]
    ds_read_b64_tr_b16 v[40:41], v75 offset:0
    ds_read_b64_tr_b16 v[42:43], v75 offset:512
    s_add_u32 m0, s56, 147456
    s_add_u32 s49, s51, s59
    buffer_load_dwordx4 v9, s[20:23], s49 offen lds
    s_add_u32 s50, s50, 1
    s_and_b32 s50, s50, 7
    v_fmac_f32 v63, v61, v61
    v_lshlrev_b32 v60, 16, v59
    v_and_b32 v61, 0xffff0000, v59
    v_add_f32 v62, v62, v60
    s_waitcnt lgkmcnt(5)
    v_mfma_f32_32x32x16_bf16 v[112:127], v[32:35], v[136:139], v[112:127]
    ds_read_b64_tr_b16 v[44:45], v79 offset:0
    ds_read_b64_tr_b16 v[46:47], v79 offset:512
    v_fmac_f32 v63, v60, v60
    v_add_f32 v62, v62, v61
    v_fmac_f32 v63, v61, v61
    s_nop 0
    v_add_f32_dpp v62, v62, v62 row_shr:1 bound_ctrl:0
    s_waitcnt vmcnt(7)
    s_waitcnt lgkmcnt(4)
    v_mfma_f32_32x32x16_bf16 v[80:95], v[36:39], v[140:143], v[80:95]
    s_barrier
    ds_read_b128 v[144:147], v64 offset:8192
    ds_read_b64_tr_b16 v[24:25], v68 offset:8192
    ds_read_b64_tr_b16 v[26:27], v68 offset:8704
    v_add_f32_dpp v63, v63, v63 row_shr:1 bound_ctrl:0
    v_add_f32_dpp v62, v62, v62 row_shr:2 bound_ctrl:0
    s_nop 0
    v_add_f32_dpp v63, v63, v63 row_shr:2 bound_ctrl:0
    v_add_f32_dpp v62, v62, v62 row_shr:4 bound_ctrl:0
    s_waitcnt lgkmcnt(5)
    v_mfma_f32_32x32x16_bf16 v[96:111], v[40:43], v[140:143], v[96:111]
    ds_read_b64_tr_b16 v[28:29], v72 offset:8192
    ds_read_b64_tr_b16 v[30:31], v72 offset:8704
    s_lshl_b32 s51, s50, 7
    s_add_u32 m0, s52, 24576
    s_add_u32 s51, s51, s48
    buffer_load_dwordx4 v5, s[8:11], s51 offen lds
    v_add_f32_dpp v63, v63, v63 row_shr:4 bound_ctrl:0
    v_add_f32_dpp v62, v62, v62 row_shr:8 bound_ctrl:0
    s_nop 0
    v_add_f32_dpp v63, v63, v63 row_shr:8 bound_ctrl:0
    v_add_f32_dpp v62, v62, v62 row_bcast:15 row_mask:0xa
    s_waitcnt lgkmcnt(5)
    v_mfma_f32_32x32x16_bf16 v[112:127], v[44:47], v[140:143], v[112:127]
    ds_read_b64_tr_b16 v[32:33], v76 offset:8192
    ds_read_b64_tr_b16 v[34:35], v76 offset:8704
    s_add_u32 m0, s52, 25600
    s_mul_i32 s49, s50, 196608
    buffer_load_dwordx4 v6, s[8:11], s51 offen lds
    v_add_f32_dpp v63, v63, v63 row_bcast:15 row_mask:0xa
    v_add_f32_dpp v62, v62, v62 row_bcast:31 row_mask:0xc
    s_nop 0
    v_add_f32_dpp v63, v63, v63 row_bcast:31 row_mask:0xc
    v_mul_f32 v62, 0x3b000000, v62
    s_waitcnt lgkmcnt(4)
    v_mfma_f32_32x32x16_bf16 v[80:95], v[24:27], v[144:147], v[80:95]
    ds_read_b128 v[148:151], v65 offset:8192
    ds_read_b64_tr_b16 v[36:37], v69 offset:8192
    ds_read_b64_tr_b16 v[38:39], v69 offset:8704
    v_mul_f32 v63, 0x3b000000, v63
    v_cvt_pk_bf16_f32 v56, -v62, -v62
    v_fma_f32 v63, -v62, v62, v63
    v_max_f32 v63, 0, v63
    s_waitcnt lgkmcnt(5)
    v_mfma_f32_32x32x16_bf16 v[96:111], v[28:31], v[144:147], v[96:111]
    ds_read_b64_tr_b16 v[40:41], v73 offset:8192
    ds_read_b64_tr_b16 v[42:43], v73 offset:8704
    s_add_u32 m0, s56, 90112
    s_add_u32 s49, s49, s57
    buffer_load_dwordx4 v7, s[12:15], s49 offen lds
    s_mul_i32 s51, s50, s53
    v_cvt_pk_bf16_f32 v60, v63, v63
    v_and_b32 v60, 0xffff0000, v60
    v_add_f32 v60, 0x3727c5ac, v60
    v_cvt_pk_bf16_f32 v60, v60, v60
    s_waitcnt lgkmcnt(5)
    v_mfma_f32_32x32x16_bf16 v[112:127], v[32:35], v[144:147], v[112:127]
    ds_read_b64_tr_b16 v[44:45], v77 offset:8192
    ds_read_b64_tr_b16 v[46:47], v77 offset:8704
    v_smfmac_f32_16x16x64_bf16 v[12:15], v[16:19], v[24:31], v52
    v_and_b32 v60, 0xffff0000, v60
    v_sqrt_f32 v60, v60
    s_nop 0
    v_cvt_pk_bf16_f32 v60, v60, v60
    v_and_b32 v60, 0xffff0000, v60
    s_waitcnt lgkmcnt(4)
    v_mfma_f32_32x32x16_bf16 v[80:95], v[36:39], v[148:151], v[80:95]
    ds_read_b128 v[152:155], v66 offset:8192
    ds_read_b64_tr_b16 v[24:25], v70 offset:8192
    ds_read_b64_tr_b16 v[26:27], v70 offset:8704
    v_rcp_f32 v57, v60
    v_mul_f32 v58, v60, v60
    s_waitcnt lgkmcnt(5)
    v_mfma_f32_32x32x16_bf16 v[96:111], v[40:43], v[148:151], v[96:111]
    ds_read_b64_tr_b16 v[28:29], v74 offset:8192
    ds_read_b64_tr_b16 v[30:31], v74 offset:8704
    s_add_u32 m0, s56, 122880
    s_add_u32 s49, s51, s58
    buffer_load_dwordx4 v8, s[16:19], s49 offen lds
    s_waitcnt lgkmcnt(5)
    v_mfma_f32_32x32x16_bf16 v[112:127], v[44:47], v[148:151], v[112:127]
    ds_read_b64_tr_b16 v[32:33], v78 offset:8192
    ds_read_b64_tr_b16 v[34:35], v78 offset:8704
    v_smfmac_f32_16x16x64_bf16 v[12:15], v[48:51], v[44:51], v52
    s_waitcnt lgkmcnt(4)
    v_mfma_f32_32x32x16_bf16 v[80:95], v[24:27], v[152:155], v[80:95]
    ds_read_b128 v[156:159], v67 offset:8192
    ds_read_b64_tr_b16 v[36:37], v71 offset:8192
    ds_read_b64_tr_b16 v[38:39], v71 offset:8704
    s_waitcnt lgkmcnt(5)
    v_mfma_f32_32x32x16_bf16 v[96:111], v[28:31], v[152:155], v[96:111]
    ds_read_b64_tr_b16 v[40:41], v75 offset:8192
    ds_read_b64_tr_b16 v[42:43], v75 offset:8704
    s_add_u32 m0, s56, 155648
    s_add_u32 s49, s51, s59
    buffer_load_dwordx4 v9, s[20:23], s49 offen lds
    s_add_u32 s50, s50, 1
    s_and_b32 s50, s50, 7
    s_waitcnt lgkmcnt(5)
    v_mfma_f32_32x32x16_bf16 v[112:127], v[32:35], v[152:155], v[112:127]
    ds_read_b64_tr_b16 v[44:45], v79 offset:8192
    ds_read_b64_tr_b16 v[46:47], v79 offset:8704
    buffer_load_dword v23, v22, s[36:39], 0 offen sc1
    s_waitcnt vmcnt(6)
    s_waitcnt lgkmcnt(4)
    v_mfma_f32_32x32x16_bf16 v[80:95], v[36:39], v[156:159], v[80:95]
    s_barrier
    ds_read_b128 v[160:163], v64 offset:16384
    ds_read_b64_tr_b16 v[24:25], v68 offset:16384
    ds_read_b64_tr_b16 v[26:27], v68 offset:16896
    s_waitcnt lgkmcnt(5)
    v_mfma_f32_32x32x16_bf16 v[96:111], v[40:43], v[156:159], v[96:111]
    ds_read_b64_tr_b16 v[28:29], v72 offset:16384
    ds_read_b64_tr_b16 v[30:31], v72 offset:16896
    s_lshl_b32 s51, s50, 7
    s_add_u32 m0, s52, 0
    s_add_u32 s51, s51, s48
    buffer_load_dwordx4 v5, s[8:11], s51 offen lds
    s_waitcnt lgkmcnt(5)
    v_mfma_f32_32x32x16_bf16 v[112:127], v[44:47], v[156:159], v[112:127]
    ds_read_b64_tr_b16 v[32:33], v76 offset:16384
    ds_read_b64_tr_b16 v[34:35], v76 offset:16896
    s_add_u32 m0, s52, 1024
    s_mul_i32 s49, s50, 196608
    buffer_load_dwordx4 v6, s[8:11], s51 offen lds
    s_waitcnt lgkmcnt(4)
    v_mfma_f32_32x32x16_bf16 v[80:95], v[24:27], v[160:163], v[80:95]
    ds_read_b128 v[164:167], v65 offset:16384
    ds_read_b64_tr_b16 v[36:37], v69 offset:16384
    ds_read_b64_tr_b16 v[38:39], v69 offset:16896
    s_waitcnt lgkmcnt(5)
    v_mfma_f32_32x32x16_bf16 v[96:111], v[28:31], v[160:163], v[96:111]
    ds_read_b64_tr_b16 v[40:41], v73 offset:16384
    ds_read_b64_tr_b16 v[42:43], v73 offset:16896
    s_add_u32 m0, s56, 65536
    s_add_u32 s49, s49, s57
    buffer_load_dwordx4 v7, s[12:15], s49 offen lds
    s_mul_i32 s51, s50, s53
    s_waitcnt lgkmcnt(5)
    v_mfma_f32_32x32x16_bf16 v[112:127], v[32:35], v[160:163], v[112:127]
    ds_read_b64_tr_b16 v[44:45], v77 offset:16384
    ds_read_b64_tr_b16 v[46:47], v77 offset:16896
    v_smfmac_f32_16x16x64_bf16 v[12:15], v[16:19], v[24:31], v52
    s_waitcnt lgkmcnt(4)
    v_mfma_f32_32x32x16_bf16 v[80:95], v[36:39], v[164:167], v[80:95]
    ds_read_b128 v[168:171], v66 offset:16384
    ds_read_b64_tr_b16 v[24:25], v70 offset:16384
    ds_read_b64_tr_b16 v[26:27], v70 offset:16896
    s_waitcnt lgkmcnt(5)
    v_mfma_f32_32x32x16_bf16 v[96:111], v[40:43], v[164:167], v[96:111]
    ds_read_b64_tr_b16 v[28:29], v74 offset:16384
    ds_read_b64_tr_b16 v[30:31], v74 offset:16896
    s_add_u32 m0, s56, 98304
    s_add_u32 s49, s51, s58
    buffer_load_dwordx4 v8, s[16:19], s49 offen lds
    s_waitcnt lgkmcnt(5)
    v_mfma_f32_32x32x16_bf16 v[112:127], v[44:47], v[164:167], v[112:127]
    ds_read_b64_tr_b16 v[32:33], v78 offset:16384
    ds_read_b64_tr_b16 v[34:35], v78 offset:16896
    v_smfmac_f32_16x16x64_bf16 v[12:15], v[48:51], v[44:51], v52
    s_waitcnt lgkmcnt(4)
    v_mfma_f32_32x32x16_bf16 v[80:95], v[24:27], v[168:171], v[80:95]
    ds_read_b128 v[172:175], v67 offset:16384
    ds_read_b64_tr_b16 v[36:37], v71 offset:16384
    ds_read_b64_tr_b16 v[38:39], v71 offset:16896
    s_waitcnt lgkmcnt(5)
    v_mfma_f32_32x32x16_bf16 v[96:111], v[28:31], v[168:171], v[96:111]
    ds_read_b64_tr_b16 v[40:41], v75 offset:16384
    ds_read_b64_tr_b16 v[42:43], v75 offset:16896
    s_add_u32 m0, s56, 131072
    s_add_u32 s49, s51, s59
    buffer_load_dwordx4 v9, s[20:23], s49 offen lds
    s_add_u32 s50, s50, 1
    s_and_b32 s50, s50, 7
    s_waitcnt lgkmcnt(5)
    v_mfma_f32_32x32x16_bf16 v[112:127], v[32:35], v[168:171], v[112:127]
    ds_read_b64_tr_b16 v[44:45], v79 offset:16384
    ds_read_b64_tr_b16 v[46:47], v79 offset:16896
    s_waitcnt vmcnt(5)
    v_cmp_eq_u32 vcc, 0, v23
    s_nop 1
    s_cbranch_vccz L_BACK_tag_QK31
    s_mov_b32 s3, 20000
L_SPIN_tag_QK31:
    s_sleep 1
    buffer_load_dword v23, v22, s[36:39], 0 offen sc1
    s_waitcnt vmcnt(0)
    v_cmp_eq_u32 vcc, 0, v23
    s_nop 0
    s_sub_u32 s3, s3, 1
    s_cbranch_vccz L_BACK_tag_QK31
    s_cmp_lg_u32 s3, 0
    s_cbranch_scc1 L_SPIN_tag_QK31
L_BACK_tag_QK31:
    v_readfirstlane_b32 s64, v23
    v_mov_b32 v59, v23
    v_readlane_b32 s3, v56, 63
    v_readlane_b32 s4, v57, 63
    v_readlane_b32 s5, v58, 63
    v_lshlrev_b32 v61, 4, v0
    v_mov_b32 v56, s3
    v_mov_b32 v57, s4
    v_mov_b32 v58, s5
    s_lshl_b32 s3, s2, 10
    s_lshl_b32 s4, s42, 7
    s_add_u32 s3, s3, s4
    s_add_u32 s3, s3, 23134208
    s_mov_b64 exec, 0xff
    buffer_store_dwordx4 v[56:59], v61, s[32:35], s3 offen sc1
    s_mov_b64 exec, -1
    s_waitcnt vmcnt(6)
    s_waitcnt lgkmcnt(4)
    v_mfma_f32_32x32x16_bf16 v[80:95], v[36:39], v[172:175], v[80:95]
    s_barrier
    ds_read_b128 v[176:179], v64 offset:24576
    ds_read_b64_tr_b16 v[24:25], v68 offset:24576
    ds_read_b64_tr_b16 v[26:27], v68 offset:25088
    s_waitcnt lgkmcnt(5)
    v_mfma_f32_32x32x16_bf16 v[96:111], v[40:43], v[172:175], v[96:111]
    ds_read_b64_tr_b16 v[28:29], v72 offset:24576
    ds_read_b64_tr_b16 v[30:31], v72 offset:25088
    s_lshl_b32 s51, s50, 7
    s_add_u32 m0, s52, 8192
    s_add_u32 s51, s51, s48
    buffer_load_dwordx4 v5, s[8:11], s51 offen lds
    s_waitcnt lgkmcnt(5)
    v_mfma_f32_32x32x16_bf16 v[112:127], v[44:47], v[172:175], v[112:127]
    ds_read_b64_tr_b16 v[32:33], v76 offset:24576
    ds_read_b64_tr_b16 v[34:35], v76 offset:25088
    s_add_u32 m0, s52, 9216
    s_mul_i32 s49, s50, 196608
    buffer_load_dwordx4 v6, s[8:11], s51 offen lds
    s_waitcnt lgkmcnt(4)
    v_mfma_f32_32x32x16_bf16 v[80:95], v[24:27], v[176:179], v[80:95]
    ds_read_b128 v[180:183], v65 offset:24576
    ds_read_b64_tr_b16 v[36:37], v69 offset:24576
    ds_read_b64_tr_b16 v[38:39], v69 offset:25088
    s_waitcnt lgkmcnt(5)
    v_mfma_f32_32x32x16_bf16 v[96:111], v[28:31], v[176:179], v[96:111]
    ds_read_b64_tr_b16 v[40:41], v73 offset:24576
    ds_read_b64_tr_b16 v[42:43], v73 offset:25088
    s_add_u32 m0, s56, 73728
    s_add_u32 s49, s49, s57
    buffer_load_dwordx4 v7, s[12:15], s49 offen lds
    s_mul_i32 s51, s50, s53
    s_waitcnt lgkmcnt(5)
    v_mfma_f32_32x32x16_bf16 v[112:127], v[32:35], v[176:179], v[112:127]
    ds_read_b64_tr_b16 v[44:45], v77 offset:24576
    ds_read_b64_tr_b16 v[46:47], v77 offset:25088
    v_smfmac_f32_16x16x64_bf16 v[12:15], v[16:19], v[24:31], v52
    s_waitcnt lgkmcnt(4)
    v_mfma_f32_32x32x16_bf16 v[80:95], v[36:39], v[180:183], v[80:95]
    ds_read_b128 v[184:187], v66 offset:24576
    ds_read_b64_tr_b16 v[24:25], v70 offset:24576
    ds_read_b64_tr_b16 v[26:27], v70 offset:25088
    s_waitcnt lgkmcnt(5)
    v_mfma_f32_32x32x16_bf16 v[96:111], v[40:43], v[180:183], v[96:111]
    ds_read_b64_tr_b16 v[28:29], v74 offset:24576
    ds_read_b64_tr_b16 v[30:31], v74 offset:25088
    s_add_u32 m0, s56, 106496
    s_add_u32 s49, s51, s58
    buffer_load_dwordx4 v8, s[16:19], s49 offen lds
    s_waitcnt lgkmcnt(5)
    v_mfma_f32_32x32x16_bf16 v[112:127], v[44:47], v[180:183], v[112:127]
    ds_read_b64_tr_b16 v[32:33], v78 offset:24576
    ds_read_b64_tr_b16 v[34:35], v78 offset:25088
    v_smfmac_f32_16x16x64_bf16 v[12:15], v[48:51], v[44:51], v52
    s_waitcnt lgkmcnt(4)
    v_mfma_f32_32x32x16_bf16 v[80:95], v[24:27], v[184:187], v[80:95]
    ds_read_b128 v[188:191], v67 offset:24576
    ds_read_b64_tr_b16 v[36:37], v71 offset:24576
    ds_read_b64_tr_b16 v[38:39], v71 offset:25088
    s_waitcnt lgkmcnt(5)
    v_mfma_f32_32x32x16_bf16 v[96:111], v[28:31], v[184:187], v[96:111]
    ds_read_b64_tr_b16 v[40:41], v75 offset:24576
    ds_read_b64_tr_b16 v[42:43], v75 offset:25088
    s_add_u32 m0, s56, 139264
    s_add_u32 s49, s51, s59
    buffer_load_dwordx4 v9, s[20:23], s49 offen lds
    s_add_u32 s50, s50, 1
    s_and_b32 s50, s50, 7
    s_waitcnt lgkmcnt(5)
    v_mfma_f32_32x32x16_bf16 v[112:127], v[32:35], v[184:187], v[112:127]
    ds_read_b64_tr_b16 v[44:45], v79 offset:24576
    ds_read_b64_tr_b16 v[46:47], v79 offset:25088
    s_and_b32 s3, s45, 7
    s_lshl_b32 s3, s3, 3
    s_add_u32 s3, s3, s42
    s_lshl_b32 s3, s3, 3
    v_add_u32 v20, s3, v0
    v_mul_u32_u24 v20, 3584, v20
    s_mov_b64 exec, 0xff
    buffer_load_dword v252, v20, s[24:27], s60 offen
    buffer_load_dword v253, v20, s[28:31], s60 offen
    s_mov_b64 exec, -1
    s_waitcnt vmcnt(8)
    s_waitcnt lgkmcnt(4)
    v_mfma_f32_32x32x16_bf16 v[80:95], v[36:39], v[188:191], v[80:95]
    s_barrier
    ds_read_b128 v[192:195], v64 offset:0
    ds_read_b64_tr_b16 v[24:25], v68 offset:0
    ds_read_b64_tr_b16 v[26:27], v68 offset:512
    s_waitcnt lgkmcnt(5)
    v_mfma_f32_32x32x16_bf16 v[96:111], v[40:43], v[188:191], v[96:111]
    ds_read_b64_tr_b16 v[28:29], v72 offset:0
    ds_read_b64_tr_b16 v[30:31], v72 offset:512
    s_lshl_b32 s51, s50, 7
    s_add_u32 m0, s52, 16384
    s_add_u32 s51, s51, s48
    buffer_load_dwordx4 v5, s[8:11], s51 offen lds
    s_waitcnt lgkmcnt(5)
    v_mfma_f32_32x32x16_bf16 v[112:127], v[44:47], v[188:191], v[112:127]
    ds_read_b64_tr_b16 v[32:33], v76 offset:0
    ds_read_b64_tr_b16 v[34:35], v76 offset:512
    s_add_u32 m0, s52, 17408
    s_mul_i32 s49, s50, 196608
    buffer_load_dwordx4 v6, s[8:11], s51 offen lds
    s_waitcnt lgkmcnt(4)
    v_mfma_f32_32x32x16_bf16 v[80:95], v[24:27], v[192:195], v[80:95]
    ds_read_b128 v[196:199], v65 offset:0
    ds_read_b64_tr_b16 v[36:37], v69 offset:0
    ds_read_b64_tr_b16 v[38:39], v69 offset:512
    s_waitcnt lgkmcnt(5)
    v_mfma_f32_32x32x16_bf16 v[96:111], v[28:31], v[192:195], v[96:111]
    ds_read_b64_tr_b16 v[40:41], v73 offset:0
    ds_read_b64_tr_b16 v[42:43], v73 offset:512
    s_add_u32 m0, s56, 81920
    s_add_u32 s49, s49, s57
    buffer_load_dwordx4 v7, s[12:15], s49 offen lds
    s_mul_i32 s51, s50, s53
    s_waitcnt lgkmcnt(5)
    v_mfma_f32_32x32x16_bf16 v[112:127], v[32:35], v[192:195], v[112:127]
    ds_read_b64_tr_b16 v[44:45], v77 offset:0
    ds_read_b64_tr_b16 v[46:47], v77 offset:512
    v_smfmac_f32_16x16x64_bf16 v[12:15], v[16:19], v[24:31], v52
    s_waitcnt lgkmcnt(4)
    v_mfma_f32_32x32x16_bf16 v[80:95], v[36:39], v[196:199], v[80:95]
    ds_read_b128 v[200:203], v66 offset:0
    ds_read_b64_tr_b16 v[24:25], v70 offset:0
    ds_read_b64_tr_b16 v[26:27], v70 offset:512
    s_waitcnt lgkmcnt(5)
    v_mfma_f32_32x32x16_bf16 v[96:111], v[40:43], v[196:199], v[96:111]
    ds_read_b64_tr_b16 v[28:29], v74 offset:0
    ds_read_b64_tr_b16 v[30:31], v74 offset:512
    s_add_u32 m0, s56, 114688
    s_add_u32 s49, s51, s58
    buffer_load_dwordx4 v8, s[16:19], s49 offen lds
    s_waitcnt lgkmcnt(5)
    v_mfma_f32_32x32x16_bf16 v[112:127], v[44:47], v[196:199], v[112:127]
    ds_read_b64_tr_b16 v[32:33], v78 offset:0
    ds_read_b64_tr_b16 v[34:35], v78 offset:512
    v_smfmac_f32_16x16x64_bf16 v[12:15], v[48:51], v[44:51], v52
    s_waitcnt lgkmcnt(4)
    v_mfma_f32_32x32x16_bf16 v[80:95], v[24:27], v[200:203], v[80:95]
    ds_read_b128 v[204:207], v67 offset:0
    ds_read_b64_tr_b16 v[36:37], v71 offset:0
    ds_read_b64_tr_b16 v[38:39], v71 offset:512
    s_waitcnt lgkmcnt(5)
    v_mfma_f32_32x32x16_bf16 v[96:111], v[28:31], v[200:203], v[96:111]
    ds_read_b64_tr_b16 v[40:41], v75 offset:0
    ds_read_b64_tr_b16 v[42:43], v75 offset:512
    s_add_u32 m0, s56, 147456
    s_add_u32 s49, s51, s59
    buffer_load_dwordx4 v9, s[20:23], s49 offen lds
    s_add_u32 s50, s50, 1
    s_and_b32 s50, s50, 7
    s_waitcnt lgkmcnt(5)
    v_mfma_f32_32x32x16_bf16 v[112:127], v[32:35], v[200:203], v[112:127]
    ds_read_b64_tr_b16 v[44:45], v79 offset:0
    ds_read_b64_tr_b16 v[46:47], v79 offset:512
    s_waitcnt vmcnt(7)
    s_waitcnt lgkmcnt(4)
    v_mfma_f32_32x32x16_bf16 v[80:95], v[36:39], v[204:207], v[80:95]
    s_barrier
    ds_read_b128 v[208:211], v64 offset:8192
    ds_read_b64_tr_b16 v[24:25], v68 offset:8192
    ds_read_b64_tr_b16 v[26:27], v68 offset:8704
    s_waitcnt lgkmcnt(5)
    v_mfma_f32_32x32x16_bf16 v[96:111], v[40:43], v[204:207], v[96:111]
    ds_read_b64_tr_b16 v[28:29], v72 offset:8192
    ds_read_b64_tr_b16 v[30:31], v72 offset:8704
    s_lshl_b32 s51, s50, 7
    s_add_u32 m0, s52, 24576
    s_add_u32 s51, s51, s48
    buffer_load_dwordx4 v5, s[8:11], s51 offen lds
    s_waitcnt lgkmcnt(5)
    v_mfma_f32_32x32x16_bf16 v[112:127], v[44:47], v[204:207], v[112:127]
    ds_read_b64_tr_b16 v[32:33], v76 offset:8192
    ds_read_b64_tr_b16 v[34:35], v76 offset:8704
    s_add_u32 m0, s52, 25600
    s_mul_i32 s49, s50, 196608
    buffer_load_dwordx4 v6, s[8:11], s51 offen lds
    s_waitcnt lgkmcnt(4)
    v_mfma_f32_32x32x16_bf16 v[80:95], v[24:27], v[208:211], v[80:95]
    ds_read_b128 v[212:215], v65 offset:8192
    ds_read_b64_tr_b16 v[36:37], v69 offset:8192
    ds_read_b64_tr_b16 v[38:39], v69 offset:8704
    s_waitcnt lgkmcnt(5)
    v_mfma_f32_32x32x16_bf16 v[96:111], v[28:31], v[208:211], v[96:111]
    ds_read_b64_tr_b16 v[40:41], v73 offset:8192
    ds_read_b64_tr_b16 v[42:43], v73 offset:8704
    s_add_u32 m0, s56, 90112
    s_add_u32 s49, s49, s57
    buffer_load_dwordx4 v7, s[12:15], s49 offen lds
    s_mul_i32 s51, s50, s53
    s_waitcnt lgkmcnt(5)
    v_mfma_f32_32x32x16_bf16 v[112:127], v[32:35], v[208:211], v[112:127]
    ds_read_b64_tr_b16 v[44:45], v77 offset:8192
    ds_read_b64_tr_b16 v[46:47], v77 offset:8704
    v_smfmac_f32_16x16x64_bf16 v[12:15], v[16:19], v[24:31], v52
    s_waitcnt lgkmcnt(4)
    v_mfma_f32_32x32x16_bf16 v[80:95], v[36:39], v[212:215], v[80:95]
    ds_read_b128 v[216:219], v66 offset:8192
    ds_read_b64_tr_b16 v[24:25], v70 offset:8192
    ds_read_b64_tr_b16 v[26:27], v70 offset:8704
    s_waitcnt lgkmcnt(5)
    v_mfma_f32_32x32x16_bf16 v[96:111], v[40:43], v[212:215], v[96:111]
    ds_read_b64_tr_b16 v[28:29], v74 offset:8192
    ds_read_b64_tr_b16 v[30:31], v74 offset:8704
    s_add_u32 m0, s56, 122880
    s_add_u32 s49, s51, s58
    buffer_load_dwordx4 v8, s[16:19], s49 offen lds
    s_waitcnt lgkmcnt(5)
    v_mfma_f32_32x32x16_bf16 v[112:127], v[44:47], v[212:215], v[112:127]
    ds_read_b64_tr_b16 v[32:33], v78 offset:8192
    ds_read_b64_tr_b16 v[34:35], v78 offset:8704
    v_smfmac_f32_16x16x64_bf16 v[12:15], v[48:51], v[44:51], v52
    v_and_b32 v61, 15, v0
    v_lshlrev_b32 v61, 4, v61
    v_lshrrev_b32 v62, 4, v0
    v_lshl_add_u32 v61, v62, 9, v61
    s_mul_i32 s71, s44, 1536
    s_lshl_b32 s0, s43, 2
    s_add_u32 s71, s71, s0
    s_add_u32 s71, s71, 133120
    v_add_u32 v61, s71, v61
    s_waitcnt lgkmcnt(4)
    v_mfma_f32_32x32x16_bf16 v[80:95], v[24:27], v[216:219], v[80:95]
    ds_read_b128 v[220:223], v67 offset:8192
    ds_read_b64_tr_b16 v[36:37], v71 offset:8192
    ds_read_b64_tr_b16 v[38:39], v71 offset:8704
    s_waitcnt lgkmcnt(5)
    v_mfma_f32_32x32x16_bf16 v[96:111], v[28:31], v[216:219], v[96:111]
    ds_read_b64_tr_b16 v[40:41], v75 offset:8192
    ds_read_b64_tr_b16 v[42:43], v75 offset:8704
    s_add_u32 m0, s56, 155648
    s_add_u32 s49, s51, s59
    buffer_load_dwordx4 v9, s[20:23], s49 offen lds
    s_add_u32 s50, s50, 1
    s_and_b32 s50, s50, 7
    s_waitcnt lgkmcnt(5)
    v_mfma_f32_32x32x16_bf16 v[112:127], v[32:35], v[216:219], v[112:127]
    ds_read_b64_tr_b16 v[44:45], v79 offset:8192
    ds_read_b64_tr_b16 v[46:47], v79 offset:8704
    s_waitcnt vmcnt(5)
    s_waitcnt lgkmcnt(4)
    v_mfma_f32_32x32x16_bf16 v[80:95], v[36:39], v[220:223], v[80:95]
    s_barrier
    ds_read_b128 v[224:227], v64 offset:16384
    ds_read_b64_tr_b16 v[24:25], v68 offset:16384
    ds_read_b64_tr_b16 v[26:27], v68 offset:16896
    s_waitcnt lgkmcnt(5)
    v_mfma_f32_32x32x16_bf16 v[96:111], v[40:43], v[220:223], v[96:111]
    ds_read_b64_tr_b16 v[28:29], v72 offset:16384
    ds_read_b64_tr_b16 v[30:31], v72 offset:16896
    s_mul_i32 s49, s50, 229376
    s_add_u32 m0, s56, 0
    s_add_u32 s49, s49, s60
    buffer_load_dwordx4 v10, s[24:27], s49 offen lds
    s_waitcnt lgkmcnt(5)
    v_mfma_f32_32x32x16_bf16 v[112:127], v[44:47], v[220:223], v[112:127]
    ds_read_b64_tr_b16 v[32:33], v76 offset:16384
    ds_read_b64_tr_b16 v[34:35], v76 offset:16896
    v_and_b32 v62, 31, v0
    s_mul_i32 s3, s44, 1536
    s_add_u32 s3, s3, 133120
    v_lshl_add_u32 v9, v62, 4, s3
    s_lshl_b32 s3, s61, 12
    s_add_u32 s3, s3, 23134208
    v_lshl_add_u32 v60, v62, 7, s3
    buffer_load_dwordx4 v[56:59], v60, s[32:35], 0 offen sc1
    s_waitcnt lgkmcnt(4)
    v_mfma_f32_32x32x16_bf16 v[80:95], v[24:27], v[224:227], v[80:95]
    ds_read_b128 v[228:231], v65 offset:16384
    ds_read_b64_tr_b16 v[36:37], v69 offset:16384
    ds_read_b64_tr_b16 v[38:39], v69 offset:16896
    s_waitcnt lgkmcnt(5)
    v_mfma_f32_32x32x16_bf16 v[96:111], v[28:31], v[224:227], v[96:111]
    ds_read_b64_tr_b16 v[40:41], v73 offset:16384
    ds_read_b64_tr_b16 v[42:43], v73 offset:16896
    s_add_u32 m0, s56, 32768
    s_add_u32 s50, s50, 1
    buffer_load_dwordx4 v11, s[28:31], s49 offen lds
    s_and_b32 s50, s50, 7
    s_waitcnt lgkmcnt(5)
    v_mfma_f32_32x32x16_bf16 v[112:127], v[32:35], v[224:227], v[112:127]
    ds_read_b64_tr_b16 v[44:45], v77 offset:16384
    ds_read_b64_tr_b16 v[46:47], v77 offset:16896
    v_smfmac_f32_16x16x64_bf16 v[12:15], v[16:19], v[24:31], v52
    s_waitcnt lgkmcnt(4)
    v_mfma_f32_32x32x16_bf16 v[80:95], v[36:39], v[228:231], v[80:95]
    ds_read_b128 v[232:235], v66 offset:16384
    ds_read_b64_tr_b16 v[24:25], v70 offset:16384
    ds_read_b64_tr_b16 v[26:27], v70 offset:16896
    s_waitcnt lgkmcnt(5)
    v_mfma_f32_32x32x16_bf16 v[96:111], v[40:43], v[228:231], v[96:111]
    ds_read_b64_tr_b16 v[28:29], v74 offset:16384
    ds_read_b64_tr_b16 v[30:31], v74 offset:16896
    s_mul_i32 s49, s50, 229376
    s_add_u32 m0, s56, 65536
    s_add_u32 s49, s49, s60
    buffer_load_dwordx4 v10, s[24:27], s49 offen lds
    s_waitcnt lgkmcnt(5)
    v_mfma_f32_32x32x16_bf16 v[112:127], v[44:47], v[228:231], v[112:127]
    ds_read_b64_tr_b16 v[32:33], v78 offset:16384
    ds_read_b64_tr_b16 v[34:35], v78 offset:16896
    v_smfmac_f32_16x16x64_bf16 v[12:15], v[48:51], v[44:51], v52
    s_waitcnt lgkmcnt(4)
    v_mfma_f32_32x32x16_bf16 v[80:95], v[24:27], v[232:235], v[80:95]
    ds_read_b128 v[236:239], v67 offset:16384
    ds_read_b64_tr_b16 v[36:37], v71 offset:16384
    ds_read_b64_tr_b16 v[38:39], v71 offset:16896
    s_waitcnt lgkmcnt(5)
    v_mfma_f32_32x32x16_bf16 v[96:111], v[28:31], v[232:235], v[96:111]
    ds_read_b64_tr_b16 v[40:41], v75 offset:16384
    ds_read_b64_tr_b16 v[42:43], v75 offset:16896
    s_add_u32 m0, s56, 98304
    s_add_u32 s50, s50, 1
    buffer_load_dwordx4 v11, s[28:31], s49 offen lds
    s_and_b32 s50, s50, 7
    s_waitcnt lgkmcnt(5)
    v_mfma_f32_32x32x16_bf16 v[112:127], v[32:35], v[232:235], v[112:127]
    ds_read_b64_tr_b16 v[44:45], v79 offset:16384
    ds_read_b64_tr_b16 v[46:47], v79 offset:16896
    s_waitcnt vmcnt(5)
    s_waitcnt lgkmcnt(4)
    v_mfma_f32_32x32x16_bf16 v[80:95], v[36:39], v[236:239], v[80:95]
    s_barrier
    ds_read_b128 v[240:243], v64 offset:24576
    ds_read_b64_tr_b16 v[24:25], v68 offset:24576
    ds_read_b64_tr_b16 v[26:27], v68 offset:25088
    s_waitcnt lgkmcnt(5)
    v_mfma_f32_32x32x16_bf16 v[96:111], v[40:43], v[236:239], v[96:111]
    ds_read_b64_tr_b16 v[28:29], v72 offset:24576
    ds_read_b64_tr_b16 v[30:31], v72 offset:25088
    s_mul_i32 s49, s50, 229376
    s_add_u32 m0, s56, 8192
    s_add_u32 s49, s49, s60
    buffer_load_dwordx4 v10, s[24:27], s49 offen lds
    s_waitcnt lgkmcnt(5)
    v_mfma_f32_32x32x16_bf16 v[112:127], v[44:47], v[236:239], v[112:127]
    ds_read_b64_tr_b16 v[32:33], v76 offset:24576
    ds_read_b64_tr_b16 v[34:35], v76 offset:25088
    s_waitcnt vmcnt(4)
    v_cmp_ne_u32 vcc, s64, v59
    s_nop 1
    s_cbranch_vccz L_BACK_rec_QK3
    s_mov_b32 s3, 20000
L_SPIN_rec_QK3:
    s_sleep 1
    buffer_load_dwordx4 v[56:59], v60, s[32:35], 0 offen sc1
    s_waitcnt vmcnt(0)
    v_cmp_ne_u32 vcc, s64, v59
    s_nop 0
    s_sub_u32 s3, s3, 1
    s_cbranch_vccz L_BACK_rec_QK3
    s_cmp_lg_u32 s3, 0
    s_cbranch_scc1 L_SPIN_rec_QK3
L_BACK_rec_QK3:
    s_waitcnt lgkmcnt(4)
    v_mfma_f32_32x32x16_bf16 v[80:95], v[24:27], v[240:243], v[80:95]
    ds_read_b128 v[244:247], v65 offset:24576
    ds_read_b64_tr_b16 v[36:37], v69 offset:24576
    ds_read_b64_tr_b16 v[38:39], v69 offset:25088
    v_cmp_gt_u32 vcc, 32, v0
    v_mov_b32 v5, v57
    v_mov_b32 v8, v58
    v_cndmask_b32 v20, 0, v56, vcc
    v_cndmask_b32 v21, 0, v56, vcc
    v_cndmask_b32 v22, 0, v56, vcc
    v_cndmask_b32 v23, 0, v56, vcc
    s_waitcnt lgkmcnt(5)
    v_mfma_f32_32x32x16_bf16 v[96:111], v[28:31], v[240:243], v[96:111]
    ds_read_b64_tr_b16 v[40:41], v73 offset:24576
    ds_read_b64_tr_b16 v[42:43], v73 offset:25088
    s_add_u32 m0, s56, 40960
    s_add_u32 s50, s50, 1
    buffer_load_dwordx4 v11, s[28:31], s49 offen lds
    s_and_b32 s50, s50, 7
    v_mul_f32 v6, 0xc0135761, v5
    v_mul_f32 v7, v5, v5
    v_mul_f32 v7, v7, v6
    v_mul_f32 v7, 0x3d372713, v7
    s_waitcnt lgkmcnt(5)
    v_mfma_f32_32x32x16_bf16 v[112:127], v[32:35], v[240:243], v[112:127]
    ds_read_b64_tr_b16 v[44:45], v77 offset:24576
    ds_read_b64_tr_b16 v[46:47], v77 offset:25088
    v_smfmac_f32_16x16x64_bf16 v[12:15], v[16:19], v[24:31], v52
    s_waitcnt lgkmcnt(4)
    v_mfma_f32_32x32x16_bf16 v[80:95], v[36:39], v[244:247], v[80:95]
    ds_read_b128 v[248:251], v66 offset:24576
    ds_read_b64_tr_b16 v[24:25], v70 offset:24576
    ds_read_b64_tr_b16 v[26:27], v70 offset:25088
    s_waitcnt lgkmcnt(5)
    v_mfma_f32_32x32x16_bf16 v[96:111], v[40:43], v[244:247], v[96:111]
    ds_read_b64_tr_b16 v[28:29], v74 offset:24576
    ds_read_b64_tr_b16 v[30:31], v74 offset:25088
    s_mul_i32 s49, s50, 229376
    s_add_u32 m0, s56, 73728
    s_add_u32 s49, s49, s60
    buffer_load_dwordx4 v10, s[24:27], s49 offen lds
    s_waitcnt lgkmcnt(5)
    v_mfma_f32_32x32x16_bf16 v[112:127], v[44:47], v[244:247], v[112:127]
    ds_read_b64_tr_b16 v[32:33], v78 offset:24576
    ds_read_b64_tr_b16 v[34:35], v78 offset:25088
    v_smfmac_f32_16x16x64_bf16 v[12:15], v[48:51], v[44:51], v52
    s_waitcnt lgkmcnt(4)
    v_mfma_f32_32x32x16_bf16 v[80:95], v[24:27], v[248:251], v[80:95]
    ds_read_b128 v[252:255], v67 offset:24576
    ds_read_b64_tr_b16 v[36:37], v71 offset:24576
    ds_read_b64_tr_b16 v[38:39], v71 offset:25088
    s_nop 2
    v_add_f32 v12, v12, v13
    v_and_b32 v62, 0xffff0000, v12
    v_sub_f32 v63, v12, v62
    v_cvt_pk_bf16_f32 v12, v62, v63
    v_add_f32 v14, v14, v15
    v_and_b32 v62, 0xffff0000, v14
    v_sub_f32 v63, v14, v62
    v_cvt_pk_bf16_f32 v14, v62, v63
    s_waitcnt lgkmcnt(5)
    v_mfma_f32_32x32x16_bf16 v[96:111], v[28:31], v[248:251], v[96:111]
    ds_read_b64_tr_b16 v[40:41], v75 offset:24576
    ds_read_b64_tr_b16 v[42:43], v75 offset:25088
    s_add_u32 m0, s56, 106496
    s_add_u32 s50, s50, 1
    buffer_load_dwordx4 v11, s[28:31], s49 offen lds
    s_and_b32 s50, s50, 7
    s_mov_b32 exec_hi, 65535
    ds_write_b32 v61, v12 offset:0
    ds_write_b32 v61, v14 offset:256
    s_mov_b64 exec, -1
    s_waitcnt lgkmcnt(7)
    v_mfma_f32_32x32x16_bf16 v[112:127], v[32:35], v[248:251], v[112:127]
    ds_read_b64_tr_b16 v[44:45], v79 offset:24576
    ds_read_b64_tr_b16 v[46:47], v79 offset:25088
    v_add_u32 v28, 65536, v1
    v_add_u32 v29, 65536, v2
    v_add_u32 v30, 65536, v3
    v_add_u32 v31, 65536, v4
    s_waitcnt vmcnt(4)
    s_waitcnt lgkmcnt(2)
    v_mfma_f32_32x32x16_bf16 v[80:95], v[36:39], v[252:255], v[80:95]
    s_barrier
    ds_read_b128 v[68:71], v9 offset:0
    ds_read_b128 v[72:75], v9 offset:512
    ds_read_b128 v[76:79], v9 offset:1024
    v_mfma_f32_32x32x16_bf16 v[96:111], v[40:43], v[252:255], v[96:111]
    ds_read_b64_tr_b16 v[32:33], v1 offset:0
    ds_read_b64_tr_b16 v[34:35], v1 offset:512
    s_mul_i32 s49, s50, 229376
    s_add_u32 m0, s56, 16384
    s_add_u32 s49, s49, s60
    buffer_load_dwordx4 v10, s[24:27], s49 offen lds
    s_waitcnt lgkmcnt(5)
    v_mfma_f32_32x32x16_bf16 v[112:127], v[44:47], v[252:255], v[112:127]
    v_xor_b32 v24, 32, v1
    ds_read_b64_tr_b16 v[36:37], v24 offset:0
    ds_read_b64_tr_b16 v[38:39], v24 offset:512
    s_add_u32 m0, s56, 49152
    s_add_u32 s50, s50, 1
    buffer_load_dwordx4 v11, s[28:31], s49 offen lds
    s_and_b32 s50, s50, 7
    s_waitcnt lgkmcnt(4)
    v_mfma_f32_32x32x16_bf16 v[80:95], v[68:71], v[20:23], v[80:95]
    s_mul_i32 s49, s50, 229376
    s_add_u32 m0, s56, 81920
    s_add_u32 s49, s49, s60
    buffer_load_dwordx4 v10, s[24:27], s49 offen lds
    v_mfma_f32_32x32x16_bf16 v[96:111], v[72:75], v[20:23], v[96:111]
    s_add_u32 m0, s56, 114688
    s_add_u32 s50, s50, 1
    buffer_load_dwordx4 v11, s[28:31], s49 offen lds
    s_and_b32 s50, s50, 7
    v_mfma_f32_32x32x16_bf16 v[112:127], v[76:79], v[20:23], v[112:127]
    v_lshlrev_b32 v9, 4, v0
    s_waitcnt lgkmcnt(2)
    v_mfma_f32_32x32x16_bf16 v[48:63], v[32:35], v[128:131], 0
    ds_read_b64_tr_b16 v[40:41], v2 offset:0
    ds_read_b64_tr_b16 v[42:43], v2 offset:512
    s_cmp_ge_u32 s57, 1024
    s_cselect_b32 s71, 1.0, 0x3eb8aa3b
    v_mul_f32 v25, s71, v5
    v_mul_f32 v80, v25, v80
    v_mul_f32 v81, v25, v81
    v_cvt_pk_bf16_f32 v80, v80, v81
    v_mul_f32 v82, v25, v82
    v_mul_f32 v83, v25, v83
    v_cvt_pk_bf16_f32 v81, v82, v83
    s_waitcnt lgkmcnt(2)
    v_mfma_f32_32x32x16_bf16 v[64:79], v[36:39], v[128:131], 0
    v_xor_b32 v24, 32, v2
    ds_read_b64_tr_b16 v[44:45], v24 offset:0
    ds_read_b64_tr_b16 v[46:47], v24 offset:512
    v_and_b32 v26, 1, v0
    v_mul_u32_u24 v26, 0xaaaa, v26
    v_add_u32 v26, 0x4444, v26
    v_lshl_or_b32 v128, v26, 16, v26
    v_mov_b32 v12, 0
    v_mov_b32 v13, 0
    v_mov_b32 v14, 0
    v_mov_b32 v15, 0
    s_waitcnt lgkmcnt(2)
    v_mfma_f32_32x32x16_bf16 v[48:63], v[40:43], v[132:135], v[48:63]
    ds_read_b64_tr_b16 v[32:33], v3 offset:0
    ds_read_b64_tr_b16 v[34:35], v3 offset:512
    v_mul_f32 v84, v25, v84
    v_mul_f32 v85, v25, v85
    v_cvt_pk_bf16_f32 v82, v84, v85
    s_waitcnt lgkmcnt(2)
    v_mfma_f32_32x32x16_bf16 v[64:79], v[44:47], v[132:135], v[64:79]
    v_smfmac_f32_16x16x64_bf16 v[12:15], v[16:19], v[40:47], v128
    v_xor_b32 v24, 32, v3
    ds_read_b64_tr_b16 v[36:37], v24 offset:0
    ds_read_b64_tr_b16 v[38:39], v24 offset:512
    v_mul_f32 v86, v25, v86
    v_mul_f32 v87, v25, v87
    v_cvt_pk_bf16_f32 v83, v86, v87
    buffer_store_dwordx4 v[80:83], v9, s[32:35], s66 offen sc1
    v_mul_f32 v88, v25, v88
    v_mul_f32 v89, v25, v89
    v_cvt_pk_bf16_f32 v84, v88, v89
    s_waitcnt lgkmcnt(2)
    v_mfma_f32_32x32x16_bf16 v[48:63], v[32:35], v[136:139], v[48:63]
    ds_read_b64_tr_b16 v[40:41], v4 offset:0
    ds_read_b64_tr_b16 v[42:43], v4 offset:512
    v_mul_f32 v90, v25, v90
    v_mul_f32 v91, v25, v91
    v_cvt_pk_bf16_f32 v85, v90, v91
    v_mul_f32 v92, v25, v92
    v_mul_f32 v93, v25, v93
    v_cvt_pk_bf16_f32 v86, v92, v93
    s_waitcnt lgkmcnt(2)
    v_mfma_f32_32x32x16_bf16 v[64:79], v[36:39], v[136:139], v[64:79]
    v_xor_b32 v24, 32, v4
    ds_read_b64_tr_b16 v[44:45], v24 offset:0
    ds_read_b64_tr_b16 v[46:47], v24 offset:512
    v_mul_f32 v94, v25, v94
    v_mul_f32 v95, v25, v95
    v_cvt_pk_bf16_f32 v87, v94, v95
    s_waitcnt lgkmcnt(2)
    v_mfma_f32_32x32x16_bf16 v[48:63], v[40:43], v[140:143], v[48:63]
    ds_read_b64_tr_b16 v[32:33], v28 offset:0
    ds_read_b64_tr_b16 v[34:35], v28 offset:512
    buffer_store_dwordx4 v[84:87], v9, s[32:35], s67 offen sc1
    s_cmp_ge_u32 s58, 1024
    s_cselect_b32 s71, 1.0, 0x3eb8aa3b
    v_mul_f32 v25, s71, v5
    v_mul_f32 v96, v25, v96
    v_mul_f32 v97, v25, v97
    v_cvt_pk_bf16_f32 v96, v96, v97
    v_mul_f32 v98, v25, v98
    v_mul_f32 v99, v25, v99
    v_cvt_pk_bf16_f32 v97, v98, v99
    s_waitcnt lgkmcnt(2)
    v_mfma_f32_32x32x16_bf16 v[64:79], v[44:47], v[140:143], v[64:79]
    v_xor_b32 v24, 32, v28
    ds_read_b64_tr_b16 v[36:37], v24 offset:0
    ds_read_b64_tr_b16 v[38:39], v24 offset:512
    v_mul_f32 v100, v25, v100
    v_mul_f32 v101, v25, v101
    v_cvt_pk_bf16_f32 v98, v100, v101
    v_mul_f32 v102, v25, v102
    v_mul_f32 v103, v25, v103
    v_cvt_pk_bf16_f32 v99, v102, v103
    s_waitcnt lgkmcnt(2)
    v_mfma_f32_32x32x16_bf16 v[48:63], v[32:35], v[144:147], v[48:63]
    ds_read_b64_tr_b16 v[40:41], v29 offset:0
    ds_read_b64_tr_b16 v[42:43], v29 offset:512
    buffer_store_dwordx4 v[96:99], v9, s[32:35], s80 offen sc1
    v_mul_f32 v104, v25, v104
    v_mul_f32 v105, v25, v105
    v_cvt_pk_bf16_f32 v100, v104, v105
    v_mul_f32 v106, v25, v106
    v_mul_f32 v107, v25, v107
    v_cvt_pk_bf16_f32 v101, v106, v107
    s_waitcnt lgkmcnt(2)
    v_mfma_f32_32x32x16_bf16 v[64:79], v[36:39], v[144:147], v[64:79]
    v_xor_b32 v24, 32, v29
    ds_read_b64_tr_b16 v[44:45], v24 offset:0
    ds_read_b64_tr_b16 v[46:47], v24 offset:512
    v_mul_f32 v108, v25, v108
    v_mul_f32 v109, v25, v109
    v_cvt_pk_bf16_f32 v102, v108, v109
    s_waitcnt lgkmcnt(2)
    v_mfma_f32_32x32x16_bf16 v[48:63], v[40:43], v[148:151], v[48:63]
    ds_read_b64_tr_b16 v[32:33], v30 offset:0
    ds_read_b64_tr_b16 v[34:35], v30 offset:512
    v_mul_f32 v110, v25, v110
    v_mul_f32 v111, v25, v111
    v_cvt_pk_bf16_f32 v103, v110, v111
    buffer_store_dwordx4 v[100:103], v9, s[32:35], s81 offen sc1
    s_cmp_ge_u32 s59, 1024
    s_cselect_b32 s71, 1.0, 0x3eb8aa3b
    v_mul_f32 v25, s71, v5
    v_mul_f32 v112, v25, v112
    v_mul_f32 v113, v25, v113
    v_cvt_pk_bf16_f32 v112, v112, v113
    s_waitcnt lgkmcnt(2)
    v_mfma_f32_32x32x16_bf16 v[64:79], v[44:47], v[148:151], v[64:79]
    v_smfmac_f32_16x16x64_bf16 v[12:15], v[16:19], v[40:47], v128
    v_xor_b32 v24, 32, v30
    ds_read_b64_tr_b16 v[36:37], v24 offset:0
    ds_read_b64_tr_b16 v[38:39], v24 offset:512
    v_mul_f32 v114, v25, v114
    v_mul_f32 v115, v25, v115
    v_cvt_pk_bf16_f32 v113, v114, v115
    v_mul_f32 v116, v25, v116
    v_mul_f32 v117, v25, v117
    v_cvt_pk_bf16_f32 v114, v116, v117
    s_waitcnt lgkmcnt(2)
    v_mfma_f32_32x32x16_bf16 v[48:63], v[32:35], v[152:155], v[48:63]
    ds_read_b64_tr_b16 v[40:41], v31 offset:0
    ds_read_b64_tr_b16 v[42:43], v31 offset:512
    v_mul_f32 v118, v25, v118
    v_mul_f32 v119, v25, v119
    v_cvt_pk_bf16_f32 v115, v118, v119
    buffer_store_dwordx4 v[112:115], v9, s[32:35], s82 offen sc1
    v_mul_f32 v120, v25, v120
    v_mul_f32 v121, v25, v121
    v_cvt_pk_bf16_f32 v116, v120, v121
    s_waitcnt lgkmcnt(2)
    v_mfma_f32_32x32x16_bf16 v[64:79], v[36:39], v[152:155], v[64:79]
    v_xor_b32 v24, 32, v31
    ds_read_b64_tr_b16 v[44:45], v24 offset:0
    ds_read_b64_tr_b16 v[46:47], v24 offset:512
    v_mul_f32 v122, v25, v122
    v_mul_f32 v123, v25, v123
    v_cvt_pk_bf16_f32 v117, v122, v123
    s_waitcnt vmcnt(9)
    s_waitcnt lgkmcnt(2)
    v_mfma_f32_32x32x16_bf16 v[48:63], v[40:43], v[156:159], v[48:63]
    s_barrier
    ds_read_b64_tr_b16 v[32:33], v1 offset:8192
    ds_read_b64_tr_b16 v[34:35], v1 offset:8704
    v_mul_f32 v124, v25, v124
    v_mul_f32 v125, v25, v125
    v_cvt_pk_bf16_f32 v118, v124, v125
    v_mul_f32 v126, v25, v126
    v_mul_f32 v127, v25, v127
    v_cvt_pk_bf16_f32 v119, v126, v127
    s_waitcnt lgkmcnt(2)
    v_mfma_f32_32x32x16_bf16 v[64:79], v[44:47], v[156:159], v[64:79]
    v_xor_b32 v24, 32, v1
    ds_read_b64_tr_b16 v[36:37], v24 offset:8192
    ds_read_b64_tr_b16 v[38:39], v24 offset:8704
    s_mul_i32 s49, s50, 229376
    s_add_u32 m0, s56, 24576
    s_add_u32 s49, s49, s60
    buffer_load_dwordx4 v10, s[24:27], s49 offen lds
    s_add_u32 m0, s56, 57344
    s_add_u32 s50, s50, 1
    buffer_load_dwordx4 v11, s[28:31], s49 offen lds
    s_and_b32 s50, s50, 7
    s_mul_i32 s49, s50, 229376
    s_add_u32 m0, s56, 90112
    s_add_u32 s49, s49, s60
    buffer_load_dwordx4 v10, s[24:27], s49 offen lds
    s_add_u32 m0, s56, 122880
    s_add_u32 s50, s50, 1
    buffer_load_dwordx4 v11, s[28:31], s49 offen lds
    s_and_b32 s50, s50, 7
    s_waitcnt lgkmcnt(2)
    v_mfma_f32_32x32x16_bf16 v[48:63], v[32:35], v[160:163], v[48:63]
    ds_read_b64_tr_b16 v[40:41], v2 offset:8192
    ds_read_b64_tr_b16 v[42:43], v2 offset:8704
    buffer_store_dwordx4 v[116:119], v9, s[32:35], s83 offen sc1
    s_mov_b32 s12, s68
    s_and_b32 s13, s69, 0xffff
    s_mov_b32 s14, 524288
    s_mov_b32 s15, 0x20000
    s_waitcnt lgkmcnt(2)
    v_mfma_f32_32x32x16_bf16 v[64:79], v[36:39], v[160:163], v[64:79]
    v_xor_b32 v24, 32, v2
    ds_read_b64_tr_b16 v[44:45], v24 offset:8192
    ds_read_b64_tr_b16 v[46:47], v24 offset:8704
    s_mov_b32 s16, s76
    s_and_b32 s17, s77, 0xffff
    s_mov_b32 s18, 1835008
    s_mov_b32 s19, 0x20000
    s_mov_b32 s20, s78
    s_and_b32 s21, s79, 0xffff
    s_mov_b32 s22, 2097152
    s_mov_b32 s23, 0x20000
    s_waitcnt lgkmcnt(2)
    v_mfma_f32_32x32x16_bf16 v[48:63], v[40:43], v[164:167], v[48:63]
    ds_read_b64_tr_b16 v[32:33], v3 offset:8192
    ds_read_b64_tr_b16 v[34:35], v3 offset:8704
    s_lshl_b32 s48, s62, 17
    s_add_u32 s48, s48, 2097152
    s_add_u32 s48, s48, s56
    s_lshl_b32 s51, s63, 14
    s_lshr_b32 s0, s62, 2
    s_add_u32 s1, s0, 4
    s_mul_i32 s1, s1, 43
    s_lshr_b32 s1, s1, 7
    s_add_u32 s1, s1, 12
    s_sub_u32 s6, s0, 4
    s_mul_i32 s6, s6, 43
    s_lshr_b32 s6, s6, 7
    s_add_u32 s6, s6, 12
    s_waitcnt lgkmcnt(2)
    v_mfma_f32_32x32x16_bf16 v[64:79], v[44:47], v[164:167], v[64:79]
    v_smfmac_f32_16x16x64_bf16 v[12:15], v[16:19], v[40:47], v128
    v_xor_b32 v24, 32, v3
    ds_read_b64_tr_b16 v[36:37], v24 offset:8192
    ds_read_b64_tr_b16 v[38:39], v24 offset:8704
    s_add_u32 s7, s0, 8
    s_cmp_lt_u32 s0, 4
    s_cselect_b32 s6, s7, s6
    s_lshl_b32 s1, s1, 4
    s_lshl_b32 s0, s0, 4
    s_sub_u32 s0, s0, 16
    s_lshl_b32 s6, s6, 4
    s_lshl_b32 s7, s63, 1
    s_add_u32 s6, s6, s7
    s_waitcnt lgkmcnt(2)
    v_mfma_f32_32x32x16_bf16 v[48:63], v[32:35], v[168:171], v[48:63]
    ds_read_b64_tr_b16 v[40:41], v4 offset:8192
    ds_read_b64_tr_b16 v[42:43], v4 offset:8704
    s_sub_u32 s6, s6, 32
    v_mov_b32 v154, s1
    v_cmp_le_u32 vcc, 16, v0
    v_mov_b32 v27, s0
    s_nop 0
    v_cndmask_b32 v154, v154, v27, vcc
    v_cmp_le_u32 vcc, 32, v0
    v_mov_b32 v27, s6
    s_nop 0
    v_cndmask_b32 v154, v154, v27, vcc
    s_waitcnt lgkmcnt(2)
    v_mfma_f32_32x32x16_bf16 v[64:79], v[36:39], v[168:171], v[64:79]
    v_xor_b32 v24, 32, v4
    ds_read_b64_tr_b16 v[44:45], v24 offset:8192
    ds_read_b64_tr_b16 v[46:47], v24 offset:8704
    v_min_u32 v27, 33, v0
    v_add_u32 v154, v154, v27
    v_lshlrev_b32 v154, 7, v154
    v_add_u32 v154, 23068672, v154
    v_and_b32 v150, 15, v0
    v_lshlrev_b32 v150, 4, v150
    v_lshrrev_b32 v151, 4, v0
    s_waitcnt lgkmcnt(2)
    v_mfma_f32_32x32x16_bf16 v[48:63], v[40:43], v[172:175], v[48:63]
    ds_read_b64_tr_b16 v[32:33], v28 offset:8192
    ds_read_b64_tr_b16 v[34:35], v28 offset:8704
    v_lshl_add_u32 v150, v151, 9, v150
    s_mul_i32 s71, s44, 1024
    s_lshl_b32 s0, s43, 2
    s_add_u32 s71, s71, s0
    s_add_u32 s71, s71, 136192
    v_add_u32 v150, s71, v150
    v_and_b32 v151, 31, v0
    s_lshl_b32 s71, s44, 10
    s_add_u32 s71, s71, 136192
    v_lshl_add_u32 v151, v151, 4, s71
    s_waitcnt lgkmcnt(2)
    v_mfma_f32_32x32x16_bf16 v[64:79], v[44:47], v[172:175], v[64:79]
    v_xor_b32 v24, 32, v28
    ds_read_b64_tr_b16 v[36:37], v24 offset:8192
    ds_read_b64_tr_b16 v[38:39], v24 offset:8704
    s_mul_i32 s71, s47, 144
    s_add_u32 s71, s71, s62
    s_lshl_b32 s71, s71, 10
    s_add_u32 s58, s71, 6291456
    s_lshl_b32 s57, s54, 1
    s_and_b32 s71, s42, 1
    s_add_u32 s57, s57, s71
    s_lshl_b32 s57, s57, 15
    s_lshl_b32 s71, s55, 7
    s_add_u32 s57, s57, s71
    s_lshr_b32 s71, s42, 1
    s_lshl_b32 s71, s71, 5
    s_waitcnt lgkmcnt(2)
    v_mfma_f32_32x32x16_bf16 v[48:63], v[32:35], v[176:179], v[48:63]
    ds_read_b64_tr_b16 v[40:41], v29 offset:8192
    ds_read_b64_tr_b16 v[42:43], v29 offset:8704
    s_add_u32 s57, s57, s71
    v_mov_b32 v104, v0
    v_mov_b32 v105, v9
    v_mov_b32 v116, v9
    v_add_u32 v117, 65536, v9
    v_add_u32 v118, 131072, v9
    v_lshrrev_b32 v96, 5, v0
    v_and_b32 v97, 15, v0
    v_lshlrev_b32 v97, 4, v97
    v_lshl_add_u32 v119, v96, 8, v97
    s_waitcnt lgkmcnt(2)
    v_mfma_f32_32x32x16_bf16 v[64:79], v[36:39], v[176:179], v[64:79]
    v_xor_b32 v24, 32, v29
    ds_read_b64_tr_b16 v[44:45], v24 offset:8192
    ds_read_b64_tr_b16 v[46:47], v24 offset:8704
    v_add_u32 v120, 65536, v119
    v_add_u32 v121, 131072, v119
    v_and_b32 v97, 31, v0
    s_waitcnt lgkmcnt(2)
    v_mfma_f32_32x32x16_bf16 v[48:63], v[40:43], v[180:183], v[48:63]
    ds_read_b64_tr_b16 v[32:33], v30 offset:8192
    ds_read_b64_tr_b16 v[34:35], v30 offset:8704
    v_lshlrev_b32 v97, 10, v97
    v_lshl_add_u32 v125, v96, 4, v97
    v_lshrrev_b32 v97, 3, v0
    v_bfe_u32 v98, v0, 4, 1
    v_lshlrev_b32 v98, 2, v98
    v_and_b32 v122, 7, v0
    s_waitcnt lgkmcnt(2)
    v_mfma_f32_32x32x16_bf16 v[64:79], v[44:47], v[180:183], v[64:79]
    v_smfmac_f32_16x16x64_bf16 v[12:15], v[16:19], v[40:47], v128
    v_xor_b32 v24, 32, v30
    ds_read_b64_tr_b16 v[36:37], v24 offset:8192
    ds_read_b64_tr_b16 v[38:39], v24 offset:8704
    s_waitcnt vmcnt(0)
    s_barrier
    s_lshl_b32 s3, s46, 4
    s_add_u32 s3, s3, s45
    s_lshl_b32 s3, s3, 7
    s_add_u32 s3, s3, 23068672
    s_cmp_eq_u32 s42, 0
    s_cselect_b32 s3, s3, 0x7fffff00
    v_mov_b32 v152, s64
    v_lshlrev_b32 v153, 2, v0
    s_mov_b32 exec_hi, 0
    buffer_store_dword v152, v153, s[32:35], s3 offen sc1
    s_mov_b64 exec, -1
    s_waitcnt lgkmcnt(2)
    v_mfma_f32_32x32x16_bf16 v[48:63], v[32:35], v[184:187], v[48:63]
    ds_read_b64_tr_b16 v[40:41], v31 offset:8192
    ds_read_b64_tr_b16 v[42:43], v31 offset:8704
    v_xor_b32 v98, v98, v122
    v_lshlrev_b32 v98, 4, v98
    v_lshl_add_u32 v122, v97, 10, v98
    v_bfe_u32 v97, v0, 2, 2
    v_lshl_add_u32 v96, v96, 2, v97
    v_lshlrev_b32 v96, 7, v96
    v_and_b32 v97, 3, v0
    v_lshl_add_u32 v96, v97, 3, v96
    v_bfe_u32 v97, v0, 3, 1
    s_waitcnt lgkmcnt(2)
    v_mfma_f32_32x32x16_bf16 v[64:79], v[36:39], v[184:187], v[64:79]
    v_xor_b32 v24, 32, v31
    ds_read_b64_tr_b16 v[44:45], v24 offset:8192
    ds_read_b64_tr_b16 v[46:47], v24 offset:8704
    v_lshlrev_b32 v97, 1, v97
    v_bfe_u32 v98, v0, 4, 1
    v_xor_b32 v97, v97, v98
    s_waitcnt vmcnt(1)
    s_waitcnt lgkmcnt(2)
    v_mfma_f32_32x32x16_bf16 v[48:63], v[40:43], v[188:191], v[48:63]
    s_barrier
    ds_read_b64_tr_b16 v[32:33], v1 offset:16384
    ds_read_b64_tr_b16 v[34:35], v1 offset:16896
    v_lshl_add_u32 v96, v97, 5, v96
    s_lshl_b32 s53, s42, 12
    s_add_u32 s53, s53, 106496
    v_add_u32 v123, s53, v96
    v_xor_b32 v124, 64, v123
    v_add_u32 v96, 16, v0
    v_and_b32 v96, 31, v96
    v_lshrrev_b32 v97, 2, v96
    v_and_b32 v96, 3, v96
    s_waitcnt lgkmcnt(2)
    v_mfma_f32_32x32x16_bf16 v[64:79], v[44:47], v[188:191], v[64:79]
    v_xor_b32 v24, 32, v1
    ds_read_b64_tr_b16 v[36:37], v24 offset:16384
    ds_read_b64_tr_b16 v[38:39], v24 offset:16896
    s_and_b32 s71, s63, 1
    s_lshl_b32 s71, s71, 2
    v_add_u32 v96, s71, v96
    v_and_b32 v98, 1, v97
    v_lshl_add_u32 v96, v98, 3, v96
    v_lshrrev_b32 v97, 1, v97
    s_waitcnt lgkmcnt(2)
    v_mfma_f32_32x32x16_bf16 v[48:63], v[32:35], v[192:195], v[48:63]
    ds_read_b64_tr_b16 v[40:41], v2 offset:16384
    ds_read_b64_tr_b16 v[42:43], v2 offset:16896
    v_lshl_add_u32 v96, v96, 4, v97
    s_lshr_b32 s71, s63, 1
    s_lshl_b32 s71, s71, 2
    v_add_u32 v96, s71, v96
    s_lshr_b32 s71, s54, 1
    s_lshl_b32 s71, s71, 4
    v_add_u32 v97, s71, v0
    v_cmp_gt_u32 vcc, 16, v0
    s_nop 1
    v_cndmask_b32 v96, v96, v97, vcc
    v_lshlrev_b32 v96, 7, v96
    v_add_u32 v126, 23101440, v96
    s_lshr_b32 s71, s42, 1
    s_waitcnt lgkmcnt(2)
    v_mfma_f32_32x32x16_bf16 v[64:79], v[36:39], v[192:195], v[64:79]
    v_xor_b32 v24, 32, v2
    ds_read_b64_tr_b16 v[44:45], v24 offset:16384
    ds_read_b64_tr_b16 v[46:47], v24 offset:16896
    s_lshl_b32 s71, s71, 14
    s_sub_u32 s71, s71, s53
    v_add_u32 v102, s71, v123
    v_xor_b32 v103, 64, v102
    s_lshl_b32 s71, s55, 7
    s_mul_i32 s50, s42, 229376
    s_add_u32 s50, s50, s71
    s_lshl_b32 s59, s42, 16
    s_add_u32 s59, s59, s71
    s_mul_i32 s71, s54, 288
    s_mul_i32 s52, s42, 14
    s_add_u32 s52, s52, s71
    s_waitcnt lgkmcnt(2)
    v_mfma_f32_32x32x16_bf16 v[48:63], v[40:43], v[196:199], v[48:63]
    ds_read_b64_tr_b16 v[32:33], v3 offset:16384
    ds_read_b64_tr_b16 v[34:35], v3 offset:16896
    s_lshl_b32 s52, s52, 10
    s_add_u32 s52, s52, 6324224
    s_waitcnt lgkmcnt(2)
    v_mfma_f32_32x32x16_bf16 v[64:79], v[44:47], v[196:199], v[64:79]
    v_smfmac_f32_16x16x64_bf16 v[12:15], v[16:19], v[40:47], v128
    v_xor_b32 v24, 32, v3
    ds_read_b64_tr_b16 v[36:37], v24 offset:16384
    ds_read_b64_tr_b16 v[38:39], v24 offset:16896
    s_waitcnt lgkmcnt(2)
    v_mfma_f32_32x32x16_bf16 v[48:63], v[32:35], v[200:203], v[48:63]
    ds_read_b64_tr_b16 v[40:41], v4 offset:16384
    ds_read_b64_tr_b16 v[42:43], v4 offset:16896
    s_waitcnt lgkmcnt(2)
    v_mfma_f32_32x32x16_bf16 v[64:79], v[36:39], v[200:203], v[64:79]
    v_xor_b32 v24, 32, v4
    ds_read_b64_tr_b16 v[44:45], v24 offset:16384
    ds_read_b64_tr_b16 v[46:47], v24 offset:16896
    s_waitcnt lgkmcnt(2)
    v_mfma_f32_32x32x16_bf16 v[48:63], v[40:43], v[204:207], v[48:63]
    ds_read_b64_tr_b16 v[32:33], v28 offset:16384
    ds_read_b64_tr_b16 v[34:35], v28 offset:16896
    s_waitcnt lgkmcnt(2)
    v_mfma_f32_32x32x16_bf16 v[64:79], v[44:47], v[204:207], v[64:79]
    v_xor_b32 v24, 32, v28
    ds_read_b64_tr_b16 v[36:37], v24 offset:16384
    ds_read_b64_tr_b16 v[38:39], v24 offset:16896
    s_waitcnt lgkmcnt(2)
    v_mfma_f32_32x32x16_bf16 v[48:63], v[32:35], v[208:211], v[48:63]
    ds_read_b64_tr_b16 v[40:41], v29 offset:16384
    ds_read_b64_tr_b16 v[42:43], v29 offset:16896
    s_waitcnt lgkmcnt(2)
    v_mfma_f32_32x32x16_bf16 v[64:79], v[36:39], v[208:211], v[64:79]
    v_xor_b32 v24, 32, v29
    ds_read_b64_tr_b16 v[44:45], v24 offset:16384
    ds_read_b64_tr_b16 v[46:47], v24 offset:16896
    s_waitcnt lgkmcnt(2)
    v_mfma_f32_32x32x16_bf16 v[48:63], v[40:43], v[212:215], v[48:63]
    ds_read_b64_tr_b16 v[32:33], v30 offset:16384
    ds_read_b64_tr_b16 v[34:35], v30 offset:16896
    s_waitcnt lgkmcnt(2)
    v_mfma_f32_32x32x16_bf16 v[64:79], v[44:47], v[212:215], v[64:79]
    v_smfmac_f32_16x16x64_bf16 v[12:15], v[16:19], v[40:47], v128
    v_xor_b32 v24, 32, v30
    ds_read_b64_tr_b16 v[36:37], v24 offset:16384
    ds_read_b64_tr_b16 v[38:39], v24 offset:16896
    s_waitcnt lgkmcnt(2)
    v_mfma_f32_32x32x16_bf16 v[48:63], v[32:35], v[216:219], v[48:63]
    ds_read_b64_tr_b16 v[40:41], v31 offset:16384
    ds_read_b64_tr_b16 v[42:43], v31 offset:16896
    s_waitcnt lgkmcnt(2)
    v_mfma_f32_32x32x16_bf16 v[64:79], v[36:39], v[216:219], v[64:79]
    v_xor_b32 v24, 32, v31
    ds_read_b64_tr_b16 v[44:45], v24 offset:16384
    ds_read_b64_tr_b16 v[46:47], v24 offset:16896
    s_waitcnt vmcnt(1)
    s_waitcnt lgkmcnt(2)
    v_mfma_f32_32x32x16_bf16 v[48:63], v[40:43], v[220:223], v[48:63]
    s_barrier
    ds_read_b64_tr_b16 v[32:33], v1 offset:24576
    ds_read_b64_tr_b16 v[34:35], v1 offset:25088
    s_waitcnt lgkmcnt(2)
    v_mfma_f32_32x32x16_bf16 v[64:79], v[44:47], v[220:223], v[64:79]
    v_xor_b32 v24, 32, v1
    ds_read_b64_tr_b16 v[36:37], v24 offset:24576
    ds_read_b64_tr_b16 v[38:39], v24 offset:25088
    buffer_load_dword v155, v154, s[32:35], s70 offen sc1
    s_waitcnt lgkmcnt(2)
    v_mfma_f32_32x32x16_bf16 v[48:63], v[32:35], v[224:227], v[48:63]
    ds_read_b64_tr_b16 v[40:41], v2 offset:24576
    ds_read_b64_tr_b16 v[42:43], v2 offset:25088
    s_waitcnt lgkmcnt(2)
    v_mfma_f32_32x32x16_bf16 v[64:79], v[36:39], v[224:227], v[64:79]
    v_xor_b32 v24, 32, v2
    ds_read_b64_tr_b16 v[44:45], v24 offset:24576
    ds_read_b64_tr_b16 v[46:47], v24 offset:25088
    s_waitcnt lgkmcnt(2)
    v_mfma_f32_32x32x16_bf16 v[48:63], v[40:43], v[228:231], v[48:63]
    ds_read_b64_tr_b16 v[32:33], v3 offset:24576
    ds_read_b64_tr_b16 v[34:35], v3 offset:25088
    s_waitcnt lgkmcnt(2)
    v_mfma_f32_32x32x16_bf16 v[64:79], v[44:47], v[228:231], v[64:79]
    v_smfmac_f32_16x16x64_bf16 v[12:15], v[16:19], v[40:47], v128
    v_xor_b32 v24, 32, v3
    ds_read_b64_tr_b16 v[36:37], v24 offset:24576
    ds_read_b64_tr_b16 v[38:39], v24 offset:25088
    s_waitcnt lgkmcnt(2)
    v_mfma_f32_32x32x16_bf16 v[48:63], v[32:35], v[232:235], v[48:63]
    ds_read_b64_tr_b16 v[40:41], v4 offset:24576
    ds_read_b64_tr_b16 v[42:43], v4 offset:25088
    s_waitcnt lgkmcnt(2)
    v_mfma_f32_32x32x16_bf16 v[64:79], v[36:39], v[232:235], v[64:79]
    v_xor_b32 v24, 32, v4
    ds_read_b64_tr_b16 v[44:45], v24 offset:24576
    ds_read_b64_tr_b16 v[46:47], v24 offset:25088
    s_waitcnt lgkmcnt(2)
    v_mfma_f32_32x32x16_bf16 v[48:63], v[40:43], v[236:239], v[48:63]
    ds_read_b64_tr_b16 v[32:33], v28 offset:24576
    ds_read_b64_tr_b16 v[34:35], v28 offset:25088
    s_waitcnt lgkmcnt(2)
    v_mfma_f32_32x32x16_bf16 v[64:79], v[44:47], v[236:239], v[64:79]
    v_xor_b32 v24, 32, v28
    ds_read_b64_tr_b16 v[36:37], v24 offset:24576
    ds_read_b64_tr_b16 v[38:39], v24 offset:25088
    s_waitcnt lgkmcnt(2)
    v_mfma_f32_32x32x16_bf16 v[48:63], v[32:35], v[240:243], v[48:63]
    ds_read_b64_tr_b16 v[40:41], v29 offset:24576
    ds_read_b64_tr_b16 v[42:43], v29 offset:25088
    s_waitcnt lgkmcnt(2)
    v_mfma_f32_32x32x16_bf16 v[64:79], v[36:39], v[240:243], v[64:79]
    v_smfmac_f32_16x16x64_bf16 v[12:15], v[16:19], v[32:39], v128
    v_xor_b32 v24, 32, v29
    ds_read_b64_tr_b16 v[44:45], v24 offset:24576
    ds_read_b64_tr_b16 v[46:47], v24 offset:25088
    buffer_load_dword v164, v154, s[32:35], s70 offen sc1
    s_waitcnt lgkmcnt(2)
    v_mfma_f32_32x32x16_bf16 v[48:63], v[40:43], v[244:247], v[48:63]
    ds_read_b64_tr_b16 v[32:33], v30 offset:24576
    ds_read_b64_tr_b16 v[34:35], v30 offset:25088
    s_waitcnt lgkmcnt(2)
    v_mfma_f32_32x32x16_bf16 v[64:79], v[44:47], v[244:247], v[64:79]
    v_xor_b32 v24, 32, v30
    ds_read_b64_tr_b16 v[36:37], v24 offset:24576
    ds_read_b64_tr_b16 v[38:39], v24 offset:25088
    v_add_f32 v12, v12, v13
    v_and_b32 v26, 0xffff0000, v12
    v_sub_f32 v27, v12, v26
    v_cvt_pk_bf16_f32 v12, v26, v27
    v_add_f32 v14, v14, v15
    v_and_b32 v26, 0xffff0000, v14
    v_sub_f32 v27, v14, v26
    v_cvt_pk_bf16_f32 v14, v26, v27
    s_mov_b32 exec_hi, 0
    ds_write_b32 v150, v12 offset:0
    ds_write_b32 v150, v14 offset:256
    s_mov_b64 exec, -1
    s_waitcnt lgkmcnt(4)
    v_mfma_f32_32x32x16_bf16 v[48:63], v[32:35], v[248:251], v[48:63]
    ds_read_b64_tr_b16 v[40:41], v31 offset:24576
    ds_read_b64_tr_b16 v[42:43], v31 offset:25088
    s_waitcnt lgkmcnt(4)
    v_mfma_f32_32x32x16_bf16 v[64:79], v[36:39], v[248:251], v[64:79]
    v_xor_b32 v24, 32, v31
    ds_read_b64_tr_b16 v[44:45], v24 offset:24576
    ds_read_b64_tr_b16 v[46:47], v24 offset:25088
    s_waitcnt lgkmcnt(4)
    s_barrier
    ds_read_b128 v[156:159], v151 offset:0
    ds_read_b128 v[160:163], v151 offset:512
    s_waitcnt lgkmcnt(4)
    v_mfma_f32_32x32x16_bf16 v[48:63], v[40:43], v[252:255], v[48:63]
    s_waitcnt lgkmcnt(2)
    v_mfma_f32_32x32x16_bf16 v[64:79], v[44:47], v[252:255], v[64:79]
    s_waitcnt vmcnt(1)
    v_cmp_ne_u32 vcc, s64, v155
    s_cmp_eq_u32 s70, 0
    s_cselect_b64 vcc, vcc, 0
    s_cbranch_vccz L_BACK_pfa_QK32
    s_waitcnt vmcnt(0)
    v_cmp_ne_u32 vcc, s64, v164
    s_nop 1
    s_cbranch_vccz L_BACK_pfa_QK32
    s_mov_b32 s3, 20000
L_SPIN_pfa_QK32:
    s_sleep 1
    buffer_load_dword v155, v154, s[32:35], s70 offen sc1
    s_waitcnt vmcnt(0)
    v_cmp_ne_u32 vcc, s64, v155
    s_nop 0
    s_sub_u32 s3, s3, 1
    s_cbranch_vccz L_BACK_pfa_QK32
    s_cmp_lg_u32 s3, 0
    s_cbranch_scc1 L_SPIN_pfa_QK32
L_BACK_pfa_QK32:
    s_barrier
    s_lshl_b32 s3, s62, 6
    s_add_u32 s3, s3, s47
    s_lshl_b32 s3, s3, 10
    buffer_load_dwordx4 v[108:111], v9, s[32:35], s3 offen sc1
    s_add_u32 s49, s51, 0
    s_and_b32 s49, s49, 0x1ffff
    s_add_u32 m0, s56, 139264
    s_add_u32 s49, s49, s48
    buffer_load_dwordx4 v9, s[32:35], s49 offen sc1 lds
    s_add_u32 s49, s51, 8192
    s_and_b32 s49, s49, 0x1ffff
    s_add_u32 m0, s56, 147456
    s_add_u32 s49, s49, s48
    buffer_load_dwordx4 v9, s[32:35], s49 offen sc1 lds
    s_add_u32 s49, s51, 16384
    s_and_b32 s49, s49, 0x1ffff
    s_add_u32 m0, s56, 155648
    s_add_u32 s49, s49, s48
    buffer_load_dwordx4 v9, s[32:35], s49 offen sc1 lds
    s_waitcnt lgkmcnt(0)
    v_mfma_f32_32x32x16_bf16 v[48:63], v[156:159], v[20:23], v[48:63]
    v_mfma_f32_32x32x16_bf16 v[64:79], v[160:163], v[20:23], v[64:79]
    v_and_b32 v96, 27, v0
    v_cmp_eq_u32 vcc, 16, v96
    v_mov_b32 v97, 0x3f803f80
    s_nop 0
    v_cndmask_b32 v16, 0, v97, vcc
    v_cndmask_b32 v17, 0, v97, vcc
    v_cndmask_b32 v18, 0, v97, vcc
    v_cndmask_b32 v19, 0, v97, vcc
    v_cndmask_b32 v20, 0, v97, vcc
    v_cndmask_b32 v21, 0, v97, vcc
    v_cndmask_b32 v22, 0, v97, vcc
    v_cndmask_b32 v23, 0, v97, vcc
    v_cndmask_b32 v24, 0, v97, vcc
    v_cndmask_b32 v25, 0, v97, vcc
    v_cndmask_b32 v26, 0, v97, vcc
    v_cndmask_b32 v27, 0, v97, vcc
    v_cndmask_b32 v28, 0, v97, vcc
    v_cndmask_b32 v29, 0, v97, vcc
    v_cndmask_b32 v30, 0, v97, vcc
    v_cndmask_b32 v31, 0, v97, vcc
    s_and_b32 s3, s62, 3
    s_mul_i32 s3, s3, 3
    s_lshl_b32 s6, s63, 1
    s_add_u32 s6, s6, s3
    s_sub_u32 s3, s6, 14
    s_cmp_ge_u32 s6, 14
    s_cselect_b32 s60, s3, s6
    v_mov_b32 v184, v6
    v_mov_b32 v186, v7
    v_mov_b32 v188, v8
    v_pk_mul_f32 v[168:169], v[48:49], v[48:49]
    v_pk_mul_f32 v[170:171], v[50:51], v[50:51]
    v_pk_mul_f32 v[172:173], v[52:53], v[52:53]
    v_pk_mul_f32 v[174:175], v[54:55], v[54:55]
    v_pk_fma_f32 v[168:169], v[168:169], v[186:187], v[184:185] op_sel_hi:[1,0,0]
    v_pk_fma_f32 v[170:171], v[170:171], v[186:187], v[184:185] op_sel_hi:[1,0,0]
    v_pk_fma_f32 v[172:173], v[172:173], v[186:187], v[184:185] op_sel_hi:[1,0,0]
    v_pk_fma_f32 v[174:175], v[174:175], v[186:187], v[184:185] op_sel_hi:[1,0,0]
    v_pk_mul_f32 v[168:169], v[168:169], v[48:49]
    v_pk_mul_f32 v[170:171], v[170:171], v[50:51]
    v_pk_mul_f32 v[172:173], v[172:173], v[52:53]
    v_pk_mul_f32 v[174:175], v[174:175], v[54:55]
    v_exp_f32 v168, v168
    v_exp_f32 v169, v169
    v_exp_f32 v170, v170
    v_exp_f32 v171, v171
    v_exp_f32 v172, v172
    v_exp_f32 v173, v173
    v_exp_f32 v174, v174
    v_exp_f32 v175, v175
    v_pk_mul_f32 v[48:49], v[48:49], v[56:57]
    v_pk_mul_f32 v[50:51], v[50:51], v[58:59]
    v_pk_mul_f32 v[52:53], v[52:53], v[60:61]
    v_pk_mul_f32 v[54:55], v[54:55], v[62:63]
    v_pk_fma_f32 v[168:169], v[168:169], v[188:189], v[188:189] op_sel_hi:[1,0,0]
    v_pk_fma_f32 v[170:171], v[170:171], v[188:189], v[188:189] op_sel_hi:[1,0,0]
    v_pk_fma_f32 v[172:173], v[172:173], v[188:189], v[188:189] op_sel_hi:[1,0,0]
    v_pk_fma_f32 v[174:175], v[174:175], v[188:189], v[188:189] op_sel_hi:[1,0,0]
    v_rcp_f32 v168, v168
    v_rcp_f32 v169, v169
    v_rcp_f32 v170, v170
    v_rcp_f32 v171, v171
    v_rcp_f32 v172, v172
    v_rcp_f32 v173, v173
    v_rcp_f32 v174, v174
    v_rcp_f32 v175, v175
    v_pk_mul_f32 v[48:49], v[48:49], v[168:169]
    v_pk_mul_f32 v[50:51], v[50:51], v[170:171]
    v_pk_mul_f32 v[52:53], v[52:53], v[172:173]
    v_pk_mul_f32 v[54:55], v[54:55], v[174:175]
    v_cvt_pk_bf16_f32 v140, v48, v49
    v_cvt_pk_bf16_f32 v141, v50, v51
    v_cvt_pk_bf16_f32 v142, v52, v53
    v_cvt_pk_bf16_f32 v143, v54, v55
    s_branch L_COMMON
L_CODE_END:
.fill 64, 4, 0xbf800000
.section .rodata,"a"
.p2align 6
.amdhsa_kernel parallel_sum__mha_block__glu_gated_geglu__prompt_kernel
  .amdhsa_next_free_vgpr 256
  .amdhsa_next_free_sgpr 84
  .amdhsa_accum_offset 256
  .amdhsa_group_segment_fixed_size 0
  .amdhsa_kernarg_size 80
  .amdhsa_user_sgpr_count 2
  .amdhsa_user_sgpr_kernarg_segment_ptr 1
  .amdhsa_system_sgpr_workgroup_id_x 1
.end_amdhsa_kernel
```
